```python
import torch

def _softmax(x, axis=-1):
    return torch.softmax(x, dim=axis)
def _gelu(x):
    return torch.nn.functional.gelu(x, approximate="tanh")
def _silu(x):
    return torch.nn.functional.silu(x)
def _sigmoid(x):
    return torch.sigmoid(x)
def _layernorm(x, axis=-1, eps=1e-5):
    m = x.mean(dim=axis, keepdim=True)
    v = x.var(dim=axis, keepdim=True, unbiased=False)
    return (x - m) / torch.sqrt(v + eps)
def _scatter_add(tgt, idx, src, axis=0):
    return tgt.clone().index_add_(axis, idx, src)
def _segment_sum(src, seg, n):
    out = torch.zeros((n,) + src.shape[1:], dtype=src.dtype)
    return out.index_add_(0, seg, src)
def _pad(x, pw):
    flat = tuple(v for pair in reversed(pw) for v in pair)
    return torch.nn.functional.pad(x, flat)

kernel_name = 'concat_heads__mha_block__ssm_conv_s4d__prompt'

def setup_inputs():

    _w = (lambda a: (lambda t: t.to(torch.bfloat16) if t.is_floating_point() else t)(torch.as_tensor(a)))
    def _A_setup():
        B, S, D, H = 1, 2048, 640, 32
        return {
            "x": _w((lambda *s: torch.randn(*s, dtype=torch.bfloat16) * 0.2)(B, S, D)),
            "wqkv": _w((lambda *s: torch.randn(*s, dtype=torch.bfloat16) * 0.2)(D, 3 * D)),
            "wo": _w((lambda *s: torch.randn(*s, dtype=torch.bfloat16) * 0.05)(D, D)),
        }
    _A_in = _A_setup()

    def _B_setup():
        Bsz, L, D, N = 1, 2048, 640, 128
        return {
            "u": _w((lambda *s: torch.randn(*s, dtype=torch.bfloat16) * 0.05)(Bsz, L, D)),
            "log_A_real": _w((lambda *s: torch.randn(*s, dtype=torch.bfloat16) * 6.4)(D, N) * 0.5),
            "A_imag": _w((lambda *s: torch.randn(*s, dtype=torch.bfloat16) * 0.1)(D, N) * 3.14),
            "C_real": _w((lambda *s: torch.randn(*s, dtype=torch.bfloat16) * 0.8)(D, N) / N ** 0.5),
            "C_imag": _w((lambda *s: torch.randn(*s, dtype=torch.bfloat16) * 0.8)(D, N) / N ** 0.5),
            "log_dt": _w((lambda *s: torch.randn(*s, dtype=torch.bfloat16) * 0.1)(D) * 0.5 - 4.0),
            "D_skip": _w((lambda *s: torch.randn(*s, dtype=torch.bfloat16) * 0.1)(D)),
        }
    _B_in = _B_setup()

    return {
        "A_x": _A_in["x"],
        "A_wqkv": _A_in["wqkv"],
        "A_wo": _A_in["wo"],
        "B_u": _B_in["u"],
        "B_log_A_real": _B_in["log_A_real"],
        "B_A_imag": _B_in["A_imag"],
        "B_C_real": _B_in["C_real"],
        "B_C_imag": _B_in["C_imag"],
        "B_log_dt": _B_in["log_dt"],
        "B_D_skip": _B_in["D_skip"],
    }

def reference(A_x, A_wqkv, A_wo, B_u, B_log_A_real, B_A_imag, B_C_real, B_C_imag, B_log_dt, B_D_skip):
    def _A_ref(x, wqkv, wo):
        B, S, D = x.shape
        H = 32
        Dh = D // H
        qkv = (lambda x, *d: x.permute(*d))((x @ wqkv).reshape(B, S, 3, H, Dh), 2, 0, 3, 1, 4)
        q, k, v = qkv[0], qkv[1], qkv[2]
        scores = torch.einsum("bhqd,bhkd->bhqk", q, k) * (Dh ** -0.5)
        p = _softmax(scores, axis=-1)
        o = torch.einsum("bhqk,bhkd->bhqd", p, v)
        return (lambda x, *d: x.permute(*d))(o, 0, 2, 1, 3).reshape(B, S, D) @ wo

    def _B_ref(u, log_A_real, A_imag, C_real, C_imag, log_dt, D_skip):
        L = u.shape[1]
        dt = torch.exp(log_dt)
        A = -torch.exp(log_A_real) + 1j * A_imag
        C = (C_real + 1j * C_imag) * dt[:, None]
        pos = (lambda x, dt: x.to(dt))(torch.arange(L), log_dt.dtype)
        P = torch.exp((A * dt[:, None])[:, :, None] * pos[None, None, :])
        K = 2.0 * torch.einsum("dn,dnl->dl", C, P).real
        L2 = 2 * L
        u_t = (lambda x, *d: x.permute(*d))(u, 0, 2, 1)
        Kf = (lambda x, *a, **k: torch.fft.rfft(x.float(), *a, **k))(K, L2)
        Uf = (lambda x, *a, **k: torch.fft.rfft(x.float(), *a, **k))(u_t, L2)
        y = (lambda x, *a, **k: torch.fft.irfft(x, *a, **k).to(torch.bfloat16))(Uf * Kf[None, :, :], L2)[:, :, :L]
        y = (lambda x, *d: x.permute(*d))(y, 0, 2, 1)
        return y + u * D_skip[None, None, :]

    a = _A_ref(A_x, A_wqkv, A_wo)
    b = _B_ref(B_u, B_log_A_real, B_A_imag, B_C_real, B_C_imag, B_log_dt, B_D_skip)
    return torch.concatenate([a, b], axis=-1)
```

```asm
; @launch grid=(512,1,1) block=(256,1,1) lds=81920
.amdgcn_target "amdgcn-amd-amdhsa--gfx950"
.text
.globl concat_heads__mha_block__ssm_conv_s4d__prompt_kernel
.p2align 8
.type concat_heads__mha_block__ssm_conv_s4d__prompt_kernel,@function
concat_heads__mha_block__ssm_conv_s4d__prompt_kernel:
    v_lshrrev_b32 v2, 6, v0
    v_and_b32 v1, 63, v0
    s_cmp_ge_u32 s2, 256
    v_readfirstlane_b32 s32, v2
    s_cbranch_scc1 aux_1
    s_load_dwordx2 s[8:9], s[0:1], 0
    s_load_dwordx2 s[12:13], s[0:1], 8
    s_load_dwordx2 s[16:17], s[0:1], 96
    s_load_dwordx2 s[28:29], s[0:1], 88
    s_getpc_b64 s[6:7]
pf_anchor:
    s_sub_u32 s6, s6, pf_anchor-concat_heads__mha_block__ssm_conv_s4d__prompt_kernel
    s_subb_u32 s7, s7, 0
    s_lshr_b32 s3, s2, 3
    s_mul_i32 s3, s3, 1408
    v_lshl_add_u32 v2, v0, 3, s3
    global_load_dwordx2 v[238:239], v2, s[6:7]
    s_mov_b32 s10, 2621440
    s_mov_b32 s11, 0x20000
    s_and_b32 s36, s2, 6
    s_bfe_u32 s4, s2, 0x10006
    s_add_u32 s36, s36, s4
    s_lshr_b32 s4, s2, 7
    s_lshl3_add_u32 s36, s4, s36
    s_bfe_u32 s5, s2, 0x30003
    s_lshr_b32 s4, s2, 6
    s_mul_i32 s41, s4, 20
    s_mul_i32 s3, s5, 10
    s_add_u32 s41, s41, s3
    s_and_b32 s3, s2, 1
    s_mul_i32 s3, s3, 0
    s_add_u32 s41, s41, s3
    s_lshr_b32 s41, s41, 3
    s_cmp_ge_u32 s41, 10
    s_cselect_b32 s3, 10, 0
    s_sub_u32 s41, s41, s3
    s_lshl_b32 s39, s41, 7
    s_lshl_b32 s42, s32, 12
    s_add_u32 s42, s42, 32768
    s_lshl2_add_u32 s3, s36, s32
    s_mul_i32 s3, s3, 40960
    v_lshrrev_b32 v24, 3, v1
    v_mul_u32_u24 v25, 1280, v24
    v_lshrrev_b32 v26, 4, v1
    v_xor_b32 v27, v26, v1
    v_and_b32 v27, 7, v27
    v_lshl_add_u32 v25, v27, 4, v25
    v_add_u32 v4, s3, v25
    v_xor_b32 v5, 64, v4
    v_add_u32 v5, 10240, v5
    v_add_u32 v6, 20480, v4
    v_add_u32 v7, 20480, v5
    s_waitcnt lgkmcnt(0)
    s_add_u32 m0, s42, 0
    s_nop 0
    buffer_load_dwordx4 v4, s[8:11], s39 offen lds
    s_add_u32 m0, s42, 1024
    s_nop 0
    buffer_load_dwordx4 v5, s[8:11], s39 offen lds
    s_add_u32 m0, s42, 2048
    s_nop 0
    buffer_load_dwordx4 v6, s[8:11], s39 offen lds
    s_add_u32 m0, s42, 3072
    s_nop 0
    buffer_load_dwordx4 v7, s[8:11], s39 offen lds
    s_add_u32 s39, s39, 128
    s_cmp_eq_u32 s39, 1280
    s_cselect_b32 s39, 0, s39
    s_and_b32 s3, s2, 6
    s_lshl_b32 s3, s3, 1
    s_lshr_b32 s33, 0x7520, s3
    s_and_b32 s33, s33, 15
    s_and_b32 s4, s2, 1
    s_bfe_u32 s5, s2, 0x30003
    s_lshl3_add_u32 s51, s4, s5
    s_add_u32 s37, s51, s33
    s_add_u32 s3, s37, 7
    s_cmp_ge_u32 s51, 13
    s_cselect_b32 s37, s3, s37
    s_cmp_lt_u32 s51, 10
    s_cselect_b32 s37, s51, s37
    s_mul_i32 s41, s41, 245760
    s_lshl_b32 s40, s37, 7
    s_lshl_b32 s43, s32, 11
    s_mul_i32 s3, s32, 61440
    v_mul_u32_u24 v25, 3840, v24
    v_lshlrev_b32 v26, 2, v26
    v_xor_b32 v26, v26, v1
    v_and_b32 v26, 7, v26
    v_lshl_add_u32 v25, v26, 4, v25
    v_add_u32 v8, s3, v25
    v_add_u32 v9, 30720, v8
    s_mov_b32 s14, 2457600
    s_mov_b32 s15, 0x20000
    s_add_u32 s4, s41, 0
    s_cmp_ge_u32 s4, 2457600
    s_cselect_b32 s5, 2457600, 0
    s_sub_u32 s4, s4, s5
    s_add_u32 s4, s4, s40
    s_add_u32 m0, s43, 0
    s_nop 0
    buffer_load_dwordx4 v8, s[12:15], s4 offen lds
    s_add_u32 m0, s43, 1024
    s_nop 0
    buffer_load_dwordx4 v9, s[12:15], s4 offen lds
    s_add_u32 m0, s42, 16384
    s_nop 0
    buffer_load_dwordx4 v4, s[8:11], s39 offen lds
    s_add_u32 m0, s42, 17408
    s_nop 0
    buffer_load_dwordx4 v5, s[8:11], s39 offen lds
    s_add_u32 m0, s42, 18432
    s_nop 0
    buffer_load_dwordx4 v6, s[8:11], s39 offen lds
    s_add_u32 m0, s42, 19456
    s_nop 0
    buffer_load_dwordx4 v7, s[8:11], s39 offen lds
    s_add_u32 s39, s39, 128
    s_cmp_eq_u32 s39, 1280
    s_cselect_b32 s39, 0, s39
    s_add_u32 s4, s41, 245760
    s_cmp_ge_u32 s4, 2457600
    s_cselect_b32 s5, 2457600, 0
    s_sub_u32 s4, s4, s5
    s_add_u32 s4, s4, s40
    s_add_u32 m0, s43, 8192
    s_nop 0
    buffer_load_dwordx4 v8, s[12:15], s4 offen lds
    s_add_u32 m0, s43, 9216
    s_nop 0
    buffer_load_dwordx4 v9, s[12:15], s4 offen lds
    s_mov_b32 s30, 256
    s_mov_b32 s31, 0x20000
    s_mov_b32 s18, 16777216
    s_mov_b32 s19, 0x20000
    v_and_b32 v24, 31, v1
    v_lshrrev_b32 v25, 5, v1
    v_bfe_u32 v26, v1, 1, 3
    v_xor_b32 v26, v26, v25
    v_lshl_add_u32 v28, v24, 7, s42
    v_xor_b32 v27, 0, v26
    v_lshl_add_u32 v10, v27, 4, v28
    v_xor_b32 v27, 2, v26
    v_lshl_add_u32 v11, v27, 4, v28
    v_xor_b32 v27, 4, v26
    v_lshl_add_u32 v12, v27, 4, v28
    v_xor_b32 v27, 6, v26
    v_lshl_add_u32 v13, v27, 4, v28
    v_lshlrev_b32 v27, 15, v25
    v_lshl_add_u32 v22, v24, 4, v27
    v_mul_u32_u24 v27, 4352, v25
    v_lshl_add_u32 v23, v24, 4, v27
    v_bfe_u32 v24, v1, 2, 2
    v_lshl_add_u32 v25, v25, 3, v24
    v_lshlrev_b32 v25, 7, v25
    v_bfe_u32 v26, v1, 4, 1
    v_lshl_add_u32 v25, v26, 5, v25
    v_bfe_u32 v26, v1, 3, 1
    v_lshl_add_u32 v25, v26, 6, v25
    v_and_b32 v26, 3, v1
    v_lshl_add_u32 v18, v26, 3, v25
    v_and_b32 v27, 1, v1
    v_bfe_u32 v28, v1, 1, 1
    v_lshl_add_u32 v27, v27, 1, v28
    v_lshl_add_u32 v14, v27, 3, v25
    v_xor_b32 v15, 64, v14
    v_xor_b32 v19, 64, v18
    v_add_u32 v16, 40960, v14
    v_add_u32 v17, 40960, v15
    v_add_u32 v20, 40960, v18
    v_add_u32 v21, 40960, v19
    v_bfe_u32 v24, v1, 3, 2
    v_mul_u32_u24 v24, 2176, v24
    v_and_b32 v26, 7, v1
    v_lshl_add_u32 v255, v26, 4, v24
    v_mov_b32 v3, 0x1010101
    s_sub_u32 s3, s51, 7
    s_cmp_ge_u32 s51, 7
    s_cselect_b32 s3, s3, s51
    s_cselect_b32 s4, 20, 10
    s_add_u32 s5, s3, 3
    s_cmp_lt_u32 s3, s33
    s_cselect_b32 s3, s3, s5
    s_add_u32 s33, s3, s4
    s_lshl_b32 s38, s33, 7
    s_cmp_ge_u32 s51, 14
    s_cselect_b32 s38, 1073741824, s38
    s_add_u32 m0, s42, 32768
    s_nop 0
    buffer_load_dwordx4 v4, s[8:11], s39 offen lds
    s_add_u32 m0, s42, 33792
    s_nop 0
    buffer_load_dwordx4 v5, s[8:11], s39 offen lds
    s_add_u32 m0, s42, 34816
    s_nop 0
    buffer_load_dwordx4 v6, s[8:11], s39 offen lds
    s_add_u32 m0, s42, 35840
    s_nop 0
    buffer_load_dwordx4 v7, s[8:11], s39 offen lds
    s_add_u32 s39, s39, 128
    s_cmp_eq_u32 s39, 1280
    s_cselect_b32 s39, 0, s39
    s_add_u32 s4, s41, 491520
    s_cmp_ge_u32 s4, 2457600
    s_cselect_b32 s5, 2457600, 0
    s_sub_u32 s4, s4, s5
    s_add_u32 s4, s4, s40
    s_add_u32 m0, s43, 16384
    s_nop 0
    buffer_load_dwordx4 v8, s[12:15], s4 offen lds
    s_add_u32 m0, s43, 17408
    s_nop 0
    buffer_load_dwordx4 v9, s[12:15], s4 offen lds
    s_lshr_b32 s57, s32, 1
    s_and_b32 s7, s2, 7
    s_lshl_b32 s44, s7, 1
    s_lshr_b32 s27, s2, 7
    s_add_u32 s44, s44, s27
    s_bfe_u32 s45, s2, 0x40003
    s_and_b32 s7, s32, 1
    s_mul_i32 s27, s44, 5
    s_mul_i32 s52, s7, 3
    s_add_u32 s52, s52, s27
    s_add_u32 s53, s27, 2
    s_lshl_b32 s54, s52, 3
    s_lshl_b32 s55, s53, 3
    s_lshl_b32 s27, s7, 2
    s_add_u32 s55, s55, s27
    s_lshl_b32 s52, s52, 15
    s_lshl_b32 s53, s53, 15
    s_lshl_b32 s27, s7, 3
    s_add_u32 s53, s53, s27
    v_and_b32 v240, 31, v1
    v_lshrrev_b32 v241, 5, v1
    v_lshlrev_b32 v242, 15, v241
    v_lshl_add_u32 v242, v240, 4, v242
    v_add_u32 v250, s52, v242
    v_lshl_add_u32 v251, v240, 4, s53
    v_lshl_add_u32 v253, v1, 4, s53
    v_bfe_u32 v242, v1, 2, 1
    v_lshlrev_b32 v242, 3, v242
    v_bfe_u32 v243, v1, 3, 1
    v_lshl_add_u32 v242, v243, 2, v242
    v_add_u32 v242, s54, v242
    v_mov_b32 v243, s55
    s_mov_b32 vcc_lo, 0x0000ffff
    s_mov_b32 vcc_hi, 0x0000ffff
    v_cndmask_b32 v242, v243, v242, vcc
    v_and_b32 v243, 3, v1
    v_add_u32 v242, v242, v243
    v_lshrrev_b32 v243, 7, v242
    v_and_b32 v242, 127, v242
    v_mov_b32 v244, 128
    s_mov_b32 vcc_lo, 0x000fffff
    s_mov_b32 vcc_hi, 0x000fffff
    v_cndmask_b32 v242, v244, v242, vcc
    s_mov_b32 s7, 557056
    v_mul_lo_u32 v243, v243, s7
    v_lshl_add_u32 v242, v242, 4, v243
    v_mul_u32_u24 v241, 4352, v241
    v_add_u32 v242, v242, v241
    v_add_u32 v242, 5242880, v242
    s_mov_b32 vcc_lo, 0xeee00000
    s_mov_b32 vcc_hi, 0xeee00000
    v_mov_b32 v244, 1073741824
    v_cndmask_b32 v252, v242, v244, vcc
    s_lshr_b32 s56, s44, 2
    s_lshl_b32 s56, s56, 1
    s_mul_i32 s7, s44, 40
    s_add_u32 s27, s7, 39
    s_lshr_b32 s7, s7, 6
    s_lshr_b32 s27, s27, 6
    s_cmp_eq_u32 s7, s27
    s_mov_b32 s34, 0x03030303
    s_cselect_b32 s34, 0x00030003, s34
    s_cselect_b32 s35, 1, 3
    s_lshl_b32 s34, s34, s56
    v_mov_b32 v240, s7
    v_mov_b32 v241, s27
    s_mov_b32 vcc_lo, 0xff00ff00
    s_mov_b32 vcc_hi, 0xaaaaaaaa
    v_cndmask_b32 v240, v240, v241, vcc
    v_bfe_u32 v241, v1, 4, 1
    v_mad_u32_u24 v241, v241, 10, 10
    v_and_b32 v242, 7, v1
    s_lshl_b32 s7, s57, 3
    v_add_u32 v242, s7, v242
    v_mov_b32 v243, s45
    s_mov_b32 vcc_lo, -1
    s_mov_b32 vcc_hi, 0
    v_cndmask_b32 v241, 0, v241, vcc
    v_cndmask_b32 v242, v243, v242, vcc
    v_add_u32 v240, v240, v241
    v_lshlrev_b32 v240, 11, v240
    v_lshl_add_u32 v240, v242, 7, v240
    v_add_u32 v254, 15990784, v240
    s_lshl_b32 s63, s45, 11
    s_add_u32 s63, s63, s44
    s_add_u32 s63, s63, 16052224
    s_lshl3_add_u32 s50, s57, s56
    s_lshl_b32 s47, s50, 11
    s_add_u32 s47, s47, 2621440
    s_mul_i32 s49, s50, 34816
    s_add_u32 s56, s56, 2
    s_mul_i32 s54, s45, 0
    s_lshr_b32 s54, s54, 3
    s_add_u32 s50, s50, 1
    s_add_u32 s48, s47, 2048
    s_mov_b32 s46, 6
    s_lshl_b32 s60, s45, 11
    s_lshl_b32 s7, s57, 10
    s_add_u32 s60, s60, s7
    s_xor_b32 s61, s60, 1024
    s_lshl_b32 s55, s32, 30
    s_and_b32 s55, s55, 1073741824
    s_add_u32 s55, s55, s60
    s_add_u32 s55, s55, 8126464
    s_lshl_b32 s7, s2, 7
    s_add_u32 s7, s7, 16089088
    s_lshl_b32 s27, s32, 28
    s_or_b32 s7, s7, s27
    v_mov_b32 v248, s7
    v_mov_b32 v249, 1
    s_cmp_ge_u32 s37, 20
    s_cbranch_scc1 g1_p1v_7
    s_lshl_b32 s3, s37, 18
    s_lshl2_add_u32 s5, s36, s32
    s_lshl_b32 s5, s5, 9
    s_add_u32 s20, s3, s5
    s_add_u32 s21, s20, 65536
    s_add_u32 s22, s20, 131072
    s_add_u32 s23, s20, 196608
    s_mov_b32 s24, 1073741824
    s_lshl4_add_u32 s3, s37, s36
    s_lshl_b32 s3, s3, 7
    s_add_u32 s3, s3, s32
    s_add_u32 s25, s3, 15990784
    s_lshl_b32 s3, s32, 28
    s_or_b32 s26, s25, s3
    s_mov_b32 s62, s25
    s_cmp_lt_u32 s37, 10
    s_cselect_b32 s6, 0x3ea52b5c, 1.0
    s_waitcnt vmcnt(12)
    s_barrier
    s_setprio 2
    ds_read_b128 v[88:91], v10 offset:0
    ds_read_b64_tr_b16 v[24:25], v14 offset:0
    ds_read_b64_tr_b16 v[26:27], v14 offset:512
    ds_read_b64_tr_b16 v[28:29], v15 offset:0
    ds_read_b64_tr_b16 v[30:31], v15 offset:512
    ds_read_b128 v[92:95], v11 offset:0
    ds_read_b64_tr_b16 v[32:33], v14 offset:2048
    ds_read_b64_tr_b16 v[34:35], v14 offset:2560
    ds_read_b64_tr_b16 v[36:37], v15 offset:2048
    ds_read_b64_tr_b16 v[38:39], v15 offset:2560
    s_add_u32 s4, s41, 737280
    s_cmp_ge_u32 s4, 2457600
    s_cselect_b32 s5, 2457600, 0
    s_sub_u32 s4, s4, s5
    s_add_u32 s4, s4, s40
    s_add_u32 m0, s43, 24576
    s_nop 0
    buffer_load_dwordx4 v8, s[12:15], s4 offen lds
    ds_read_b128 v[96:99], v12 offset:0
    ds_read_b64_tr_b16 v[40:41], v14 offset:4096
    ds_read_b64_tr_b16 v[42:43], v14 offset:4608
    ds_read_b64_tr_b16 v[44:45], v15 offset:4096
    ds_read_b64_tr_b16 v[46:47], v15 offset:4608
    s_waitcnt lgkmcnt(10)
    v_mfma_f32_32x32x16_bf16 v[56:71], v[24:27], v[88:91], 0
    ds_read_b128 v[100:103], v13 offset:0
    ds_read_b64_tr_b16 v[48:49], v14 offset:6144
    ds_read_b64_tr_b16 v[50:51], v14 offset:6656
    v_mfma_f32_32x32x16_bf16 v[72:87], v[28:31], v[88:91], 0
    ds_read_b64_tr_b16 v[52:53], v15 offset:6144
    ds_read_b64_tr_b16 v[54:55], v15 offset:6656
    s_add_u32 m0, s43, 25600
    s_nop 0
    buffer_load_dwordx4 v9, s[12:15], s4 offen lds
    s_waitcnt lgkmcnt(10)
    v_mfma_f32_32x32x16_bf16 v[56:71], v[32:35], v[92:95], v[56:71]
    v_mfma_f32_32x32x16_bf16 v[72:87], v[36:39], v[92:95], v[72:87]
    s_waitcnt lgkmcnt(0)
    v_mfma_f32_32x32x16_bf16 v[56:71], v[40:43], v[96:99], v[56:71]
    s_add_u32 m0, s42, 0
    s_nop 0
    buffer_load_dwordx4 v4, s[8:11], s39 offen lds
    v_mfma_f32_32x32x16_bf16 v[72:87], v[44:47], v[96:99], v[72:87]
    s_add_u32 m0, s42, 1024
    s_nop 0
    buffer_load_dwordx4 v5, s[8:11], s39 offen lds
    v_mfma_f32_32x32x16_bf16 v[56:71], v[48:51], v[100:103], v[56:71]
    s_add_u32 m0, s42, 2048
    s_nop 0
    buffer_load_dwordx4 v6, s[8:11], s39 offen lds
    v_mfma_f32_32x32x16_bf16 v[72:87], v[52:55], v[100:103], v[72:87]
    s_add_u32 m0, s42, 3072
    s_nop 0
    buffer_load_dwordx4 v7, s[8:11], s39 offen lds
    s_add_u32 s39, s39, 128
    s_cmp_eq_u32 s39, 1280
    s_cselect_b32 s39, 0, s39
    s_waitcnt vmcnt(12)
    s_barrier
    ds_read_b128 v[104:107], v10 offset:16384
    ds_read_b64_tr_b16 v[24:25], v14 offset:8192
    ds_read_b64_tr_b16 v[26:27], v14 offset:8704
    ds_read_b64_tr_b16 v[28:29], v15 offset:8192
    ds_read_b64_tr_b16 v[30:31], v15 offset:8704
    ds_read_b128 v[108:111], v11 offset:16384
    ds_read_b64_tr_b16 v[32:33], v14 offset:10240
    ds_read_b64_tr_b16 v[34:35], v14 offset:10752
    ds_read_b64_tr_b16 v[36:37], v15 offset:10240
    ds_read_b64_tr_b16 v[38:39], v15 offset:10752
    s_add_u32 s4, s41, 983040
    s_cmp_ge_u32 s4, 2457600
    s_cselect_b32 s5, 2457600, 0
    s_sub_u32 s4, s4, s5
    s_add_u32 s4, s4, s40
    s_add_u32 m0, s43, 0
    s_nop 0
    buffer_load_dwordx4 v8, s[12:15], s4 offen lds
    ds_read_b128 v[112:115], v12 offset:16384
    ds_read_b64_tr_b16 v[40:41], v14 offset:12288
    ds_read_b64_tr_b16 v[42:43], v14 offset:12800
    ds_read_b64_tr_b16 v[44:45], v15 offset:12288
    ds_read_b64_tr_b16 v[46:47], v15 offset:12800
    s_waitcnt lgkmcnt(10)
    v_mfma_f32_32x32x16_bf16 v[56:71], v[24:27], v[104:107], v[56:71]
    ds_read_b128 v[116:119], v13 offset:16384
    ds_read_b64_tr_b16 v[48:49], v14 offset:14336
    ds_read_b64_tr_b16 v[50:51], v14 offset:14848
    v_mfma_f32_32x32x16_bf16 v[72:87], v[28:31], v[104:107], v[72:87]
    ds_read_b64_tr_b16 v[52:53], v15 offset:14336
    ds_read_b64_tr_b16 v[54:55], v15 offset:14848
    s_add_u32 m0, s43, 1024
    s_nop 0
    buffer_load_dwordx4 v9, s[12:15], s4 offen lds
    s_waitcnt lgkmcnt(10)
    v_mfma_f32_32x32x16_bf16 v[56:71], v[32:35], v[108:111], v[56:71]
    v_mfma_f32_32x32x16_bf16 v[72:87], v[36:39], v[108:111], v[72:87]
    s_waitcnt lgkmcnt(0)
    v_mfma_f32_32x32x16_bf16 v[56:71], v[40:43], v[112:115], v[56:71]
    s_add_u32 m0, s42, 16384
    s_nop 0
    buffer_load_dwordx4 v4, s[8:11], s39 offen lds
    v_mfma_f32_32x32x16_bf16 v[72:87], v[44:47], v[112:115], v[72:87]
    s_add_u32 m0, s42, 17408
    s_nop 0
    buffer_load_dwordx4 v5, s[8:11], s39 offen lds
    v_mfma_f32_32x32x16_bf16 v[56:71], v[48:51], v[116:119], v[56:71]
    s_add_u32 m0, s42, 18432
    s_nop 0
    buffer_load_dwordx4 v6, s[8:11], s39 offen lds
    v_mfma_f32_32x32x16_bf16 v[72:87], v[52:55], v[116:119], v[72:87]
    s_add_u32 m0, s42, 19456
    s_nop 0
    buffer_load_dwordx4 v7, s[8:11], s39 offen lds
    s_add_u32 s39, s39, 128
    s_cmp_eq_u32 s39, 1280
    s_cselect_b32 s39, 0, s39
    s_waitcnt vmcnt(12)
    s_barrier
    ds_read_b128 v[120:123], v10 offset:32768
    ds_read_b64_tr_b16 v[24:25], v14 offset:16384
    ds_read_b64_tr_b16 v[26:27], v14 offset:16896
    ds_read_b64_tr_b16 v[28:29], v15 offset:16384
    ds_read_b64_tr_b16 v[30:31], v15 offset:16896
    ds_read_b128 v[124:127], v11 offset:32768
    ds_read_b64_tr_b16 v[32:33], v14 offset:18432
    ds_read_b64_tr_b16 v[34:35], v14 offset:18944
    ds_read_b64_tr_b16 v[36:37], v15 offset:18432
    ds_read_b64_tr_b16 v[38:39], v15 offset:18944
    s_add_u32 s4, s41, 1228800
    s_cmp_ge_u32 s4, 2457600
    s_cselect_b32 s5, 2457600, 0
    s_sub_u32 s4, s4, s5
    s_add_u32 s4, s4, s40
    s_add_u32 m0, s43, 8192
    s_nop 0
    buffer_load_dwordx4 v8, s[12:15], s4 offen lds
    ds_read_b128 v[128:131], v12 offset:32768
    ds_read_b64_tr_b16 v[40:41], v14 offset:20480
    ds_read_b64_tr_b16 v[42:43], v14 offset:20992
    ds_read_b64_tr_b16 v[44:45], v15 offset:20480
    ds_read_b64_tr_b16 v[46:47], v15 offset:20992
    s_waitcnt lgkmcnt(10)
    v_mfma_f32_32x32x16_bf16 v[56:71], v[24:27], v[120:123], v[56:71]
    ds_read_b128 v[132:135], v13 offset:32768
    ds_read_b64_tr_b16 v[48:49], v14 offset:22528
    ds_read_b64_tr_b16 v[50:51], v14 offset:23040
    v_mfma_f32_32x32x16_bf16 v[72:87], v[28:31], v[120:123], v[72:87]
    ds_read_b64_tr_b16 v[52:53], v15 offset:22528
    ds_read_b64_tr_b16 v[54:55], v15 offset:23040
    s_add_u32 m0, s43, 9216
    s_nop 0
    buffer_load_dwordx4 v9, s[12:15], s4 offen lds
    s_waitcnt lgkmcnt(10)
    v_mfma_f32_32x32x16_bf16 v[56:71], v[32:35], v[124:127], v[56:71]
    v_mfma_f32_32x32x16_bf16 v[72:87], v[36:39], v[124:127], v[72:87]
    s_waitcnt lgkmcnt(0)
    v_mfma_f32_32x32x16_bf16 v[56:71], v[40:43], v[128:131], v[56:71]
    s_add_u32 m0, s42, 32768
    s_nop 0
    buffer_load_dwordx4 v4, s[8:11], s39 offen lds
    v_mfma_f32_32x32x16_bf16 v[72:87], v[44:47], v[128:131], v[72:87]
    s_add_u32 m0, s42, 33792
    s_nop 0
    buffer_load_dwordx4 v5, s[8:11], s39 offen lds
    v_mfma_f32_32x32x16_bf16 v[56:71], v[48:51], v[132:135], v[56:71]
    s_add_u32 m0, s42, 34816
    s_nop 0
    buffer_load_dwordx4 v6, s[8:11], s39 offen lds
    v_mfma_f32_32x32x16_bf16 v[72:87], v[52:55], v[132:135], v[72:87]
    s_add_u32 m0, s42, 35840
    s_nop 0
    buffer_load_dwordx4 v7, s[8:11], s39 offen lds
    s_add_u32 s39, s39, 128
    s_cmp_eq_u32 s39, 1280
    s_cselect_b32 s39, 0, s39
    s_waitcnt vmcnt(12)
    s_barrier
    ds_read_b128 v[136:139], v10 offset:0
    ds_read_b64_tr_b16 v[24:25], v14 offset:24576
    ds_read_b64_tr_b16 v[26:27], v14 offset:25088
    ds_read_b64_tr_b16 v[28:29], v15 offset:24576
    ds_read_b64_tr_b16 v[30:31], v15 offset:25088
    ds_read_b128 v[140:143], v11 offset:0
    ds_read_b64_tr_b16 v[32:33], v14 offset:26624
    ds_read_b64_tr_b16 v[34:35], v14 offset:27136
    ds_read_b64_tr_b16 v[36:37], v15 offset:26624
    ds_read_b64_tr_b16 v[38:39], v15 offset:27136
    s_add_u32 s4, s41, 1474560
    s_cmp_ge_u32 s4, 2457600
    s_cselect_b32 s5, 2457600, 0
    s_sub_u32 s4, s4, s5
    s_add_u32 s4, s4, s40
    s_add_u32 m0, s43, 16384
    s_nop 0
    buffer_load_dwordx4 v8, s[12:15], s4 offen lds
    ds_read_b128 v[144:147], v12 offset:0
    ds_read_b64_tr_b16 v[40:41], v14 offset:28672
    ds_read_b64_tr_b16 v[42:43], v14 offset:29184
    ds_read_b64_tr_b16 v[44:45], v15 offset:28672
    ds_read_b64_tr_b16 v[46:47], v15 offset:29184
    s_waitcnt lgkmcnt(10)
    v_mfma_f32_32x32x16_bf16 v[56:71], v[24:27], v[136:139], v[56:71]
    ds_read_b128 v[148:151], v13 offset:0
    ds_read_b64_tr_b16 v[48:49], v14 offset:30720
    ds_read_b64_tr_b16 v[50:51], v14 offset:31232
    v_mfma_f32_32x32x16_bf16 v[72:87], v[28:31], v[136:139], v[72:87]
    ds_read_b64_tr_b16 v[52:53], v15 offset:30720
    ds_read_b64_tr_b16 v[54:55], v15 offset:31232
    s_add_u32 m0, s43, 17408
    s_nop 0
    buffer_load_dwordx4 v9, s[12:15], s4 offen lds
    s_waitcnt lgkmcnt(10)
    v_mfma_f32_32x32x16_bf16 v[56:71], v[32:35], v[140:143], v[56:71]
    v_mfma_f32_32x32x16_bf16 v[72:87], v[36:39], v[140:143], v[72:87]
    s_waitcnt lgkmcnt(0)
    v_mfma_f32_32x32x16_bf16 v[56:71], v[40:43], v[144:147], v[56:71]
    s_add_u32 m0, s42, 0
    s_nop 0
    buffer_load_dwordx4 v4, s[8:11], s39 offen lds
    v_mfma_f32_32x32x16_bf16 v[72:87], v[44:47], v[144:147], v[72:87]
    s_add_u32 m0, s42, 1024
    s_nop 0
    buffer_load_dwordx4 v5, s[8:11], s39 offen lds
    v_mfma_f32_32x32x16_bf16 v[56:71], v[48:51], v[148:151], v[56:71]
    s_add_u32 m0, s42, 2048
    s_nop 0
    buffer_load_dwordx4 v6, s[8:11], s39 offen lds
    v_mfma_f32_32x32x16_bf16 v[72:87], v[52:55], v[148:151], v[72:87]
    s_add_u32 m0, s42, 3072
    s_nop 0
    buffer_load_dwordx4 v7, s[8:11], s39 offen lds
    s_add_u32 s39, s39, 128
    s_cmp_eq_u32 s39, 1280
    s_cselect_b32 s39, 0, s39
    v_mov_b32 v249, 16
    s_mov_b64 exec, 1
    buffer_store_dword v249, v248, s[16:19], 0 offen sc1
    s_mov_b64 exec, -1
    v_mov_b32 v249, 17
    s_waitcnt vmcnt(13)
    s_barrier
    ds_read_b128 v[152:155], v10 offset:16384
    ds_read_b64_tr_b16 v[24:25], v14 offset:0
    ds_read_b64_tr_b16 v[26:27], v14 offset:512
    ds_read_b64_tr_b16 v[28:29], v15 offset:0
    ds_read_b64_tr_b16 v[30:31], v15 offset:512
    ds_read_b128 v[156:159], v11 offset:16384
    ds_read_b64_tr_b16 v[32:33], v14 offset:2048
    ds_read_b64_tr_b16 v[34:35], v14 offset:2560
    ds_read_b64_tr_b16 v[36:37], v15 offset:2048
    ds_read_b64_tr_b16 v[38:39], v15 offset:2560
    s_add_u32 s4, s41, 1720320
    s_cmp_ge_u32 s4, 2457600
    s_cselect_b32 s5, 2457600, 0
    s_sub_u32 s4, s4, s5
    s_add_u32 s4, s4, s40
    s_add_u32 m0, s43, 24576
    s_nop 0
    buffer_load_dwordx4 v8, s[12:15], s4 offen lds
    ds_read_b128 v[160:163], v12 offset:16384
    ds_read_b64_tr_b16 v[40:41], v14 offset:4096
    ds_read_b64_tr_b16 v[42:43], v14 offset:4608
    ds_read_b64_tr_b16 v[44:45], v15 offset:4096
    ds_read_b64_tr_b16 v[46:47], v15 offset:4608
    s_waitcnt lgkmcnt(10)
    v_mfma_f32_32x32x16_bf16 v[56:71], v[24:27], v[152:155], v[56:71]
    ds_read_b128 v[164:167], v13 offset:16384
    ds_read_b64_tr_b16 v[48:49], v14 offset:6144
    ds_read_b64_tr_b16 v[50:51], v14 offset:6656
    v_mfma_f32_32x32x16_bf16 v[72:87], v[28:31], v[152:155], v[72:87]
    ds_read_b64_tr_b16 v[52:53], v15 offset:6144
    ds_read_b64_tr_b16 v[54:55], v15 offset:6656
    s_add_u32 m0, s43, 25600
    s_nop 0
    buffer_load_dwordx4 v9, s[12:15], s4 offen lds
    s_waitcnt lgkmcnt(10)
    v_mfma_f32_32x32x16_bf16 v[56:71], v[32:35], v[156:159], v[56:71]
    v_mfma_f32_32x32x16_bf16 v[72:87], v[36:39], v[156:159], v[72:87]
    s_waitcnt lgkmcnt(0)
    v_mfma_f32_32x32x16_bf16 v[56:71], v[40:43], v[160:163], v[56:71]
    s_add_u32 m0, s42, 16384
    s_nop 0
    buffer_load_dwordx4 v4, s[8:11], s39 offen lds
    v_mfma_f32_32x32x16_bf16 v[72:87], v[44:47], v[160:163], v[72:87]
    s_add_u32 m0, s42, 17408
    s_nop 0
    buffer_load_dwordx4 v5, s[8:11], s39 offen lds
    v_mfma_f32_32x32x16_bf16 v[56:71], v[48:51], v[164:167], v[56:71]
    s_add_u32 m0, s42, 18432
    s_nop 0
    buffer_load_dwordx4 v6, s[8:11], s39 offen lds
    v_mfma_f32_32x32x16_bf16 v[72:87], v[52:55], v[164:167], v[72:87]
    s_add_u32 m0, s42, 19456
    s_nop 0
    buffer_load_dwordx4 v7, s[8:11], s39 offen lds
    s_add_u32 s39, s39, 128
    s_cmp_eq_u32 s39, 1280
    s_cselect_b32 s39, 0, s39
    s_waitcnt vmcnt(13)
    s_barrier
    ds_read_b128 v[168:171], v10 offset:32768
    ds_read_b64_tr_b16 v[24:25], v14 offset:8192
    ds_read_b64_tr_b16 v[26:27], v14 offset:8704
    ds_read_b64_tr_b16 v[28:29], v15 offset:8192
    ds_read_b64_tr_b16 v[30:31], v15 offset:8704
    ds_read_b128 v[172:175], v11 offset:32768
    ds_read_b64_tr_b16 v[32:33], v14 offset:10240
    ds_read_b64_tr_b16 v[34:35], v14 offset:10752
    ds_read_b64_tr_b16 v[36:37], v15 offset:10240
    ds_read_b64_tr_b16 v[38:39], v15 offset:10752
    s_add_u32 s4, s41, 1966080
    s_cmp_ge_u32 s4, 2457600
    s_cselect_b32 s5, 2457600, 0
    s_sub_u32 s4, s4, s5
    s_add_u32 s4, s4, s40
    s_add_u32 m0, s43, 0
    s_nop 0
    buffer_load_dwordx4 v8, s[12:15], s4 offen lds
    ds_read_b128 v[176:179], v12 offset:32768
    ds_read_b64_tr_b16 v[40:41], v14 offset:12288
    ds_read_b64_tr_b16 v[42:43], v14 offset:12800
    ds_read_b64_tr_b16 v[44:45], v15 offset:12288
    ds_read_b64_tr_b16 v[46:47], v15 offset:12800
    s_waitcnt lgkmcnt(10)
    v_mfma_f32_32x32x16_bf16 v[56:71], v[24:27], v[168:171], v[56:71]
    ds_read_b128 v[180:183], v13 offset:32768
    ds_read_b64_tr_b16 v[48:49], v14 offset:14336
    ds_read_b64_tr_b16 v[50:51], v14 offset:14848
    v_mfma_f32_32x32x16_bf16 v[72:87], v[28:31], v[168:171], v[72:87]
    ds_read_b64_tr_b16 v[52:53], v15 offset:14336
    ds_read_b64_tr_b16 v[54:55], v15 offset:14848
    s_add_u32 m0, s43, 1024
    s_nop 0
    buffer_load_dwordx4 v9, s[12:15], s4 offen lds
    s_waitcnt lgkmcnt(10)
    v_mfma_f32_32x32x16_bf16 v[56:71], v[32:35], v[172:175], v[56:71]
    v_mfma_f32_32x32x16_bf16 v[72:87], v[36:39], v[172:175], v[72:87]
    s_waitcnt lgkmcnt(0)
    v_mfma_f32_32x32x16_bf16 v[56:71], v[40:43], v[176:179], v[56:71]
    s_add_u32 m0, s42, 32768
    s_nop 0
    buffer_load_dwordx4 v4, s[8:11], s39 offen lds
    v_mfma_f32_32x32x16_bf16 v[72:87], v[44:47], v[176:179], v[72:87]
    s_add_u32 m0, s42, 33792
    s_nop 0
    buffer_load_dwordx4 v5, s[8:11], s39 offen lds
    v_mfma_f32_32x32x16_bf16 v[56:71], v[48:51], v[180:183], v[56:71]
    s_add_u32 m0, s42, 34816
    s_nop 0
    buffer_load_dwordx4 v6, s[8:11], s39 offen lds
    v_mfma_f32_32x32x16_bf16 v[72:87], v[52:55], v[180:183], v[72:87]
    s_add_u32 m0, s42, 35840
    s_nop 0
    buffer_load_dwordx4 v7, s[8:11], s39 offen lds
    s_add_u32 s39, s39, 128
    s_cmp_eq_u32 s39, 1280
    s_cselect_b32 s39, 0, s39
    s_waitcnt vmcnt(13)
    s_barrier
    ds_read_b128 v[184:187], v10 offset:0
    ds_read_b64_tr_b16 v[24:25], v14 offset:16384
    ds_read_b64_tr_b16 v[26:27], v14 offset:16896
    ds_read_b64_tr_b16 v[28:29], v15 offset:16384
    ds_read_b64_tr_b16 v[30:31], v15 offset:16896
    ds_read_b128 v[188:191], v11 offset:0
    ds_read_b64_tr_b16 v[32:33], v14 offset:18432
    ds_read_b64_tr_b16 v[34:35], v14 offset:18944
    ds_read_b64_tr_b16 v[36:37], v15 offset:18432
    ds_read_b64_tr_b16 v[38:39], v15 offset:18944
    s_add_u32 s4, s41, 2211840
    s_cmp_ge_u32 s4, 2457600
    s_cselect_b32 s5, 2457600, 0
    s_sub_u32 s4, s4, s5
    s_add_u32 s4, s4, s40
    s_add_u32 m0, s43, 8192
    s_nop 0
    buffer_load_dwordx4 v8, s[12:15], s4 offen lds
    ds_read_b128 v[192:195], v12 offset:0
    ds_read_b64_tr_b16 v[40:41], v14 offset:20480
    ds_read_b64_tr_b16 v[42:43], v14 offset:20992
    ds_read_b64_tr_b16 v[44:45], v15 offset:20480
    ds_read_b64_tr_b16 v[46:47], v15 offset:20992
    s_waitcnt lgkmcnt(10)
    v_mfma_f32_32x32x16_bf16 v[56:71], v[24:27], v[184:187], v[56:71]
    ds_read_b128 v[196:199], v13 offset:0
    ds_read_b64_tr_b16 v[48:49], v14 offset:22528
    ds_read_b64_tr_b16 v[50:51], v14 offset:23040
    v_mfma_f32_32x32x16_bf16 v[72:87], v[28:31], v[184:187], v[72:87]
    ds_read_b64_tr_b16 v[52:53], v15 offset:22528
    ds_read_b64_tr_b16 v[54:55], v15 offset:23040
    s_add_u32 m0, s43, 9216
    s_nop 0
    buffer_load_dwordx4 v9, s[12:15], s4 offen lds
    s_waitcnt lgkmcnt(10)
    v_mfma_f32_32x32x16_bf16 v[56:71], v[32:35], v[188:191], v[56:71]
    v_mfma_f32_32x32x16_bf16 v[72:87], v[36:39], v[188:191], v[72:87]
    s_waitcnt lgkmcnt(0)
    v_mfma_f32_32x32x16_bf16 v[56:71], v[40:43], v[192:195], v[56:71]
    s_add_u32 m0, s42, 0
    s_nop 0
    buffer_load_dwordx4 v4, s[8:11], s39 offen lds
    v_mfma_f32_32x32x16_bf16 v[72:87], v[44:47], v[192:195], v[72:87]
    s_add_u32 m0, s42, 1024
    s_nop 0
    buffer_load_dwordx4 v5, s[8:11], s39 offen lds
    v_mfma_f32_32x32x16_bf16 v[56:71], v[48:51], v[196:199], v[56:71]
    s_add_u32 m0, s42, 2048
    s_nop 0
    buffer_load_dwordx4 v6, s[8:11], s39 offen lds
    v_mfma_f32_32x32x16_bf16 v[72:87], v[52:55], v[196:199], v[72:87]
    s_add_u32 m0, s42, 3072
    s_nop 0
    buffer_load_dwordx4 v7, s[8:11], s39 offen lds
    s_add_u32 s39, s39, 128
    s_cmp_eq_u32 s39, 1280
    s_cselect_b32 s39, 0, s39
    s_waitcnt vmcnt(12)
    s_barrier
    ds_read_b128 v[200:203], v10 offset:16384
    ds_read_b64_tr_b16 v[24:25], v14 offset:24576
    ds_read_b64_tr_b16 v[26:27], v14 offset:25088
    ds_read_b64_tr_b16 v[28:29], v15 offset:24576
    ds_read_b64_tr_b16 v[30:31], v15 offset:25088
    ds_read_b128 v[204:207], v11 offset:16384
    ds_read_b64_tr_b16 v[32:33], v14 offset:26624
    ds_read_b64_tr_b16 v[34:35], v14 offset:27136
    ds_read_b64_tr_b16 v[36:37], v15 offset:26624
    ds_read_b64_tr_b16 v[38:39], v15 offset:27136
    s_add_u32 s4, s41, 0
    s_cmp_ge_u32 s4, 2457600
    s_cselect_b32 s5, 2457600, 0
    s_sub_u32 s4, s4, s5
    s_add_u32 s4, s4, s38
    s_add_u32 m0, s43, 16384
    s_nop 0
    buffer_load_dwordx4 v8, s[12:15], s4 offen lds
    ds_read_b128 v[208:211], v12 offset:16384
    ds_read_b64_tr_b16 v[40:41], v14 offset:28672
    ds_read_b64_tr_b16 v[42:43], v14 offset:29184
    ds_read_b64_tr_b16 v[44:45], v15 offset:28672
    ds_read_b64_tr_b16 v[46:47], v15 offset:29184
    s_waitcnt lgkmcnt(10)
    v_mfma_f32_32x32x16_bf16 v[56:71], v[24:27], v[200:203], v[56:71]
    ds_read_b128 v[212:215], v13 offset:16384
    ds_read_b64_tr_b16 v[48:49], v14 offset:30720
    ds_read_b64_tr_b16 v[50:51], v14 offset:31232
    v_mfma_f32_32x32x16_bf16 v[72:87], v[28:31], v[200:203], v[72:87]
    ds_read_b64_tr_b16 v[52:53], v15 offset:30720
    ds_read_b64_tr_b16 v[54:55], v15 offset:31232
    s_add_u32 m0, s43, 17408
    s_nop 0
    buffer_load_dwordx4 v9, s[12:15], s4 offen lds
    s_waitcnt lgkmcnt(10)
    v_mfma_f32_32x32x16_bf16 v[56:71], v[32:35], v[204:207], v[56:71]
    v_mfma_f32_32x32x16_bf16 v[72:87], v[36:39], v[204:207], v[72:87]
    s_waitcnt lgkmcnt(0)
    v_mfma_f32_32x32x16_bf16 v[56:71], v[40:43], v[208:211], v[56:71]
    v_mov_b32 v4, 0x3f803f80
    v_mfma_f32_32x32x16_bf16 v[72:87], v[44:47], v[208:211], v[72:87]
    v_mov_b32 v5, 0x3f803f80
    v_mfma_f32_32x32x16_bf16 v[56:71], v[48:51], v[212:215], v[56:71]
    v_mov_b32 v6, 0x3f803f80
    v_mfma_f32_32x32x16_bf16 v[72:87], v[52:55], v[212:215], v[72:87]
    v_mov_b32 v7, 0x3f803f80
    s_waitcnt vmcnt(8)
    s_barrier
    ds_read_b128 v[216:219], v10 offset:32768
    ds_read_b64_tr_b16 v[24:25], v14 offset:0
    ds_read_b64_tr_b16 v[26:27], v14 offset:512
    ds_read_b64_tr_b16 v[28:29], v15 offset:0
    ds_read_b64_tr_b16 v[30:31], v15 offset:512
    ds_read_b128 v[220:223], v11 offset:32768
    ds_read_b64_tr_b16 v[32:33], v14 offset:2048
    ds_read_b64_tr_b16 v[34:35], v14 offset:2560
    ds_read_b64_tr_b16 v[36:37], v15 offset:2048
    ds_read_b64_tr_b16 v[38:39], v15 offset:2560
    s_add_u32 s4, s41, 245760
    s_cmp_ge_u32 s4, 2457600
    s_cselect_b32 s5, 2457600, 0
    s_sub_u32 s4, s4, s5
    s_add_u32 s4, s4, s38
    s_add_u32 m0, s43, 24576
    s_nop 0
    buffer_load_dwordx4 v8, s[12:15], s4 offen lds
    ds_read_b128 v[224:227], v12 offset:32768
    ds_read_b64_tr_b16 v[40:41], v14 offset:4096
    ds_read_b64_tr_b16 v[42:43], v14 offset:4608
    ds_read_b64_tr_b16 v[44:45], v15 offset:4096
    ds_read_b64_tr_b16 v[46:47], v15 offset:4608
    s_waitcnt lgkmcnt(10)
    v_mfma_f32_32x32x16_bf16 v[56:71], v[24:27], v[216:219], v[56:71]
    ds_read_b128 v[228:231], v13 offset:32768
    ds_read_b64_tr_b16 v[48:49], v14 offset:6144
    ds_read_b64_tr_b16 v[50:51], v14 offset:6656
    v_mfma_f32_32x32x16_bf16 v[72:87], v[28:31], v[216:219], v[72:87]
    ds_read_b64_tr_b16 v[52:53], v15 offset:6144
    ds_read_b64_tr_b16 v[54:55], v15 offset:6656
    s_add_u32 m0, s43, 25600
    s_nop 0
    buffer_load_dwordx4 v9, s[12:15], s4 offen lds
    s_waitcnt lgkmcnt(10)
    v_mfma_f32_32x32x16_bf16 v[56:71], v[32:35], v[220:223], v[56:71]
    s_add_u32 s4, s41, 491520
    s_cmp_ge_u32 s4, 2457600
    s_cselect_b32 s5, 2457600, 0
    s_sub_u32 s4, s4, s5
    s_add_u32 s4, s4, s38
    s_add_u32 m0, s43, 49152
    s_nop 0
    buffer_load_dwordx4 v8, s[12:15], s4 offen lds
    s_add_u32 m0, s43, 50176
    s_nop 0
    buffer_load_dwordx4 v9, s[12:15], s4 offen lds
    v_mfma_f32_32x32x16_bf16 v[72:87], v[36:39], v[220:223], v[72:87]
    s_add_u32 s4, s41, 737280
    s_cmp_ge_u32 s4, 2457600
    s_cselect_b32 s5, 2457600, 0
    s_sub_u32 s4, s4, s5
    s_add_u32 s4, s4, s38
    s_add_u32 m0, s43, 57344
    s_nop 0
    buffer_load_dwordx4 v8, s[12:15], s4 offen lds
    s_add_u32 m0, s43, 58368
    s_nop 0
    buffer_load_dwordx4 v9, s[12:15], s4 offen lds
    s_waitcnt lgkmcnt(0)
    v_mfma_f32_32x32x16_bf16 v[56:71], v[40:43], v[224:227], v[56:71]
    v_mfma_f32_32x32x16_bf16 v[72:87], v[44:47], v[224:227], v[72:87]
    v_mfma_f32_32x32x16_bf16 v[56:71], v[48:51], v[228:231], v[56:71]
    v_mfma_f32_32x32x16_bf16 v[72:87], v[52:55], v[228:231], v[72:87]
    s_waitcnt vmcnt(8)
    s_barrier
    ds_read_b128 v[232:235], v10 offset:0
    ds_read_b64_tr_b16 v[24:25], v14 offset:8192
    ds_read_b64_tr_b16 v[26:27], v14 offset:8704
    ds_read_b64_tr_b16 v[28:29], v15 offset:8192
    ds_read_b64_tr_b16 v[30:31], v15 offset:8704
    ds_read_b128 v[236:239], v11 offset:0
    ds_read_b64_tr_b16 v[32:33], v14 offset:10240
    ds_read_b64_tr_b16 v[34:35], v14 offset:10752
    ds_read_b64_tr_b16 v[36:37], v15 offset:10240
    ds_read_b64_tr_b16 v[38:39], v15 offset:10752
    s_add_u32 s4, s41, 983040
    s_cmp_ge_u32 s4, 2457600
    s_cselect_b32 s5, 2457600, 0
    s_sub_u32 s4, s4, s5
    s_add_u32 s4, s4, s38
    s_add_u32 m0, s43, 0
    s_nop 0
    buffer_load_dwordx4 v8, s[12:15], s4 offen lds
    ds_read_b128 v[240:243], v12 offset:0
    ds_read_b64_tr_b16 v[40:41], v14 offset:12288
    ds_read_b64_tr_b16 v[42:43], v14 offset:12800
    ds_read_b64_tr_b16 v[44:45], v15 offset:12288
    ds_read_b64_tr_b16 v[46:47], v15 offset:12800
    s_waitcnt lgkmcnt(10)
    v_mfma_f32_32x32x16_bf16 v[56:71], v[24:27], v[232:235], v[56:71]
    ds_read_b128 v[244:247], v13 offset:0
    ds_read_b64_tr_b16 v[48:49], v14 offset:14336
    ds_read_b64_tr_b16 v[50:51], v14 offset:14848
    ds_read_b64_tr_b16 v[52:53], v15 offset:14336
    ds_read_b64_tr_b16 v[54:55], v15 offset:14848
    s_add_u32 m0, s43, 1024
    s_nop 0
    buffer_load_dwordx4 v9, s[12:15], s4 offen lds
    s_waitcnt lgkmcnt(10)
    v_mfma_f32_32x32x16_bf16 v[56:71], v[32:35], v[236:239], v[56:71]
    s_add_u32 s4, s41, 1228800
    s_cmp_ge_u32 s4, 2457600
    s_cselect_b32 s5, 2457600, 0
    s_sub_u32 s4, s4, s5
    s_add_u32 s4, s4, s38
    s_add_u32 m0, s43, 65536
    s_nop 0
    buffer_load_dwordx4 v8, s[12:15], s4 offen lds
    s_add_u32 m0, s43, 66560
    s_nop 0
    buffer_load_dwordx4 v9, s[12:15], s4 offen lds
    s_add_u32 s4, s41, 1474560
    s_cmp_ge_u32 s4, 2457600
    s_cselect_b32 s5, 2457600, 0
    s_sub_u32 s4, s4, s5
    s_add_u32 s4, s4, s38
    s_add_u32 m0, s43, 73728
    s_nop 0
    buffer_load_dwordx4 v8, s[12:15], s4 offen lds
    s_add_u32 m0, s43, 74752
    s_nop 0
    buffer_load_dwordx4 v9, s[12:15], s4 offen lds
    s_waitcnt lgkmcnt(0)
    v_mfma_f32_32x32x16_bf16 v[56:71], v[40:43], v[240:243], v[56:71]
    s_waitcnt vmcnt(12)
    s_barrier
    v_mfma_f32_32x32x16_bf16 v[56:71], v[48:51], v[244:247], v[56:71]
    v_mfma_f32_32x32x16_bf16 v[72:87], v[28:31], v[232:235], v[72:87]
    s_mov_b32 exec_hi, 0
    buffer_store_dwordx4 v[4:7], v255, s[16:19], s24 offen offset:2048 sc1
    s_mov_b32 exec_hi, -1
    buffer_load_dword v2, off, s[28:31], 0 offset:128 sc1
    s_nop 5
    v_mfma_f32_32x32x16_bf16 v[72:87], v[36:39], v[236:239], v[72:87]
    v_mul_f32 v56, s6, v56
    v_mul_f32 v57, s6, v57
    v_mul_f32 v58, s6, v58
    v_mul_f32 v59, s6, v59
    v_mul_f32 v60, s6, v60
    v_mul_f32 v61, s6, v61
    v_mul_f32 v62, s6, v62
    v_mul_f32 v63, s6, v63
    v_cvt_pk_bf16_f32 v56, v56, v57
    v_mfma_f32_32x32x16_bf16 v[72:87], v[44:47], v[240:243], v[72:87]
    v_cvt_pk_bf16_f32 v57, v58, v59
    v_cvt_pk_bf16_f32 v58, v60, v61
    v_cvt_pk_bf16_f32 v59, v62, v63
    buffer_store_dwordx4 v[56:59], v22, s[16:19], s20 offen sc1
    v_mul_f32 v64, s6, v64
    v_mul_f32 v65, s6, v65
    v_mul_f32 v66, s6, v66
    v_mul_f32 v67, s6, v67
    v_mul_f32 v68, s6, v68
    v_mfma_f32_32x32x16_bf16 v[72:87], v[52:55], v[244:247], v[72:87]
    v_mul_f32 v69, s6, v69
    v_mul_f32 v70, s6, v70
    v_mul_f32 v71, s6, v71
    v_cvt_pk_bf16_f32 v60, v64, v65
    v_cvt_pk_bf16_f32 v61, v66, v67
    v_cvt_pk_bf16_f32 v62, v68, v69
    v_cvt_pk_bf16_f32 v63, v70, v71
    buffer_store_dwordx4 v[60:63], v22, s[16:19], s21 offen sc1
    s_branch g1_p2_3
g1_p1v_7:
    s_sub_u32 s3, s37, 20
    s_lshr_b32 s4, s3, 1
    s_mul_i32 s4, s4, 557056
    s_lshl2_add_u32 s5, s36, s32
    s_mul_i32 s5, s5, 8704
    s_add_u32 s4, s4, s5
    s_add_u32 s4, s4, 5242880
    s_and_b32 s3, s3, 1
    s_mov_b32 s24, s4
    s_lshl_b32 s3, s3, 10
    s_add_u32 s20, s4, s3
    s_add_u32 s21, s20, 2176
    s_add_u32 s22, s20, 512
    s_add_u32 s23, s20, 2688
    s_lshl4_add_u32 s3, s37, s36
    s_lshl_b32 s3, s3, 7
    s_add_u32 s3, s3, s32
    s_add_u32 s25, s3, 15990784
    s_lshl_b32 s3, s32, 28
    s_or_b32 s26, s25, s3
    s_mov_b32 s62, s25
    v_mov_b32 v22, v23
    s_mov_b32 s6, 1.0
    s_waitcnt vmcnt(12)
    s_barrier
    s_setprio 2
    ds_read_b128 v[88:91], v10 offset:0
    ds_read_b64_tr_b16 v[24:25], v18 offset:0
    ds_read_b64_tr_b16 v[26:27], v18 offset:512
    ds_read_b64_tr_b16 v[28:29], v19 offset:0
    ds_read_b64_tr_b16 v[30:31], v19 offset:512
    ds_read_b128 v[92:95], v11 offset:0
    ds_read_b64_tr_b16 v[32:33], v18 offset:2048
    ds_read_b64_tr_b16 v[34:35], v18 offset:2560
    ds_read_b64_tr_b16 v[36:37], v19 offset:2048
    ds_read_b64_tr_b16 v[38:39], v19 offset:2560
    s_add_u32 s4, s41, 737280
    s_cmp_ge_u32 s4, 2457600
    s_cselect_b32 s5, 2457600, 0
    s_sub_u32 s4, s4, s5
    s_add_u32 s4, s4, s40
    s_add_u32 m0, s43, 24576
    s_nop 0
    buffer_load_dwordx4 v8, s[12:15], s4 offen lds
    ds_read_b128 v[96:99], v12 offset:0
    ds_read_b64_tr_b16 v[40:41], v18 offset:4096
    ds_read_b64_tr_b16 v[42:43], v18 offset:4608
    ds_read_b64_tr_b16 v[44:45], v19 offset:4096
    ds_read_b64_tr_b16 v[46:47], v19 offset:4608
    s_waitcnt lgkmcnt(10)
    v_mfma_f32_32x32x16_bf16 v[56:71], v[88:91], v[24:27], 0
    ds_read_b128 v[100:103], v13 offset:0
    ds_read_b64_tr_b16 v[48:49], v18 offset:6144
    ds_read_b64_tr_b16 v[50:51], v18 offset:6656
    v_mfma_f32_32x32x16_bf16 v[72:87], v[88:91], v[28:31], 0
    ds_read_b64_tr_b16 v[52:53], v19 offset:6144
    ds_read_b64_tr_b16 v[54:55], v19 offset:6656
    s_add_u32 m0, s43, 25600
    s_nop 0
    buffer_load_dwordx4 v9, s[12:15], s4 offen lds
    s_waitcnt lgkmcnt(10)
    v_mfma_f32_32x32x16_bf16 v[56:71], v[92:95], v[32:35], v[56:71]
    v_mfma_f32_32x32x16_bf16 v[72:87], v[92:95], v[36:39], v[72:87]
    s_waitcnt lgkmcnt(0)
    v_mfma_f32_32x32x16_bf16 v[56:71], v[96:99], v[40:43], v[56:71]
    s_add_u32 m0, s42, 0
    s_nop 0
    buffer_load_dwordx4 v4, s[8:11], s39 offen lds
    v_mfma_f32_32x32x16_bf16 v[72:87], v[96:99], v[44:47], v[72:87]
    s_add_u32 m0, s42, 1024
    s_nop 0
    buffer_load_dwordx4 v5, s[8:11], s39 offen lds
    v_mfma_f32_32x32x16_bf16 v[56:71], v[100:103], v[48:51], v[56:71]
    s_add_u32 m0, s42, 2048
    s_nop 0
    buffer_load_dwordx4 v6, s[8:11], s39 offen lds
    v_mfma_f32_32x32x16_bf16 v[72:87], v[100:103], v[52:55], v[72:87]
    s_add_u32 m0, s42, 3072
    s_nop 0
    buffer_load_dwordx4 v7, s[8:11], s39 offen lds
    s_add_u32 s39, s39, 128
    s_cmp_eq_u32 s39, 1280
    s_cselect_b32 s39, 0, s39
    s_waitcnt vmcnt(12)
    s_barrier
    ds_read_b128 v[104:107], v10 offset:16384
    ds_read_b64_tr_b16 v[24:25], v18 offset:8192
    ds_read_b64_tr_b16 v[26:27], v18 offset:8704
    ds_read_b64_tr_b16 v[28:29], v19 offset:8192
    ds_read_b64_tr_b16 v[30:31], v19 offset:8704
    ds_read_b128 v[108:111], v11 offset:16384
    ds_read_b64_tr_b16 v[32:33], v18 offset:10240
    ds_read_b64_tr_b16 v[34:35], v18 offset:10752
    ds_read_b64_tr_b16 v[36:37], v19 offset:10240
    ds_read_b64_tr_b16 v[38:39], v19 offset:10752
    s_add_u32 s4, s41, 983040
    s_cmp_ge_u32 s4, 2457600
    s_cselect_b32 s5, 2457600, 0
    s_sub_u32 s4, s4, s5
    s_add_u32 s4, s4, s40
    s_add_u32 m0, s43, 0
    s_nop 0
    buffer_load_dwordx4 v8, s[12:15], s4 offen lds
    ds_read_b128 v[112:115], v12 offset:16384
    ds_read_b64_tr_b16 v[40:41], v18 offset:12288
    ds_read_b64_tr_b16 v[42:43], v18 offset:12800
    ds_read_b64_tr_b16 v[44:45], v19 offset:12288
    ds_read_b64_tr_b16 v[46:47], v19 offset:12800
    s_waitcnt lgkmcnt(10)
    v_mfma_f32_32x32x16_bf16 v[56:71], v[104:107], v[24:27], v[56:71]
    ds_read_b128 v[116:119], v13 offset:16384
    ds_read_b64_tr_b16 v[48:49], v18 offset:14336
    ds_read_b64_tr_b16 v[50:51], v18 offset:14848
    v_mfma_f32_32x32x16_bf16 v[72:87], v[104:107], v[28:31], v[72:87]
    ds_read_b64_tr_b16 v[52:53], v19 offset:14336
    ds_read_b64_tr_b16 v[54:55], v19 offset:14848
    s_add_u32 m0, s43, 1024
    s_nop 0
    buffer_load_dwordx4 v9, s[12:15], s4 offen lds
    s_waitcnt lgkmcnt(10)
    v_mfma_f32_32x32x16_bf16 v[56:71], v[108:111], v[32:35], v[56:71]
    v_mfma_f32_32x32x16_bf16 v[72:87], v[108:111], v[36:39], v[72:87]
    s_waitcnt lgkmcnt(0)
    v_mfma_f32_32x32x16_bf16 v[56:71], v[112:115], v[40:43], v[56:71]
    s_add_u32 m0, s42, 16384
    s_nop 0
    buffer_load_dwordx4 v4, s[8:11], s39 offen lds
    v_mfma_f32_32x32x16_bf16 v[72:87], v[112:115], v[44:47], v[72:87]
    s_add_u32 m0, s42, 17408
    s_nop 0
    buffer_load_dwordx4 v5, s[8:11], s39 offen lds
    v_mfma_f32_32x32x16_bf16 v[56:71], v[116:119], v[48:51], v[56:71]
    s_add_u32 m0, s42, 18432
    s_nop 0
    buffer_load_dwordx4 v6, s[8:11], s39 offen lds
    v_mfma_f32_32x32x16_bf16 v[72:87], v[116:119], v[52:55], v[72:87]
    s_add_u32 m0, s42, 19456
    s_nop 0
    buffer_load_dwordx4 v7, s[8:11], s39 offen lds
    s_add_u32 s39, s39, 128
    s_cmp_eq_u32 s39, 1280
    s_cselect_b32 s39, 0, s39
    s_waitcnt vmcnt(12)
    s_barrier
    ds_read_b128 v[120:123], v10 offset:32768
    ds_read_b64_tr_b16 v[24:25], v18 offset:16384
    ds_read_b64_tr_b16 v[26:27], v18 offset:16896
    ds_read_b64_tr_b16 v[28:29], v19 offset:16384
    ds_read_b64_tr_b16 v[30:31], v19 offset:16896
    ds_read_b128 v[124:127], v11 offset:32768
    ds_read_b64_tr_b16 v[32:33], v18 offset:18432
    ds_read_b64_tr_b16 v[34:35], v18 offset:18944
    ds_read_b64_tr_b16 v[36:37], v19 offset:18432
    ds_read_b64_tr_b16 v[38:39], v19 offset:18944
    s_add_u32 s4, s41, 1228800
    s_cmp_ge_u32 s4, 2457600
    s_cselect_b32 s5, 2457600, 0
    s_sub_u32 s4, s4, s5
    s_add_u32 s4, s4, s40
    s_add_u32 m0, s43, 8192
    s_nop 0
    buffer_load_dwordx4 v8, s[12:15], s4 offen lds
    ds_read_b128 v[128:131], v12 offset:32768
    ds_read_b64_tr_b16 v[40:41], v18 offset:20480
    ds_read_b64_tr_b16 v[42:43], v18 offset:20992
    ds_read_b64_tr_b16 v[44:45], v19 offset:20480
    ds_read_b64_tr_b16 v[46:47], v19 offset:20992
    s_waitcnt lgkmcnt(10)
    v_mfma_f32_32x32x16_bf16 v[56:71], v[120:123], v[24:27], v[56:71]
    ds_read_b128 v[132:135], v13 offset:32768
    ds_read_b64_tr_b16 v[48:49], v18 offset:22528
    ds_read_b64_tr_b16 v[50:51], v18 offset:23040
    v_mfma_f32_32x32x16_bf16 v[72:87], v[120:123], v[28:31], v[72:87]
    ds_read_b64_tr_b16 v[52:53], v19 offset:22528
    ds_read_b64_tr_b16 v[54:55], v19 offset:23040
    s_add_u32 m0, s43, 9216
    s_nop 0
    buffer_load_dwordx4 v9, s[12:15], s4 offen lds
    s_waitcnt lgkmcnt(10)
    v_mfma_f32_32x32x16_bf16 v[56:71], v[124:127], v[32:35], v[56:71]
    v_mfma_f32_32x32x16_bf16 v[72:87], v[124:127], v[36:39], v[72:87]
    s_waitcnt lgkmcnt(0)
    v_mfma_f32_32x32x16_bf16 v[56:71], v[128:131], v[40:43], v[56:71]
    s_add_u32 m0, s42, 32768
    s_nop 0
    buffer_load_dwordx4 v4, s[8:11], s39 offen lds
    v_mfma_f32_32x32x16_bf16 v[72:87], v[128:131], v[44:47], v[72:87]
    s_add_u32 m0, s42, 33792
    s_nop 0
    buffer_load_dwordx4 v5, s[8:11], s39 offen lds
    v_mfma_f32_32x32x16_bf16 v[56:71], v[132:135], v[48:51], v[56:71]
    s_add_u32 m0, s42, 34816
    s_nop 0
    buffer_load_dwordx4 v6, s[8:11], s39 offen lds
    v_mfma_f32_32x32x16_bf16 v[72:87], v[132:135], v[52:55], v[72:87]
    s_add_u32 m0, s42, 35840
    s_nop 0
    buffer_load_dwordx4 v7, s[8:11], s39 offen lds
    s_add_u32 s39, s39, 128
    s_cmp_eq_u32 s39, 1280
    s_cselect_b32 s39, 0, s39
    s_waitcnt vmcnt(12)
    s_barrier
    ds_read_b128 v[136:139], v10 offset:0
    ds_read_b64_tr_b16 v[24:25], v18 offset:24576
    ds_read_b64_tr_b16 v[26:27], v18 offset:25088
    ds_read_b64_tr_b16 v[28:29], v19 offset:24576
    ds_read_b64_tr_b16 v[30:31], v19 offset:25088
    ds_read_b128 v[140:143], v11 offset:0
    ds_read_b64_tr_b16 v[32:33], v18 offset:26624
    ds_read_b64_tr_b16 v[34:35], v18 offset:27136
    ds_read_b64_tr_b16 v[36:37], v19 offset:26624
    ds_read_b64_tr_b16 v[38:39], v19 offset:27136
    s_add_u32 s4, s41, 1474560
    s_cmp_ge_u32 s4, 2457600
    s_cselect_b32 s5, 2457600, 0
    s_sub_u32 s4, s4, s5
    s_add_u32 s4, s4, s40
    s_add_u32 m0, s43, 16384
    s_nop 0
    buffer_load_dwordx4 v8, s[12:15], s4 offen lds
    ds_read_b128 v[144:147], v12 offset:0
    ds_read_b64_tr_b16 v[40:41], v18 offset:28672
    ds_read_b64_tr_b16 v[42:43], v18 offset:29184
    ds_read_b64_tr_b16 v[44:45], v19 offset:28672
    ds_read_b64_tr_b16 v[46:47], v19 offset:29184
    s_waitcnt lgkmcnt(10)
    v_mfma_f32_32x32x16_bf16 v[56:71], v[136:139], v[24:27], v[56:71]
    ds_read_b128 v[148:151], v13 offset:0
    ds_read_b64_tr_b16 v[48:49], v18 offset:30720
    ds_read_b64_tr_b16 v[50:51], v18 offset:31232
    v_mfma_f32_32x32x16_bf16 v[72:87], v[136:139], v[28:31], v[72:87]
    ds_read_b64_tr_b16 v[52:53], v19 offset:30720
    ds_read_b64_tr_b16 v[54:55], v19 offset:31232
    s_add_u32 m0, s43, 17408
    s_nop 0
    buffer_load_dwordx4 v9, s[12:15], s4 offen lds
    s_waitcnt lgkmcnt(10)
    v_mfma_f32_32x32x16_bf16 v[56:71], v[140:143], v[32:35], v[56:71]
    v_mfma_f32_32x32x16_bf16 v[72:87], v[140:143], v[36:39], v[72:87]
    s_waitcnt lgkmcnt(0)
    v_mfma_f32_32x32x16_bf16 v[56:71], v[144:147], v[40:43], v[56:71]
    s_add_u32 m0, s42, 0
    s_nop 0
    buffer_load_dwordx4 v4, s[8:11], s39 offen lds
    v_mfma_f32_32x32x16_bf16 v[72:87], v[144:147], v[44:47], v[72:87]
    s_add_u32 m0, s42, 1024
    s_nop 0
    buffer_load_dwordx4 v5, s[8:11], s39 offen lds
    v_mfma_f32_32x32x16_bf16 v[56:71], v[148:151], v[48:51], v[56:71]
    s_add_u32 m0, s42, 2048
    s_nop 0
    buffer_load_dwordx4 v6, s[8:11], s39 offen lds
    v_mfma_f32_32x32x16_bf16 v[72:87], v[148:151], v[52:55], v[72:87]
    s_add_u32 m0, s42, 3072
    s_nop 0
    buffer_load_dwordx4 v7, s[8:11], s39 offen lds
    s_add_u32 s39, s39, 128
    s_cmp_eq_u32 s39, 1280
    s_cselect_b32 s39, 0, s39
    v_mov_b32 v249, 16
    s_mov_b64 exec, 1
    buffer_store_dword v249, v248, s[16:19], 0 offen sc1
    s_mov_b64 exec, -1
    v_mov_b32 v249, 17
    s_waitcnt vmcnt(13)
    s_barrier
    ds_read_b128 v[152:155], v10 offset:16384
    ds_read_b64_tr_b16 v[24:25], v18 offset:0
    ds_read_b64_tr_b16 v[26:27], v18 offset:512
    ds_read_b64_tr_b16 v[28:29], v19 offset:0
    ds_read_b64_tr_b16 v[30:31], v19 offset:512
    ds_read_b128 v[156:159], v11 offset:16384
    ds_read_b64_tr_b16 v[32:33], v18 offset:2048
    ds_read_b64_tr_b16 v[34:35], v18 offset:2560
    ds_read_b64_tr_b16 v[36:37], v19 offset:2048
    ds_read_b64_tr_b16 v[38:39], v19 offset:2560
    s_add_u32 s4, s41, 1720320
    s_cmp_ge_u32 s4, 2457600
    s_cselect_b32 s5, 2457600, 0
    s_sub_u32 s4, s4, s5
    s_add_u32 s4, s4, s40
    s_add_u32 m0, s43, 24576
    s_nop 0
    buffer_load_dwordx4 v8, s[12:15], s4 offen lds
    ds_read_b128 v[160:163], v12 offset:16384
    ds_read_b64_tr_b16 v[40:41], v18 offset:4096
    ds_read_b64_tr_b16 v[42:43], v18 offset:4608
    ds_read_b64_tr_b16 v[44:45], v19 offset:4096
    ds_read_b64_tr_b16 v[46:47], v19 offset:4608
    s_waitcnt lgkmcnt(10)
    v_mfma_f32_32x32x16_bf16 v[56:71], v[152:155], v[24:27], v[56:71]
    ds_read_b128 v[164:167], v13 offset:16384
    ds_read_b64_tr_b16 v[48:49], v18 offset:6144
    ds_read_b64_tr_b16 v[50:51], v18 offset:6656
    v_mfma_f32_32x32x16_bf16 v[72:87], v[152:155], v[28:31], v[72:87]
    ds_read_b64_tr_b16 v[52:53], v19 offset:6144
    ds_read_b64_tr_b16 v[54:55], v19 offset:6656
    s_add_u32 m0, s43, 25600
    s_nop 0
    buffer_load_dwordx4 v9, s[12:15], s4 offen lds
    s_waitcnt lgkmcnt(10)
    v_mfma_f32_32x32x16_bf16 v[56:71], v[156:159], v[32:35], v[56:71]
    v_mfma_f32_32x32x16_bf16 v[72:87], v[156:159], v[36:39], v[72:87]
    s_waitcnt lgkmcnt(0)
    v_mfma_f32_32x32x16_bf16 v[56:71], v[160:163], v[40:43], v[56:71]
    s_add_u32 m0, s42, 16384
    s_nop 0
    buffer_load_dwordx4 v4, s[8:11], s39 offen lds
    v_mfma_f32_32x32x16_bf16 v[72:87], v[160:163], v[44:47], v[72:87]
    s_add_u32 m0, s42, 17408
    s_nop 0
    buffer_load_dwordx4 v5, s[8:11], s39 offen lds
    v_mfma_f32_32x32x16_bf16 v[56:71], v[164:167], v[48:51], v[56:71]
    s_add_u32 m0, s42, 18432
    s_nop 0
    buffer_load_dwordx4 v6, s[8:11], s39 offen lds
    v_mfma_f32_32x32x16_bf16 v[72:87], v[164:167], v[52:55], v[72:87]
    s_add_u32 m0, s42, 19456
    s_nop 0
    buffer_load_dwordx4 v7, s[8:11], s39 offen lds
    s_add_u32 s39, s39, 128
    s_cmp_eq_u32 s39, 1280
    s_cselect_b32 s39, 0, s39
    s_waitcnt vmcnt(13)
    s_barrier
    ds_read_b128 v[168:171], v10 offset:32768
    ds_read_b64_tr_b16 v[24:25], v18 offset:8192
    ds_read_b64_tr_b16 v[26:27], v18 offset:8704
    ds_read_b64_tr_b16 v[28:29], v19 offset:8192
    ds_read_b64_tr_b16 v[30:31], v19 offset:8704
    ds_read_b128 v[172:175], v11 offset:32768
    ds_read_b64_tr_b16 v[32:33], v18 offset:10240
    ds_read_b64_tr_b16 v[34:35], v18 offset:10752
    ds_read_b64_tr_b16 v[36:37], v19 offset:10240
    ds_read_b64_tr_b16 v[38:39], v19 offset:10752
    s_add_u32 s4, s41, 1966080
    s_cmp_ge_u32 s4, 2457600
    s_cselect_b32 s5, 2457600, 0
    s_sub_u32 s4, s4, s5
    s_add_u32 s4, s4, s40
    s_add_u32 m0, s43, 0
    s_nop 0
    buffer_load_dwordx4 v8, s[12:15], s4 offen lds
    ds_read_b128 v[176:179], v12 offset:32768
    ds_read_b64_tr_b16 v[40:41], v18 offset:12288
    ds_read_b64_tr_b16 v[42:43], v18 offset:12800
    ds_read_b64_tr_b16 v[44:45], v19 offset:12288
    ds_read_b64_tr_b16 v[46:47], v19 offset:12800
    s_waitcnt lgkmcnt(10)
    v_mfma_f32_32x32x16_bf16 v[56:71], v[168:171], v[24:27], v[56:71]
    ds_read_b128 v[180:183], v13 offset:32768
    ds_read_b64_tr_b16 v[48:49], v18 offset:14336
    ds_read_b64_tr_b16 v[50:51], v18 offset:14848
    v_mfma_f32_32x32x16_bf16 v[72:87], v[168:171], v[28:31], v[72:87]
    ds_read_b64_tr_b16 v[52:53], v19 offset:14336
    ds_read_b64_tr_b16 v[54:55], v19 offset:14848
    s_add_u32 m0, s43, 1024
    s_nop 0
    buffer_load_dwordx4 v9, s[12:15], s4 offen lds
    s_waitcnt lgkmcnt(10)
    v_mfma_f32_32x32x16_bf16 v[56:71], v[172:175], v[32:35], v[56:71]
    v_mfma_f32_32x32x16_bf16 v[72:87], v[172:175], v[36:39], v[72:87]
    s_waitcnt lgkmcnt(0)
    v_mfma_f32_32x32x16_bf16 v[56:71], v[176:179], v[40:43], v[56:71]
    s_add_u32 m0, s42, 32768
    s_nop 0
    buffer_load_dwordx4 v4, s[8:11], s39 offen lds
    v_mfma_f32_32x32x16_bf16 v[72:87], v[176:179], v[44:47], v[72:87]
    s_add_u32 m0, s42, 33792
    s_nop 0
    buffer_load_dwordx4 v5, s[8:11], s39 offen lds
    v_mfma_f32_32x32x16_bf16 v[56:71], v[180:183], v[48:51], v[56:71]
    s_add_u32 m0, s42, 34816
    s_nop 0
    buffer_load_dwordx4 v6, s[8:11], s39 offen lds
    v_mfma_f32_32x32x16_bf16 v[72:87], v[180:183], v[52:55], v[72:87]
    s_add_u32 m0, s42, 35840
    s_nop 0
    buffer_load_dwordx4 v7, s[8:11], s39 offen lds
    s_add_u32 s39, s39, 128
    s_cmp_eq_u32 s39, 1280
    s_cselect_b32 s39, 0, s39
    s_waitcnt vmcnt(13)
    s_barrier
    ds_read_b128 v[184:187], v10 offset:0
    ds_read_b64_tr_b16 v[24:25], v18 offset:16384
    ds_read_b64_tr_b16 v[26:27], v18 offset:16896
    ds_read_b64_tr_b16 v[28:29], v19 offset:16384
    ds_read_b64_tr_b16 v[30:31], v19 offset:16896
    ds_read_b128 v[188:191], v11 offset:0
    ds_read_b64_tr_b16 v[32:33], v18 offset:18432
    ds_read_b64_tr_b16 v[34:35], v18 offset:18944
    ds_read_b64_tr_b16 v[36:37], v19 offset:18432
    ds_read_b64_tr_b16 v[38:39], v19 offset:18944
    s_add_u32 s4, s41, 2211840
    s_cmp_ge_u32 s4, 2457600
    s_cselect_b32 s5, 2457600, 0
    s_sub_u32 s4, s4, s5
    s_add_u32 s4, s4, s40
    s_add_u32 m0, s43, 8192
    s_nop 0
    buffer_load_dwordx4 v8, s[12:15], s4 offen lds
    ds_read_b128 v[192:195], v12 offset:0
    ds_read_b64_tr_b16 v[40:41], v18 offset:20480
    ds_read_b64_tr_b16 v[42:43], v18 offset:20992
    ds_read_b64_tr_b16 v[44:45], v19 offset:20480
    ds_read_b64_tr_b16 v[46:47], v19 offset:20992
    s_waitcnt lgkmcnt(10)
    v_mfma_f32_32x32x16_bf16 v[56:71], v[184:187], v[24:27], v[56:71]
    ds_read_b128 v[196:199], v13 offset:0
    ds_read_b64_tr_b16 v[48:49], v18 offset:22528
    ds_read_b64_tr_b16 v[50:51], v18 offset:23040
    v_mfma_f32_32x32x16_bf16 v[72:87], v[184:187], v[28:31], v[72:87]
    ds_read_b64_tr_b16 v[52:53], v19 offset:22528
    ds_read_b64_tr_b16 v[54:55], v19 offset:23040
    s_add_u32 m0, s43, 9216
    s_nop 0
    buffer_load_dwordx4 v9, s[12:15], s4 offen lds
    s_waitcnt lgkmcnt(10)
    v_mfma_f32_32x32x16_bf16 v[56:71], v[188:191], v[32:35], v[56:71]
    v_mfma_f32_32x32x16_bf16 v[72:87], v[188:191], v[36:39], v[72:87]
    s_waitcnt lgkmcnt(0)
    v_mfma_f32_32x32x16_bf16 v[56:71], v[192:195], v[40:43], v[56:71]
    s_add_u32 m0, s42, 0
    s_nop 0
    buffer_load_dwordx4 v4, s[8:11], s39 offen lds
    v_mfma_f32_32x32x16_bf16 v[72:87], v[192:195], v[44:47], v[72:87]
    s_add_u32 m0, s42, 1024
    s_nop 0
    buffer_load_dwordx4 v5, s[8:11], s39 offen lds
    v_mfma_f32_32x32x16_bf16 v[56:71], v[196:199], v[48:51], v[56:71]
    s_add_u32 m0, s42, 2048
    s_nop 0
    buffer_load_dwordx4 v6, s[8:11], s39 offen lds
    v_mfma_f32_32x32x16_bf16 v[72:87], v[196:199], v[52:55], v[72:87]
    s_add_u32 m0, s42, 3072
    s_nop 0
    buffer_load_dwordx4 v7, s[8:11], s39 offen lds
    s_add_u32 s39, s39, 128
    s_cmp_eq_u32 s39, 1280
    s_cselect_b32 s39, 0, s39
    s_waitcnt vmcnt(12)
    s_barrier
    ds_read_b128 v[200:203], v10 offset:16384
    ds_read_b64_tr_b16 v[24:25], v18 offset:24576
    ds_read_b64_tr_b16 v[26:27], v18 offset:25088
    ds_read_b64_tr_b16 v[28:29], v19 offset:24576
    ds_read_b64_tr_b16 v[30:31], v19 offset:25088
    ds_read_b128 v[204:207], v11 offset:16384
    ds_read_b64_tr_b16 v[32:33], v18 offset:26624
    ds_read_b64_tr_b16 v[34:35], v18 offset:27136
    ds_read_b64_tr_b16 v[36:37], v19 offset:26624
    ds_read_b64_tr_b16 v[38:39], v19 offset:27136
    s_add_u32 s4, s41, 0
    s_cmp_ge_u32 s4, 2457600
    s_cselect_b32 s5, 2457600, 0
    s_sub_u32 s4, s4, s5
    s_add_u32 s4, s4, s38
    s_add_u32 m0, s43, 16384
    s_nop 0
    buffer_load_dwordx4 v8, s[12:15], s4 offen lds
    ds_read_b128 v[208:211], v12 offset:16384
    ds_read_b64_tr_b16 v[40:41], v18 offset:28672
    ds_read_b64_tr_b16 v[42:43], v18 offset:29184
    ds_read_b64_tr_b16 v[44:45], v19 offset:28672
    ds_read_b64_tr_b16 v[46:47], v19 offset:29184
    s_waitcnt lgkmcnt(10)
    v_mfma_f32_32x32x16_bf16 v[56:71], v[200:203], v[24:27], v[56:71]
    ds_read_b128 v[212:215], v13 offset:16384
    ds_read_b64_tr_b16 v[48:49], v18 offset:30720
    ds_read_b64_tr_b16 v[50:51], v18 offset:31232
    v_mfma_f32_32x32x16_bf16 v[72:87], v[200:203], v[28:31], v[72:87]
    ds_read_b64_tr_b16 v[52:53], v19 offset:30720
    ds_read_b64_tr_b16 v[54:55], v19 offset:31232
    s_add_u32 m0, s43, 17408
    s_nop 0
    buffer_load_dwordx4 v9, s[12:15], s4 offen lds
    s_waitcnt lgkmcnt(10)
    v_mfma_f32_32x32x16_bf16 v[56:71], v[204:207], v[32:35], v[56:71]
    v_mfma_f32_32x32x16_bf16 v[72:87], v[204:207], v[36:39], v[72:87]
    s_waitcnt lgkmcnt(0)
    v_mfma_f32_32x32x16_bf16 v[56:71], v[208:211], v[40:43], v[56:71]
    v_mov_b32 v4, 0x3f803f80
    v_mfma_f32_32x32x16_bf16 v[72:87], v[208:211], v[44:47], v[72:87]
    v_mov_b32 v5, 0x3f803f80
    v_mfma_f32_32x32x16_bf16 v[56:71], v[212:215], v[48:51], v[56:71]
    v_mov_b32 v6, 0x3f803f80
    v_mfma_f32_32x32x16_bf16 v[72:87], v[212:215], v[52:55], v[72:87]
    v_mov_b32 v7, 0x3f803f80
    s_waitcnt vmcnt(8)
    s_barrier
    ds_read_b128 v[216:219], v10 offset:32768
    ds_read_b64_tr_b16 v[24:25], v18 offset:0
    ds_read_b64_tr_b16 v[26:27], v18 offset:512
    ds_read_b64_tr_b16 v[28:29], v19 offset:0
    ds_read_b64_tr_b16 v[30:31], v19 offset:512
    ds_read_b128 v[220:223], v11 offset:32768
    ds_read_b64_tr_b16 v[32:33], v18 offset:2048
    ds_read_b64_tr_b16 v[34:35], v18 offset:2560
    ds_read_b64_tr_b16 v[36:37], v19 offset:2048
    ds_read_b64_tr_b16 v[38:39], v19 offset:2560
    s_add_u32 s4, s41, 245760
    s_cmp_ge_u32 s4, 2457600
    s_cselect_b32 s5, 2457600, 0
    s_sub_u32 s4, s4, s5
    s_add_u32 s4, s4, s38
    s_add_u32 m0, s43, 24576
    s_nop 0
    buffer_load_dwordx4 v8, s[12:15], s4 offen lds
    ds_read_b128 v[224:227], v12 offset:32768
    ds_read_b64_tr_b16 v[40:41], v18 offset:4096
    ds_read_b64_tr_b16 v[42:43], v18 offset:4608
    ds_read_b64_tr_b16 v[44:45], v19 offset:4096
    ds_read_b64_tr_b16 v[46:47], v19 offset:4608
    s_waitcnt lgkmcnt(10)
    v_mfma_f32_32x32x16_bf16 v[56:71], v[216:219], v[24:27], v[56:71]
    ds_read_b128 v[228:231], v13 offset:32768
    ds_read_b64_tr_b16 v[48:49], v18 offset:6144
    ds_read_b64_tr_b16 v[50:51], v18 offset:6656
    v_mfma_f32_32x32x16_bf16 v[72:87], v[216:219], v[28:31], v[72:87]
    ds_read_b64_tr_b16 v[52:53], v19 offset:6144
    ds_read_b64_tr_b16 v[54:55], v19 offset:6656
    s_add_u32 m0, s43, 25600
    s_nop 0
    buffer_load_dwordx4 v9, s[12:15], s4 offen lds
    s_waitcnt lgkmcnt(10)
    v_mfma_f32_32x32x16_bf16 v[56:71], v[220:223], v[32:35], v[56:71]
    s_add_u32 s4, s41, 491520
    s_cmp_ge_u32 s4, 2457600
    s_cselect_b32 s5, 2457600, 0
    s_sub_u32 s4, s4, s5
    s_add_u32 s4, s4, s38
    s_add_u32 m0, s43, 49152
    s_nop 0
    buffer_load_dwordx4 v8, s[12:15], s4 offen lds
    s_add_u32 m0, s43, 50176
    s_nop 0
    buffer_load_dwordx4 v9, s[12:15], s4 offen lds
    v_mfma_f32_32x32x16_bf16 v[72:87], v[220:223], v[36:39], v[72:87]
    s_add_u32 s4, s41, 737280
    s_cmp_ge_u32 s4, 2457600
    s_cselect_b32 s5, 2457600, 0
    s_sub_u32 s4, s4, s5
    s_add_u32 s4, s4, s38
    s_add_u32 m0, s43, 57344
    s_nop 0
    buffer_load_dwordx4 v8, s[12:15], s4 offen lds
    s_add_u32 m0, s43, 58368
    s_nop 0
    buffer_load_dwordx4 v9, s[12:15], s4 offen lds
    s_waitcnt lgkmcnt(0)
    v_mfma_f32_32x32x16_bf16 v[56:71], v[224:227], v[40:43], v[56:71]
    v_mfma_f32_32x32x16_bf16 v[72:87], v[224:227], v[44:47], v[72:87]
    v_mfma_f32_32x32x16_bf16 v[56:71], v[228:231], v[48:51], v[56:71]
    v_mfma_f32_32x32x16_bf16 v[72:87], v[228:231], v[52:55], v[72:87]
    s_waitcnt vmcnt(8)
    s_barrier
    ds_read_b128 v[232:235], v10 offset:0
    ds_read_b64_tr_b16 v[24:25], v18 offset:8192
    ds_read_b64_tr_b16 v[26:27], v18 offset:8704
    ds_read_b64_tr_b16 v[28:29], v19 offset:8192
    ds_read_b64_tr_b16 v[30:31], v19 offset:8704
    ds_read_b128 v[236:239], v11 offset:0
    ds_read_b64_tr_b16 v[32:33], v18 offset:10240
    ds_read_b64_tr_b16 v[34:35], v18 offset:10752
    ds_read_b64_tr_b16 v[36:37], v19 offset:10240
    ds_read_b64_tr_b16 v[38:39], v19 offset:10752
    s_add_u32 s4, s41, 983040
    s_cmp_ge_u32 s4, 2457600
    s_cselect_b32 s5, 2457600, 0
    s_sub_u32 s4, s4, s5
    s_add_u32 s4, s4, s38
    s_add_u32 m0, s43, 0
    s_nop 0
    buffer_load_dwordx4 v8, s[12:15], s4 offen lds
    ds_read_b128 v[240:243], v12 offset:0
    ds_read_b64_tr_b16 v[40:41], v18 offset:12288
    ds_read_b64_tr_b16 v[42:43], v18 offset:12800
    ds_read_b64_tr_b16 v[44:45], v19 offset:12288
    ds_read_b64_tr_b16 v[46:47], v19 offset:12800
    s_waitcnt lgkmcnt(10)
    v_mfma_f32_32x32x16_bf16 v[56:71], v[232:235], v[24:27], v[56:71]
    ds_read_b128 v[244:247], v13 offset:0
    ds_read_b64_tr_b16 v[48:49], v18 offset:14336
    ds_read_b64_tr_b16 v[50:51], v18 offset:14848
    ds_read_b64_tr_b16 v[52:53], v19 offset:14336
    ds_read_b64_tr_b16 v[54:55], v19 offset:14848
    s_add_u32 m0, s43, 1024
    s_nop 0
    buffer_load_dwordx4 v9, s[12:15], s4 offen lds
    s_waitcnt lgkmcnt(10)
    v_mfma_f32_32x32x16_bf16 v[56:71], v[236:239], v[32:35], v[56:71]
    s_add_u32 s4, s41, 1228800
    s_cmp_ge_u32 s4, 2457600
    s_cselect_b32 s5, 2457600, 0
    s_sub_u32 s4, s4, s5
    s_add_u32 s4, s4, s38
    s_add_u32 m0, s43, 65536
    s_nop 0
    buffer_load_dwordx4 v8, s[12:15], s4 offen lds
    s_add_u32 m0, s43, 66560
    s_nop 0
    buffer_load_dwordx4 v9, s[12:15], s4 offen lds
    s_add_u32 s4, s41, 1474560
    s_cmp_ge_u32 s4, 2457600
    s_cselect_b32 s5, 2457600, 0
    s_sub_u32 s4, s4, s5
    s_add_u32 s4, s4, s38
    s_add_u32 m0, s43, 73728
    s_nop 0
    buffer_load_dwordx4 v8, s[12:15], s4 offen lds
    s_add_u32 m0, s43, 74752
    s_nop 0
    buffer_load_dwordx4 v9, s[12:15], s4 offen lds
    s_waitcnt lgkmcnt(0)
    v_mfma_f32_32x32x16_bf16 v[56:71], v[240:243], v[40:43], v[56:71]
    s_waitcnt vmcnt(12)
    s_barrier
    v_mfma_f32_32x32x16_bf16 v[56:71], v[244:247], v[48:51], v[56:71]
    v_mfma_f32_32x32x16_bf16 v[72:87], v[232:235], v[28:31], v[72:87]
    s_mov_b32 exec_hi, 0
    buffer_store_dwordx4 v[4:7], v255, s[16:19], s24 offen offset:2048 sc1
    s_mov_b32 exec_hi, -1
    buffer_load_dword v2, off, s[28:31], 0 offset:128 sc1
    s_nop 5
    v_mfma_f32_32x32x16_bf16 v[72:87], v[236:239], v[36:39], v[72:87]
    v_cvt_pk_bf16_f32 v56, v56, v57
    v_cvt_pk_bf16_f32 v57, v58, v59
    v_cvt_pk_bf16_f32 v58, v60, v61
    v_cvt_pk_bf16_f32 v59, v62, v63
    v_mfma_f32_32x32x16_bf16 v[72:87], v[240:243], v[44:47], v[72:87]
    buffer_store_dwordx4 v[56:59], v22, s[16:19], s20 offen sc1
    v_cvt_pk_bf16_f32 v60, v64, v65
    v_cvt_pk_bf16_f32 v61, v66, v67
    v_cvt_pk_bf16_f32 v62, v68, v69
    v_mfma_f32_32x32x16_bf16 v[72:87], v[244:247], v[52:55], v[72:87]
    v_cvt_pk_bf16_f32 v63, v70, v71
    buffer_store_dwordx4 v[60:63], v22, s[16:19], s21 offen sc1
g1_p2_3:
    s_cmp_lt_u32 s51, 7
    s_cbranch_scc1 g1_p2q_4
    s_cmp_lt_u32 s51, 14
    s_cbranch_scc1 g1_p2v_5
    s_load_dwordx2 s[8:9], s[0:1], 16
    s_load_dwordx2 s[12:13], s[0:1], 24
    s_nop 5
    v_mul_f32 v72, s6, v72
    v_mul_f32 v73, s6, v73
    v_mul_f32 v74, s6, v74
    v_mul_f32 v75, s6, v75
    v_mul_f32 v76, s6, v76
    v_mul_f32 v77, s6, v77
    v_mul_f32 v78, s6, v78
    v_mul_f32 v79, s6, v79
    v_cvt_pk_bf16_f32 v72, v72, v73
    v_cvt_pk_bf16_f32 v73, v74, v75
    v_cvt_pk_bf16_f32 v74, v76, v77
    v_cvt_pk_bf16_f32 v75, v78, v79
    buffer_store_dwordx4 v[72:75], v22, s[16:19], s22 offen sc1
    v_mul_f32 v80, s6, v80
    v_mul_f32 v81, s6, v81
    v_mul_f32 v82, s6, v82
    v_mul_f32 v83, s6, v83
    v_mul_f32 v84, s6, v84
    v_mul_f32 v85, s6, v85
    v_mul_f32 v86, s6, v86
    v_mul_f32 v87, s6, v87
    v_cvt_pk_bf16_f32 v76, v80, v81
    v_cvt_pk_bf16_f32 v77, v82, v83
    v_cvt_pk_bf16_f32 v78, v84, v85
    v_cvt_pk_bf16_f32 v79, v86, v87
    buffer_store_dwordx4 v[76:79], v22, s[16:19], s23 offen sc1
    s_mov_b32 s10, 819200
    s_mov_b32 s14, 2621440
    s_lshr_b32 s3, s2, 6
    s_bfe_u32 s4, s2, 0x30001
    s_lshl3_add_u32 s3, s3, s4
    s_mul_i32 s4, s3, 81920
    s_mul_i32 s3, s3, 25600
    v_lshlrev_b32 v24, 4, v0
    s_waitcnt vmcnt(0) lgkmcnt(0)
    s_mov_b32 s58, 0x40000
clr_top_8:
    v_cmp_eq_u32 vcc, 0, v2
    s_cbranch_vccz clr_ok_9
    s_sub_u32 s58, s58, 1
    s_cbranch_scc1 clr_ok_9
    s_sleep 8
    buffer_load_dword v2, off, s[28:31], 0 offset:128 sc1
    s_waitcnt vmcnt(0)
    s_branch clr_top_8
clr_ok_9:
    s_barrier
    s_mov_b64 exec, 1
    buffer_store_dword v3, off, s[16:19], s26 sc1
    s_mov_b64 exec, -1
    s_mov_b64 exec, 1
    buffer_store_dword v249, v248, s[16:19], 0 offen sc1
    s_mov_b64 exec, -1
    buffer_load_dwordx4 v[28:31], v24, s[8:11], s3 offen
    s_add_u32 s3, s3, 4096
    buffer_load_dwordx4 v[32:35], v24, s[8:11], s3 offen
    s_add_u32 s3, s3, 4096
    buffer_load_dwordx4 v[36:39], v24, s[8:11], s3 offen
    s_add_u32 s3, s3, 4096
    buffer_load_dwordx4 v[40:43], v24, s[8:11], s3 offen
    s_add_u32 s3, s3, 4096
    buffer_load_dwordx4 v[44:47], v24, s[8:11], s3 offen
    s_add_u32 s3, s3, 4096
    buffer_load_dwordx4 v[48:51], v24, s[8:11], s3 offen
    s_add_u32 s3, s3, 4096
    buffer_load_dwordx4 v[52:55], v24, s[8:11], s3 offen
    s_add_u32 s3, s3, 4096
    s_mov_b32 s20, 1073741824
    s_mov_b32 s21, 1073741824
    s_mov_b32 s22, 1073741824
    s_mov_b32 s23, 1073741824
    s_mov_b32 s24, 1073741824
    s_mov_b64 exec, s[34:35]
    buffer_load_dword v2, v254, s[16:19], 0 offen sc1
    s_mov_b64 exec, -1
    s_branch at_start_6
g1_p2q_4:
    ds_read_b64_tr_b16 v[24:25], v14 offset:16384
    ds_read_b64_tr_b16 v[26:27], v14 offset:16896
    ds_read_b64_tr_b16 v[32:33], v14 offset:18432
    ds_read_b64_tr_b16 v[34:35], v14 offset:18944
    ds_read_b64_tr_b16 v[40:41], v14 offset:20480
    ds_read_b64_tr_b16 v[42:43], v14 offset:20992
    s_nop 1
    v_mul_f32 v72, s6, v72
    v_mul_f32 v73, s6, v73
    v_mul_f32 v74, s6, v74
    v_mul_f32 v75, s6, v75
    v_mul_f32 v76, s6, v76
    v_mul_f32 v77, s6, v77
    s_waitcnt lgkmcnt(4)
    v_mfma_f32_32x32x16_bf16 v[56:71], v[24:27], v[88:91], 0
    ds_read_b64_tr_b16 v[48:49], v14 offset:22528
    ds_read_b64_tr_b16 v[50:51], v14 offset:23040
    v_mul_f32 v78, s6, v78
    v_mul_f32 v79, s6, v79
    v_cvt_pk_bf16_f32 v72, v72, v73
    v_cvt_pk_bf16_f32 v73, v74, v75
    v_cvt_pk_bf16_f32 v74, v76, v77
    v_cvt_pk_bf16_f32 v75, v78, v79
    s_waitcnt lgkmcnt(4)
    v_mfma_f32_32x32x16_bf16 v[56:71], v[32:35], v[92:95], v[56:71]
    s_waitcnt vmcnt(14)
    s_barrier
    ds_read_b64_tr_b16 v[24:25], v14 offset:24576
    ds_read_b64_tr_b16 v[26:27], v14 offset:25088
    buffer_store_dwordx4 v[72:75], v22, s[16:19], s22 offen sc1
    v_mul_f32 v80, s6, v80
    v_mul_f32 v81, s6, v81
    v_mul_f32 v82, s6, v82
    v_mul_f32 v83, s6, v83
    v_mul_f32 v84, s6, v84
    ds_read_b64_tr_b16 v[28:29], v15 offset:16384
    ds_read_b64_tr_b16 v[30:31], v15 offset:16896
    s_waitcnt lgkmcnt(6)
    v_mfma_f32_32x32x16_bf16 v[56:71], v[40:43], v[96:99], v[56:71]
    ds_read_b64_tr_b16 v[32:33], v14 offset:26624
    ds_read_b64_tr_b16 v[34:35], v14 offset:27136
    v_mul_f32 v85, s6, v85
    v_mul_f32 v86, s6, v86
    v_mul_f32 v87, s6, v87
    v_cvt_pk_bf16_f32 v76, v80, v81
    v_cvt_pk_bf16_f32 v77, v82, v83
    v_cvt_pk_bf16_f32 v78, v84, v85
    ds_read_b64_tr_b16 v[36:37], v15 offset:18432
    ds_read_b64_tr_b16 v[38:39], v15 offset:18944
    s_waitcnt lgkmcnt(8)
    v_mfma_f32_32x32x16_bf16 v[56:71], v[48:51], v[100:103], v[56:71]
    ds_read_b64_tr_b16 v[40:41], v14 offset:28672
    ds_read_b64_tr_b16 v[42:43], v14 offset:29184
    v_cvt_pk_bf16_f32 v79, v86, v87
    buffer_store_dwordx4 v[76:79], v22, s[16:19], s23 offen sc1
    s_lshl_b32 s3, s33, 18
    s_lshl2_add_u32 s5, s36, s32
    s_lshl_b32 s5, s5, 9
    s_add_u32 s20, s3, s5
    ds_read_b64_tr_b16 v[44:45], v15 offset:20480
    ds_read_b64_tr_b16 v[46:47], v15 offset:20992
    s_waitcnt lgkmcnt(10)
    v_mfma_f32_32x32x16_bf16 v[56:71], v[24:27], v[104:107], v[56:71]
    ds_read_b64_tr_b16 v[48:49], v14 offset:30720
    ds_read_b64_tr_b16 v[50:51], v14 offset:31232
    s_add_u32 s21, s20, 65536
    s_add_u32 s22, s20, 131072
    s_add_u32 s23, s20, 196608
    s_waitcnt lgkmcnt(10)
    v_mfma_f32_32x32x16_bf16 v[72:87], v[28:31], v[88:91], 0
    ds_read_b64_tr_b16 v[52:53], v15 offset:22528
    ds_read_b64_tr_b16 v[54:55], v15 offset:23040
    s_mov_b32 s24, 1073741824
    s_lshl4_add_u32 s3, s33, s36
    s_lshl_b32 s3, s3, 7
    s_waitcnt lgkmcnt(10)
    v_mfma_f32_32x32x16_bf16 v[56:71], v[32:35], v[108:111], v[56:71]
    s_waitcnt vmcnt(14)
    s_barrier
    ds_read_b64_tr_b16 v[24:25], v16 offset:8192
    ds_read_b64_tr_b16 v[26:27], v16 offset:8704
    s_add_u32 s3, s3, s32
    s_add_u32 s25, s3, 15990784
    s_waitcnt lgkmcnt(10)
    v_mfma_f32_32x32x16_bf16 v[72:87], v[36:39], v[92:95], v[72:87]
    ds_read_b64_tr_b16 v[28:29], v15 offset:24576
    ds_read_b64_tr_b16 v[30:31], v15 offset:25088
    s_add_u32 s4, s41, 1720320
    s_cmp_ge_u32 s4, 2457600
    s_cselect_b32 s5, 2457600, 0
    s_sub_u32 s4, s4, s5
    s_add_u32 s4, s4, s38
    s_add_u32 m0, s43, 8192
    s_nop 0
    buffer_load_dwordx4 v8, s[12:15], s4 offen lds
    s_waitcnt lgkmcnt(10)
    v_mfma_f32_32x32x16_bf16 v[56:71], v[40:43], v[112:115], v[56:71]
    ds_read_b64_tr_b16 v[32:33], v16 offset:10240
    ds_read_b64_tr_b16 v[34:35], v16 offset:10752
    s_waitcnt lgkmcnt(10)
    v_mfma_f32_32x32x16_bf16 v[72:87], v[44:47], v[96:99], v[72:87]
    ds_read_b64_tr_b16 v[36:37], v15 offset:26624
    ds_read_b64_tr_b16 v[38:39], v15 offset:27136
    s_add_u32 m0, s43, 9216
    s_nop 0
    buffer_load_dwordx4 v9, s[12:15], s4 offen lds
    s_waitcnt lgkmcnt(10)
    v_mfma_f32_32x32x16_bf16 v[56:71], v[48:51], v[116:119], v[56:71]
    ds_read_b64_tr_b16 v[40:41], v16 offset:12288
    ds_read_b64_tr_b16 v[42:43], v16 offset:12800
    s_waitcnt lgkmcnt(10)
    v_mfma_f32_32x32x16_bf16 v[72:87], v[52:55], v[100:103], v[72:87]
    ds_read_b64_tr_b16 v[44:45], v15 offset:28672
    ds_read_b64_tr_b16 v[46:47], v15 offset:29184
    s_add_u32 s4, s41, 1966080
    s_cmp_ge_u32 s4, 2457600
    s_cselect_b32 s5, 2457600, 0
    s_sub_u32 s4, s4, s5
    s_add_u32 s4, s4, s38
    s_add_u32 m0, s43, 32768
    s_nop 0
    buffer_load_dwordx4 v8, s[12:15], s4 offen lds
    s_waitcnt lgkmcnt(10)
    v_mfma_f32_32x32x16_bf16 v[56:71], v[24:27], v[120:123], v[56:71]
    ds_read_b64_tr_b16 v[48:49], v16 offset:14336
    ds_read_b64_tr_b16 v[50:51], v16 offset:14848
    s_waitcnt lgkmcnt(10)
    v_mfma_f32_32x32x16_bf16 v[72:87], v[28:31], v[104:107], v[72:87]
    ds_read_b64_tr_b16 v[52:53], v15 offset:30720
    ds_read_b64_tr_b16 v[54:55], v15 offset:31232
    s_add_u32 m0, s43, 33792
    s_nop 0
    buffer_load_dwordx4 v9, s[12:15], s4 offen lds
    s_waitcnt lgkmcnt(10)
    v_mfma_f32_32x32x16_bf16 v[56:71], v[32:35], v[124:127], v[56:71]
    s_waitcnt vmcnt(16)
    s_barrier
    ds_read_b64_tr_b16 v[24:25], v16 offset:16384
    ds_read_b64_tr_b16 v[26:27], v16 offset:16896
    s_waitcnt lgkmcnt(10)
    v_mfma_f32_32x32x16_bf16 v[72:87], v[36:39], v[108:111], v[72:87]
    ds_read_b64_tr_b16 v[28:29], v17 offset:8192
    ds_read_b64_tr_b16 v[30:31], v17 offset:8704
    s_add_u32 s4, s41, 2211840
    s_cmp_ge_u32 s4, 2457600
    s_cselect_b32 s5, 2457600, 0
    s_sub_u32 s4, s4, s5
    s_add_u32 s4, s4, s38
    s_add_u32 m0, s43, 40960
    s_nop 0
    buffer_load_dwordx4 v8, s[12:15], s4 offen lds
    s_waitcnt lgkmcnt(10)
    v_mfma_f32_32x32x16_bf16 v[56:71], v[40:43], v[128:131], v[56:71]
    ds_read_b64_tr_b16 v[32:33], v16 offset:18432
    ds_read_b64_tr_b16 v[34:35], v16 offset:18944
    s_waitcnt lgkmcnt(10)
    v_mfma_f32_32x32x16_bf16 v[72:87], v[44:47], v[112:115], v[72:87]
    ds_read_b64_tr_b16 v[36:37], v17 offset:10240
    ds_read_b64_tr_b16 v[38:39], v17 offset:10752
    s_add_u32 m0, s43, 41984
    s_nop 0
    buffer_load_dwordx4 v9, s[12:15], s4 offen lds
    s_waitcnt lgkmcnt(10)
    v_mfma_f32_32x32x16_bf16 v[56:71], v[48:51], v[132:135], v[56:71]
    ds_read_b64_tr_b16 v[40:41], v16 offset:20480
    ds_read_b64_tr_b16 v[42:43], v16 offset:20992
    s_waitcnt lgkmcnt(10)
    v_mfma_f32_32x32x16_bf16 v[72:87], v[52:55], v[116:119], v[72:87]
    ds_read_b64_tr_b16 v[44:45], v17 offset:12288
    ds_read_b64_tr_b16 v[46:47], v17 offset:12800
    s_waitcnt lgkmcnt(10)
    v_mfma_f32_32x32x16_bf16 v[56:71], v[24:27], v[136:139], v[56:71]
    ds_read_b64_tr_b16 v[48:49], v16 offset:22528
    ds_read_b64_tr_b16 v[50:51], v16 offset:23040
    s_waitcnt lgkmcnt(10)
    v_mfma_f32_32x32x16_bf16 v[72:87], v[28:31], v[120:123], v[72:87]
    ds_read_b64_tr_b16 v[52:53], v17 offset:14336
    ds_read_b64_tr_b16 v[54:55], v17 offset:14848
    s_waitcnt lgkmcnt(10)
    v_mfma_f32_32x32x16_bf16 v[56:71], v[32:35], v[140:143], v[56:71]
    s_waitcnt vmcnt(16)
    s_barrier
    ds_read_b64_tr_b16 v[24:25], v14 offset:0
    ds_read_b64_tr_b16 v[26:27], v14 offset:512
    s_waitcnt lgkmcnt(10)
    v_mfma_f32_32x32x16_bf16 v[72:87], v[36:39], v[124:127], v[72:87]
    ds_read_b64_tr_b16 v[28:29], v17 offset:16384
    ds_read_b64_tr_b16 v[30:31], v17 offset:16896
    s_waitcnt lgkmcnt(10)
    v_mfma_f32_32x32x16_bf16 v[56:71], v[40:43], v[144:147], v[56:71]
    ds_read_b64_tr_b16 v[32:33], v14 offset:2048
    ds_read_b64_tr_b16 v[34:35], v14 offset:2560
    s_waitcnt lgkmcnt(10)
    v_mfma_f32_32x32x16_bf16 v[72:87], v[44:47], v[128:131], v[72:87]
    ds_read_b64_tr_b16 v[36:37], v17 offset:18432
    ds_read_b64_tr_b16 v[38:39], v17 offset:18944
    s_waitcnt vmcnt(6)
    s_mov_b32 s58, 0x40000
clr_top_10:
    v_cmp_eq_u32 vcc, 0, v2
    s_cbranch_vccz clr_ok_11
    s_sub_u32 s58, s58, 1
    s_cbranch_scc1 clr_ok_11
    s_sleep 8
    buffer_load_dword v2, off, s[28:31], 0 offset:128 sc1
    s_waitcnt vmcnt(0)
    s_branch clr_top_10
clr_ok_11:
    s_barrier
    s_mov_b64 exec, 1
    buffer_store_dword v3, off, s[16:19], s26 sc1
    s_mov_b64 exec, -1
    s_lshl_b32 s26, s32, 28
    s_or_b32 s26, s26, s25
    s_mov_b32 s62, s25
    s_waitcnt lgkmcnt(10)
    v_mfma_f32_32x32x16_bf16 v[56:71], v[48:51], v[148:151], v[56:71]
    ds_read_b64_tr_b16 v[40:41], v14 offset:4096
    ds_read_b64_tr_b16 v[42:43], v14 offset:4608
    s_waitcnt lgkmcnt(10)
    v_mfma_f32_32x32x16_bf16 v[72:87], v[52:55], v[132:135], v[72:87]
    ds_read_b64_tr_b16 v[44:45], v17 offset:20480
    ds_read_b64_tr_b16 v[46:47], v17 offset:20992
    s_waitcnt lgkmcnt(10)
    v_mfma_f32_32x32x16_bf16 v[56:71], v[24:27], v[152:155], v[56:71]
    ds_read_b64_tr_b16 v[48:49], v14 offset:6144
    ds_read_b64_tr_b16 v[50:51], v14 offset:6656
    s_waitcnt lgkmcnt(10)
    v_mfma_f32_32x32x16_bf16 v[72:87], v[28:31], v[136:139], v[72:87]
    ds_read_b64_tr_b16 v[52:53], v17 offset:22528
    ds_read_b64_tr_b16 v[54:55], v17 offset:23040
    s_waitcnt lgkmcnt(10)
    v_mfma_f32_32x32x16_bf16 v[56:71], v[32:35], v[156:159], v[56:71]
    s_waitcnt vmcnt(15)
    s_barrier
    ds_read_b64_tr_b16 v[24:25], v16 offset:24576
    ds_read_b64_tr_b16 v[26:27], v16 offset:25088
    s_waitcnt lgkmcnt(10)
    v_mfma_f32_32x32x16_bf16 v[72:87], v[36:39], v[140:143], v[72:87]
    ds_read_b64_tr_b16 v[28:29], v15 offset:0
    ds_read_b64_tr_b16 v[30:31], v15 offset:512
    s_waitcnt lgkmcnt(10)
    v_mfma_f32_32x32x16_bf16 v[56:71], v[40:43], v[160:163], v[56:71]
    ds_read_b64_tr_b16 v[32:33], v16 offset:26624
    ds_read_b64_tr_b16 v[34:35], v16 offset:27136
    s_waitcnt lgkmcnt(10)
    v_mfma_f32_32x32x16_bf16 v[72:87], v[44:47], v[144:147], v[72:87]
    ds_read_b64_tr_b16 v[36:37], v15 offset:2048
    ds_read_b64_tr_b16 v[38:39], v15 offset:2560
    s_waitcnt lgkmcnt(10)
    v_mfma_f32_32x32x16_bf16 v[56:71], v[48:51], v[164:167], v[56:71]
    ds_read_b64_tr_b16 v[40:41], v16 offset:28672
    ds_read_b64_tr_b16 v[42:43], v16 offset:29184
    s_waitcnt lgkmcnt(10)
    v_mfma_f32_32x32x16_bf16 v[72:87], v[52:55], v[148:151], v[72:87]
    ds_read_b64_tr_b16 v[44:45], v15 offset:4096
    ds_read_b64_tr_b16 v[46:47], v15 offset:4608
    s_waitcnt lgkmcnt(10)
    v_mfma_f32_32x32x16_bf16 v[56:71], v[24:27], v[168:171], v[56:71]
    ds_read_b64_tr_b16 v[48:49], v16 offset:30720
    ds_read_b64_tr_b16 v[50:51], v16 offset:31232
    s_waitcnt lgkmcnt(10)
    v_mfma_f32_32x32x16_bf16 v[72:87], v[28:31], v[152:155], v[72:87]
    ds_read_b64_tr_b16 v[52:53], v15 offset:6144
    ds_read_b64_tr_b16 v[54:55], v15 offset:6656
    s_waitcnt lgkmcnt(10)
    v_mfma_f32_32x32x16_bf16 v[56:71], v[32:35], v[172:175], v[56:71]
    s_waitcnt vmcnt(13)
    s_barrier
    ds_read_b64_tr_b16 v[24:25], v16 offset:32768
    ds_read_b64_tr_b16 v[26:27], v16 offset:33280
    s_waitcnt lgkmcnt(10)
    v_mfma_f32_32x32x16_bf16 v[72:87], v[36:39], v[156:159], v[72:87]
    ds_read_b64_tr_b16 v[28:29], v17 offset:24576
    ds_read_b64_tr_b16 v[30:31], v17 offset:25088
    s_waitcnt lgkmcnt(10)
    v_mfma_f32_32x32x16_bf16 v[56:71], v[40:43], v[176:179], v[56:71]
    ds_read_b64_tr_b16 v[32:33], v16 offset:34816
    ds_read_b64_tr_b16 v[34:35], v16 offset:35328
    s_waitcnt lgkmcnt(10)
    v_mfma_f32_32x32x16_bf16 v[72:87], v[44:47], v[160:163], v[72:87]
    ds_read_b64_tr_b16 v[36:37], v17 offset:26624
    ds_read_b64_tr_b16 v[38:39], v17 offset:27136
    s_waitcnt lgkmcnt(10)
    v_mfma_f32_32x32x16_bf16 v[56:71], v[48:51], v[180:183], v[56:71]
    ds_read_b64_tr_b16 v[40:41], v16 offset:36864
    ds_read_b64_tr_b16 v[42:43], v16 offset:37376
    s_waitcnt lgkmcnt(10)
    v_mfma_f32_32x32x16_bf16 v[72:87], v[52:55], v[164:167], v[72:87]
    ds_read_b64_tr_b16 v[44:45], v17 offset:28672
    ds_read_b64_tr_b16 v[46:47], v17 offset:29184
    s_waitcnt lgkmcnt(10)
    v_mfma_f32_32x32x16_bf16 v[56:71], v[24:27], v[184:187], v[56:71]
    ds_read_b64_tr_b16 v[48:49], v16 offset:38912
    ds_read_b64_tr_b16 v[50:51], v16 offset:39424
    s_waitcnt lgkmcnt(10)
    v_mfma_f32_32x32x16_bf16 v[72:87], v[28:31], v[168:171], v[72:87]
    ds_read_b64_tr_b16 v[52:53], v17 offset:30720
    ds_read_b64_tr_b16 v[54:55], v17 offset:31232
    s_waitcnt lgkmcnt(10)
    v_mfma_f32_32x32x16_bf16 v[56:71], v[32:35], v[188:191], v[56:71]
    s_waitcnt vmcnt(5)
    s_barrier
    ds_read_b64_tr_b16 v[24:25], v14 offset:8192
    ds_read_b64_tr_b16 v[26:27], v14 offset:8704
    s_waitcnt lgkmcnt(10)
    v_mfma_f32_32x32x16_bf16 v[72:87], v[36:39], v[172:175], v[72:87]
    ds_read_b64_tr_b16 v[28:29], v17 offset:32768
    ds_read_b64_tr_b16 v[30:31], v17 offset:33280
    s_waitcnt lgkmcnt(10)
    v_mfma_f32_32x32x16_bf16 v[56:71], v[40:43], v[192:195], v[56:71]
    ds_read_b64_tr_b16 v[32:33], v14 offset:10240
    ds_read_b64_tr_b16 v[34:35], v14 offset:10752
    s_waitcnt lgkmcnt(10)
    v_mfma_f32_32x32x16_bf16 v[72:87], v[44:47], v[176:179], v[72:87]
    ds_read_b64_tr_b16 v[36:37], v17 offset:34816
    ds_read_b64_tr_b16 v[38:39], v17 offset:35328
    s_mov_b64 exec, 1
    buffer_store_dword v249, v248, s[16:19], 0 offen sc1
    s_mov_b64 exec, -1
    s_waitcnt lgkmcnt(10)
    v_mfma_f32_32x32x16_bf16 v[56:71], v[48:51], v[196:199], v[56:71]
    ds_read_b64_tr_b16 v[40:41], v14 offset:12288
    ds_read_b64_tr_b16 v[42:43], v14 offset:12800
    s_waitcnt lgkmcnt(10)
    v_mfma_f32_32x32x16_bf16 v[72:87], v[52:55], v[180:183], v[72:87]
    ds_read_b64_tr_b16 v[44:45], v17 offset:36864
    ds_read_b64_tr_b16 v[46:47], v17 offset:37376
    s_waitcnt lgkmcnt(10)
    v_mfma_f32_32x32x16_bf16 v[56:71], v[24:27], v[200:203], v[56:71]
    ds_read_b64_tr_b16 v[48:49], v14 offset:14336
    ds_read_b64_tr_b16 v[50:51], v14 offset:14848
    s_waitcnt lgkmcnt(10)
    v_mfma_f32_32x32x16_bf16 v[72:87], v[28:31], v[184:187], v[72:87]
    ds_read_b64_tr_b16 v[52:53], v17 offset:38912
    ds_read_b64_tr_b16 v[54:55], v17 offset:39424
    s_waitcnt lgkmcnt(10)
    v_mfma_f32_32x32x16_bf16 v[56:71], v[32:35], v[204:207], v[56:71]
    s_waitcnt vmcnt(4)
    s_barrier
    ds_read_b64_tr_b16 v[24:25], v14 offset:32768
    ds_read_b64_tr_b16 v[26:27], v14 offset:33280
    s_waitcnt lgkmcnt(10)
    v_mfma_f32_32x32x16_bf16 v[72:87], v[36:39], v[188:191], v[72:87]
    ds_read_b64_tr_b16 v[28:29], v15 offset:8192
    ds_read_b64_tr_b16 v[30:31], v15 offset:8704
    s_waitcnt lgkmcnt(10)
    v_mfma_f32_32x32x16_bf16 v[56:71], v[40:43], v[208:211], v[56:71]
    ds_read_b64_tr_b16 v[32:33], v14 offset:34816
    ds_read_b64_tr_b16 v[34:35], v14 offset:35328
    s_waitcnt lgkmcnt(10)
    v_mfma_f32_32x32x16_bf16 v[72:87], v[44:47], v[192:195], v[72:87]
    ds_read_b64_tr_b16 v[36:37], v15 offset:10240
    ds_read_b64_tr_b16 v[38:39], v15 offset:10752
    s_waitcnt lgkmcnt(10)
    v_mfma_f32_32x32x16_bf16 v[56:71], v[48:51], v[212:215], v[56:71]
    ds_read_b64_tr_b16 v[40:41], v14 offset:36864
    ds_read_b64_tr_b16 v[42:43], v14 offset:37376
    s_waitcnt lgkmcnt(10)
    v_mfma_f32_32x32x16_bf16 v[72:87], v[52:55], v[196:199], v[72:87]
    ds_read_b64_tr_b16 v[44:45], v15 offset:12288
    ds_read_b64_tr_b16 v[46:47], v15 offset:12800
    s_waitcnt lgkmcnt(10)
    v_mfma_f32_32x32x16_bf16 v[56:71], v[24:27], v[216:219], v[56:71]
    ds_read_b64_tr_b16 v[48:49], v14 offset:38912
    ds_read_b64_tr_b16 v[50:51], v14 offset:39424
    s_waitcnt lgkmcnt(10)
    v_mfma_f32_32x32x16_bf16 v[72:87], v[28:31], v[200:203], v[72:87]
    ds_read_b64_tr_b16 v[52:53], v15 offset:14336
    ds_read_b64_tr_b16 v[54:55], v15 offset:14848
    s_waitcnt lgkmcnt(10)
    v_mfma_f32_32x32x16_bf16 v[56:71], v[32:35], v[220:223], v[56:71]
    s_waitcnt vmcnt(2)
    s_barrier
    ds_read_b64_tr_b16 v[24:25], v16 offset:0
    ds_read_b64_tr_b16 v[26:27], v16 offset:512
    s_waitcnt lgkmcnt(10)
    v_mfma_f32_32x32x16_bf16 v[72:87], v[36:39], v[204:207], v[72:87]
    ds_read_b64_tr_b16 v[28:29], v15 offset:32768
    ds_read_b64_tr_b16 v[30:31], v15 offset:33280
    s_waitcnt lgkmcnt(10)
    v_mfma_f32_32x32x16_bf16 v[56:71], v[40:43], v[224:227], v[56:71]
    ds_read_b64_tr_b16 v[32:33], v16 offset:2048
    ds_read_b64_tr_b16 v[34:35], v16 offset:2560
    s_waitcnt lgkmcnt(10)
    v_mfma_f32_32x32x16_bf16 v[72:87], v[44:47], v[208:211], v[72:87]
    ds_read_b64_tr_b16 v[36:37], v15 offset:34816
    ds_read_b64_tr_b16 v[38:39], v15 offset:35328
    s_waitcnt lgkmcnt(10)
    v_mfma_f32_32x32x16_bf16 v[56:71], v[48:51], v[228:231], v[56:71]
    ds_read_b64_tr_b16 v[40:41], v16 offset:4096
    ds_read_b64_tr_b16 v[42:43], v16 offset:4608
    s_waitcnt lgkmcnt(10)
    v_mfma_f32_32x32x16_bf16 v[72:87], v[52:55], v[212:215], v[72:87]
    ds_read_b64_tr_b16 v[44:45], v15 offset:36864
    ds_read_b64_tr_b16 v[46:47], v15 offset:37376
    s_waitcnt lgkmcnt(10)
    v_mfma_f32_32x32x16_bf16 v[56:71], v[24:27], v[232:235], v[56:71]
    ds_read_b64_tr_b16 v[48:49], v16 offset:6144
    ds_read_b64_tr_b16 v[50:51], v16 offset:6656
    s_waitcnt lgkmcnt(10)
    v_mfma_f32_32x32x16_bf16 v[72:87], v[28:31], v[216:219], v[72:87]
    ds_read_b64_tr_b16 v[52:53], v15 offset:38912
    ds_read_b64_tr_b16 v[54:55], v15 offset:39424
    s_waitcnt lgkmcnt(10)
    v_mfma_f32_32x32x16_bf16 v[56:71], v[32:35], v[236:239], v[56:71]
    s_waitcnt lgkmcnt(8)
    v_mfma_f32_32x32x16_bf16 v[72:87], v[36:39], v[220:223], v[72:87]
    ds_read_b64_tr_b16 v[28:29], v17 offset:0
    ds_read_b64_tr_b16 v[30:31], v17 offset:512
    s_waitcnt lgkmcnt(8)
    v_mfma_f32_32x32x16_bf16 v[56:71], v[40:43], v[240:243], v[56:71]
    s_waitcnt lgkmcnt(6)
    v_mfma_f32_32x32x16_bf16 v[72:87], v[44:47], v[224:227], v[72:87]
    ds_read_b64_tr_b16 v[36:37], v17 offset:2048
    ds_read_b64_tr_b16 v[38:39], v17 offset:2560
    s_waitcnt lgkmcnt(6)
    v_mfma_f32_32x32x16_bf16 v[56:71], v[48:51], v[244:247], v[56:71]
    s_waitcnt lgkmcnt(4)
    v_mfma_f32_32x32x16_bf16 v[72:87], v[52:55], v[228:231], v[72:87]
    ds_read_b64_tr_b16 v[44:45], v17 offset:4096
    ds_read_b64_tr_b16 v[46:47], v17 offset:4608
    s_mov_b64 exec, s[34:35]
    buffer_load_dword v2, v254, s[16:19], 0 offen sc1
    s_mov_b64 exec, -1
    s_waitcnt lgkmcnt(4)
    v_mfma_f32_32x32x16_bf16 v[72:87], v[28:31], v[232:235], v[72:87]
    ds_read_b64_tr_b16 v[52:53], v17 offset:6144
    ds_read_b64_tr_b16 v[54:55], v17 offset:6656
    s_waitcnt lgkmcnt(4)
    v_mfma_f32_32x32x16_bf16 v[72:87], v[36:39], v[236:239], v[72:87]
    s_nop 5
    v_cvt_pk_bf16_f32 v8, v56, v57
    v_cvt_pk_bf16_f32 v9, v58, v59
    v_cvt_pk_bf16_f32 v10, v60, v61
    s_waitcnt lgkmcnt(2)
    v_mfma_f32_32x32x16_bf16 v[72:87], v[44:47], v[240:243], v[72:87]
    v_cvt_pk_bf16_f32 v11, v62, v63
    v_cvt_pk_bf16_f32 v12, v64, v65
    v_cvt_pk_bf16_f32 v13, v66, v67
    s_waitcnt lgkmcnt(0)
    v_mfma_f32_32x32x16_bf16 v[72:87], v[52:55], v[244:247], v[72:87]
    v_cvt_pk_bf16_f32 v14, v68, v69
    v_cvt_pk_bf16_f32 v15, v70, v71
    s_nop 9
    v_cvt_pk_bf16_f32 v240, v72, v73
    v_cvt_pk_bf16_f32 v241, v74, v75
    v_cvt_pk_bf16_f32 v242, v76, v77
    v_cvt_pk_bf16_f32 v243, v78, v79
    v_cvt_pk_bf16_f32 v244, v80, v81
    v_cvt_pk_bf16_f32 v245, v82, v83
    v_cvt_pk_bf16_f32 v246, v84, v85
    v_cvt_pk_bf16_f32 v247, v86, v87
    s_branch at_start_6
g1_p2v_5:
    ds_read_b64_tr_b16 v[24:25], v18 offset:16384
    ds_read_b64_tr_b16 v[26:27], v18 offset:16896
    ds_read_b64_tr_b16 v[32:33], v18 offset:18432
    ds_read_b64_tr_b16 v[34:35], v18 offset:18944
    ds_read_b64_tr_b16 v[40:41], v18 offset:20480
    ds_read_b64_tr_b16 v[42:43], v18 offset:20992
    s_nop 1
    v_mul_f32 v72, s6, v72
    v_mul_f32 v73, s6, v73
    v_mul_f32 v74, s6, v74
    v_mul_f32 v75, s6, v75
    v_mul_f32 v76, s6, v76
    v_mul_f32 v77, s6, v77
    s_waitcnt lgkmcnt(4)
    v_mfma_f32_32x32x16_bf16 v[56:71], v[88:91], v[24:27], 0
    ds_read_b64_tr_b16 v[48:49], v18 offset:22528
    ds_read_b64_tr_b16 v[50:51], v18 offset:23040
    v_mul_f32 v78, s6, v78
    v_mul_f32 v79, s6, v79
    v_cvt_pk_bf16_f32 v72, v72, v73
    v_cvt_pk_bf16_f32 v73, v74, v75
    v_cvt_pk_bf16_f32 v74, v76, v77
    v_cvt_pk_bf16_f32 v75, v78, v79
    s_waitcnt lgkmcnt(4)
    v_mfma_f32_32x32x16_bf16 v[56:71], v[92:95], v[32:35], v[56:71]
    s_waitcnt vmcnt(14)
    s_barrier
    ds_read_b64_tr_b16 v[24:25], v18 offset:24576
    ds_read_b64_tr_b16 v[26:27], v18 offset:25088
    buffer_store_dwordx4 v[72:75], v22, s[16:19], s22 offen sc1
    v_mul_f32 v80, s6, v80
    v_mul_f32 v81, s6, v81
    v_mul_f32 v82, s6, v82
    v_mul_f32 v83, s6, v83
    v_mul_f32 v84, s6, v84
    ds_read_b64_tr_b16 v[28:29], v19 offset:16384
    ds_read_b64_tr_b16 v[30:31], v19 offset:16896
    s_waitcnt lgkmcnt(6)
    v_mfma_f32_32x32x16_bf16 v[56:71], v[96:99], v[40:43], v[56:71]
    ds_read_b64_tr_b16 v[32:33], v18 offset:26624
    ds_read_b64_tr_b16 v[34:35], v18 offset:27136
    v_mul_f32 v85, s6, v85
    v_mul_f32 v86, s6, v86
    v_mul_f32 v87, s6, v87
    v_cvt_pk_bf16_f32 v76, v80, v81
    v_cvt_pk_bf16_f32 v77, v82, v83
    v_cvt_pk_bf16_f32 v78, v84, v85
    ds_read_b64_tr_b16 v[36:37], v19 offset:18432
    ds_read_b64_tr_b16 v[38:39], v19 offset:18944
    s_waitcnt lgkmcnt(8)
    v_mfma_f32_32x32x16_bf16 v[56:71], v[100:103], v[48:51], v[56:71]
    ds_read_b64_tr_b16 v[40:41], v18 offset:28672
    ds_read_b64_tr_b16 v[42:43], v18 offset:29184
    v_cvt_pk_bf16_f32 v79, v86, v87
    buffer_store_dwordx4 v[76:79], v22, s[16:19], s23 offen sc1
    s_sub_u32 s3, s33, 20
    s_lshr_b32 s4, s3, 1
    s_mul_i32 s4, s4, 557056
    s_lshl2_add_u32 s5, s36, s32
    ds_read_b64_tr_b16 v[44:45], v19 offset:20480
    ds_read_b64_tr_b16 v[46:47], v19 offset:20992
    s_waitcnt lgkmcnt(10)
    v_mfma_f32_32x32x16_bf16 v[56:71], v[104:107], v[24:27], v[56:71]
    ds_read_b64_tr_b16 v[48:49], v18 offset:30720
    ds_read_b64_tr_b16 v[50:51], v18 offset:31232
    s_mul_i32 s5, s5, 8704
    s_add_u32 s4, s4, s5
    s_add_u32 s4, s4, 5242880
    s_waitcnt lgkmcnt(10)
    v_mfma_f32_32x32x16_bf16 v[72:87], v[88:91], v[28:31], 0
    ds_read_b64_tr_b16 v[52:53], v19 offset:22528
    ds_read_b64_tr_b16 v[54:55], v19 offset:23040
    s_and_b32 s3, s3, 1
    s_mov_b32 s24, s4
    s_lshl_b32 s3, s3, 10
    s_waitcnt lgkmcnt(10)
    v_mfma_f32_32x32x16_bf16 v[56:71], v[108:111], v[32:35], v[56:71]
    s_waitcnt vmcnt(14)
    s_barrier
    ds_read_b64_tr_b16 v[24:25], v20 offset:8192
    ds_read_b64_tr_b16 v[26:27], v20 offset:8704
    s_add_u32 s20, s4, s3
    s_add_u32 s21, s20, 2176
    s_add_u32 s22, s20, 512
    s_waitcnt lgkmcnt(10)
    v_mfma_f32_32x32x16_bf16 v[72:87], v[92:95], v[36:39], v[72:87]
    ds_read_b64_tr_b16 v[28:29], v19 offset:24576
    ds_read_b64_tr_b16 v[30:31], v19 offset:25088
    s_add_u32 s23, s20, 2688
    s_lshl4_add_u32 s3, s33, s36
    s_lshl_b32 s3, s3, 7
    s_waitcnt lgkmcnt(10)
    v_mfma_f32_32x32x16_bf16 v[56:71], v[112:115], v[40:43], v[56:71]
    ds_read_b64_tr_b16 v[32:33], v20 offset:10240
    ds_read_b64_tr_b16 v[34:35], v20 offset:10752
    s_add_u32 s3, s3, s32
    s_add_u32 s25, s3, 15990784
    v_mov_b32 v22, v23
    s_waitcnt lgkmcnt(10)
    v_mfma_f32_32x32x16_bf16 v[72:87], v[96:99], v[44:47], v[72:87]
    ds_read_b64_tr_b16 v[36:37], v19 offset:26624
    ds_read_b64_tr_b16 v[38:39], v19 offset:27136
    s_add_u32 s4, s41, 1720320
    s_cmp_ge_u32 s4, 2457600
    s_cselect_b32 s5, 2457600, 0
    s_sub_u32 s4, s4, s5
    s_add_u32 s4, s4, s38
    s_add_u32 m0, s43, 8192
    s_nop 0
    buffer_load_dwordx4 v8, s[12:15], s4 offen lds
    s_waitcnt lgkmcnt(10)
    v_mfma_f32_32x32x16_bf16 v[56:71], v[116:119], v[48:51], v[56:71]
    ds_read_b64_tr_b16 v[40:41], v20 offset:12288
    ds_read_b64_tr_b16 v[42:43], v20 offset:12800
    s_waitcnt lgkmcnt(10)
    v_mfma_f32_32x32x16_bf16 v[72:87], v[100:103], v[52:55], v[72:87]
    ds_read_b64_tr_b16 v[44:45], v19 offset:28672
    ds_read_b64_tr_b16 v[46:47], v19 offset:29184
    s_add_u32 m0, s43, 9216
    s_nop 0
    buffer_load_dwordx4 v9, s[12:15], s4 offen lds
    s_waitcnt lgkmcnt(10)
    v_mfma_f32_32x32x16_bf16 v[56:71], v[120:123], v[24:27], v[56:71]
    ds_read_b64_tr_b16 v[48:49], v20 offset:14336
    ds_read_b64_tr_b16 v[50:51], v20 offset:14848
    s_waitcnt lgkmcnt(10)
    v_mfma_f32_32x32x16_bf16 v[72:87], v[104:107], v[28:31], v[72:87]
    ds_read_b64_tr_b16 v[52:53], v19 offset:30720
    ds_read_b64_tr_b16 v[54:55], v19 offset:31232
    s_add_u32 s4, s41, 1966080
    s_cmp_ge_u32 s4, 2457600
    s_cselect_b32 s5, 2457600, 0
    s_sub_u32 s4, s4, s5
    s_add_u32 s4, s4, s38
    s_add_u32 m0, s43, 32768
    s_nop 0
    buffer_load_dwordx4 v8, s[12:15], s4 offen lds
    s_waitcnt lgkmcnt(10)
    v_mfma_f32_32x32x16_bf16 v[56:71], v[124:127], v[32:35], v[56:71]
    s_waitcnt vmcnt(15)
    s_barrier
    ds_read_b64_tr_b16 v[24:25], v20 offset:16384
    ds_read_b64_tr_b16 v[26:27], v20 offset:16896
    s_waitcnt lgkmcnt(10)
    v_mfma_f32_32x32x16_bf16 v[72:87], v[108:111], v[36:39], v[72:87]
    ds_read_b64_tr_b16 v[28:29], v21 offset:8192
    ds_read_b64_tr_b16 v[30:31], v21 offset:8704
    s_add_u32 m0, s43, 33792
    s_nop 0
    buffer_load_dwordx4 v9, s[12:15], s4 offen lds
    s_waitcnt lgkmcnt(10)
    v_mfma_f32_32x32x16_bf16 v[56:71], v[128:131], v[40:43], v[56:71]
    ds_read_b64_tr_b16 v[32:33], v20 offset:18432
    ds_read_b64_tr_b16 v[34:35], v20 offset:18944
    s_waitcnt lgkmcnt(10)
    v_mfma_f32_32x32x16_bf16 v[72:87], v[112:115], v[44:47], v[72:87]
    ds_read_b64_tr_b16 v[36:37], v21 offset:10240
    ds_read_b64_tr_b16 v[38:39], v21 offset:10752
    s_add_u32 s4, s41, 2211840
    s_cmp_ge_u32 s4, 2457600
    s_cselect_b32 s5, 2457600, 0
    s_sub_u32 s4, s4, s5
    s_add_u32 s4, s4, s38
    s_add_u32 m0, s43, 40960
    s_nop 0
    buffer_load_dwordx4 v8, s[12:15], s4 offen lds
    s_waitcnt lgkmcnt(10)
    v_mfma_f32_32x32x16_bf16 v[56:71], v[132:135], v[48:51], v[56:71]
    ds_read_b64_tr_b16 v[40:41], v20 offset:20480
    ds_read_b64_tr_b16 v[42:43], v20 offset:20992
    s_waitcnt lgkmcnt(10)
    v_mfma_f32_32x32x16_bf16 v[72:87], v[116:119], v[52:55], v[72:87]
    ds_read_b64_tr_b16 v[44:45], v21 offset:12288
    ds_read_b64_tr_b16 v[46:47], v21 offset:12800
    s_add_u32 m0, s43, 41984
    s_nop 0
    buffer_load_dwordx4 v9, s[12:15], s4 offen lds
    s_waitcnt lgkmcnt(10)
    v_mfma_f32_32x32x16_bf16 v[56:71], v[136:139], v[24:27], v[56:71]
    ds_read_b64_tr_b16 v[48:49], v20 offset:22528
    ds_read_b64_tr_b16 v[50:51], v20 offset:23040
    s_waitcnt lgkmcnt(10)
    v_mfma_f32_32x32x16_bf16 v[72:87], v[120:123], v[28:31], v[72:87]
    ds_read_b64_tr_b16 v[52:53], v21 offset:14336
    ds_read_b64_tr_b16 v[54:55], v21 offset:14848
    s_waitcnt lgkmcnt(10)
    v_mfma_f32_32x32x16_bf16 v[56:71], v[140:143], v[32:35], v[56:71]
    s_waitcnt vmcnt(16)
    s_barrier
    ds_read_b64_tr_b16 v[24:25], v18 offset:0
    ds_read_b64_tr_b16 v[26:27], v18 offset:512
    s_waitcnt lgkmcnt(10)
    v_mfma_f32_32x32x16_bf16 v[72:87], v[124:127], v[36:39], v[72:87]
    ds_read_b64_tr_b16 v[28:29], v21 offset:16384
    ds_read_b64_tr_b16 v[30:31], v21 offset:16896
    s_waitcnt lgkmcnt(10)
    v_mfma_f32_32x32x16_bf16 v[56:71], v[144:147], v[40:43], v[56:71]
    ds_read_b64_tr_b16 v[32:33], v18 offset:2048
    ds_read_b64_tr_b16 v[34:35], v18 offset:2560
    s_waitcnt lgkmcnt(10)
    v_mfma_f32_32x32x16_bf16 v[72:87], v[128:131], v[44:47], v[72:87]
    ds_read_b64_tr_b16 v[36:37], v21 offset:18432
    ds_read_b64_tr_b16 v[38:39], v21 offset:18944
    s_waitcnt vmcnt(6)
    s_mov_b32 s58, 0x40000
clr_top_12:
    v_cmp_eq_u32 vcc, 0, v2
    s_cbranch_vccz clr_ok_13
    s_sub_u32 s58, s58, 1
    s_cbranch_scc1 clr_ok_13
    s_sleep 8
    buffer_load_dword v2, off, s[28:31], 0 offset:128 sc1
    s_waitcnt vmcnt(0)
    s_branch clr_top_12
clr_ok_13:
    s_barrier
    s_mov_b64 exec, 1
    buffer_store_dword v3, off, s[16:19], s26 sc1
    s_mov_b64 exec, -1
    s_lshl_b32 s26, s32, 28
    s_or_b32 s26, s26, s25
    s_mov_b32 s62, s25
    s_waitcnt lgkmcnt(10)
    v_mfma_f32_32x32x16_bf16 v[56:71], v[148:151], v[48:51], v[56:71]
    ds_read_b64_tr_b16 v[40:41], v18 offset:4096
    ds_read_b64_tr_b16 v[42:43], v18 offset:4608
    s_waitcnt lgkmcnt(10)
    v_mfma_f32_32x32x16_bf16 v[72:87], v[132:135], v[52:55], v[72:87]
    ds_read_b64_tr_b16 v[44:45], v21 offset:20480
    ds_read_b64_tr_b16 v[46:47], v21 offset:20992
    s_waitcnt lgkmcnt(10)
    v_mfma_f32_32x32x16_bf16 v[56:71], v[152:155], v[24:27], v[56:71]
    ds_read_b64_tr_b16 v[48:49], v18 offset:6144
    ds_read_b64_tr_b16 v[50:51], v18 offset:6656
    s_waitcnt lgkmcnt(10)
    v_mfma_f32_32x32x16_bf16 v[72:87], v[136:139], v[28:31], v[72:87]
    ds_read_b64_tr_b16 v[52:53], v21 offset:22528
    ds_read_b64_tr_b16 v[54:55], v21 offset:23040
    s_waitcnt lgkmcnt(10)
    v_mfma_f32_32x32x16_bf16 v[56:71], v[156:159], v[32:35], v[56:71]
    s_waitcnt vmcnt(15)
    s_barrier
    ds_read_b64_tr_b16 v[24:25], v20 offset:24576
    ds_read_b64_tr_b16 v[26:27], v20 offset:25088
    s_waitcnt lgkmcnt(10)
    v_mfma_f32_32x32x16_bf16 v[72:87], v[140:143], v[36:39], v[72:87]
    ds_read_b64_tr_b16 v[28:29], v19 offset:0
    ds_read_b64_tr_b16 v[30:31], v19 offset:512
    s_waitcnt lgkmcnt(10)
    v_mfma_f32_32x32x16_bf16 v[56:71], v[160:163], v[40:43], v[56:71]
    ds_read_b64_tr_b16 v[32:33], v20 offset:26624
    ds_read_b64_tr_b16 v[34:35], v20 offset:27136
    s_waitcnt lgkmcnt(10)
    v_mfma_f32_32x32x16_bf16 v[72:87], v[144:147], v[44:47], v[72:87]
    ds_read_b64_tr_b16 v[36:37], v19 offset:2048
    ds_read_b64_tr_b16 v[38:39], v19 offset:2560
    s_waitcnt lgkmcnt(10)
    v_mfma_f32_32x32x16_bf16 v[56:71], v[164:167], v[48:51], v[56:71]
    ds_read_b64_tr_b16 v[40:41], v20 offset:28672
    ds_read_b64_tr_b16 v[42:43], v20 offset:29184
    s_waitcnt lgkmcnt(10)
    v_mfma_f32_32x32x16_bf16 v[72:87], v[148:151], v[52:55], v[72:87]
    ds_read_b64_tr_b16 v[44:45], v19 offset:4096
    ds_read_b64_tr_b16 v[46:47], v19 offset:4608
    s_waitcnt lgkmcnt(10)
    v_mfma_f32_32x32x16_bf16 v[56:71], v[168:171], v[24:27], v[56:71]
    ds_read_b64_tr_b16 v[48:49], v20 offset:30720
    ds_read_b64_tr_b16 v[50:51], v20 offset:31232
    s_waitcnt lgkmcnt(10)
    v_mfma_f32_32x32x16_bf16 v[72:87], v[152:155], v[28:31], v[72:87]
    ds_read_b64_tr_b16 v[52:53], v19 offset:6144
    ds_read_b64_tr_b16 v[54:55], v19 offset:6656
    s_waitcnt lgkmcnt(10)
    v_mfma_f32_32x32x16_bf16 v[56:71], v[172:175], v[32:35], v[56:71]
    s_waitcnt vmcnt(13)
    s_barrier
    ds_read_b64_tr_b16 v[24:25], v20 offset:32768
    ds_read_b64_tr_b16 v[26:27], v20 offset:33280
    s_waitcnt lgkmcnt(10)
    v_mfma_f32_32x32x16_bf16 v[72:87], v[156:159], v[36:39], v[72:87]
    ds_read_b64_tr_b16 v[28:29], v21 offset:24576
    ds_read_b64_tr_b16 v[30:31], v21 offset:25088
    s_waitcnt lgkmcnt(10)
    v_mfma_f32_32x32x16_bf16 v[56:71], v[176:179], v[40:43], v[56:71]
    ds_read_b64_tr_b16 v[32:33], v20 offset:34816
    ds_read_b64_tr_b16 v[34:35], v20 offset:35328
    s_waitcnt lgkmcnt(10)
    v_mfma_f32_32x32x16_bf16 v[72:87], v[160:163], v[44:47], v[72:87]
    ds_read_b64_tr_b16 v[36:37], v21 offset:26624
    ds_read_b64_tr_b16 v[38:39], v21 offset:27136
    s_waitcnt lgkmcnt(10)
    v_mfma_f32_32x32x16_bf16 v[56:71], v[180:183], v[48:51], v[56:71]
    ds_read_b64_tr_b16 v[40:41], v20 offset:36864
    ds_read_b64_tr_b16 v[42:43], v20 offset:37376
    s_waitcnt lgkmcnt(10)
    v_mfma_f32_32x32x16_bf16 v[72:87], v[164:167], v[52:55], v[72:87]
    ds_read_b64_tr_b16 v[44:45], v21 offset:28672
    ds_read_b64_tr_b16 v[46:47], v21 offset:29184
    s_waitcnt lgkmcnt(10)
    v_mfma_f32_32x32x16_bf16 v[56:71], v[184:187], v[24:27], v[56:71]
    ds_read_b64_tr_b16 v[48:49], v20 offset:38912
    ds_read_b64_tr_b16 v[50:51], v20 offset:39424
    s_waitcnt lgkmcnt(10)
    v_mfma_f32_32x32x16_bf16 v[72:87], v[168:171], v[28:31], v[72:87]
    ds_read_b64_tr_b16 v[52:53], v21 offset:30720
    ds_read_b64_tr_b16 v[54:55], v21 offset:31232
    s_waitcnt lgkmcnt(10)
    v_mfma_f32_32x32x16_bf16 v[56:71], v[188:191], v[32:35], v[56:71]
    s_waitcnt vmcnt(5)
    s_barrier
    ds_read_b64_tr_b16 v[24:25], v18 offset:8192
    ds_read_b64_tr_b16 v[26:27], v18 offset:8704
    s_waitcnt lgkmcnt(10)
    v_mfma_f32_32x32x16_bf16 v[72:87], v[172:175], v[36:39], v[72:87]
    ds_read_b64_tr_b16 v[28:29], v21 offset:32768
    ds_read_b64_tr_b16 v[30:31], v21 offset:33280
    s_waitcnt lgkmcnt(10)
    v_mfma_f32_32x32x16_bf16 v[56:71], v[192:195], v[40:43], v[56:71]
    ds_read_b64_tr_b16 v[32:33], v18 offset:10240
    ds_read_b64_tr_b16 v[34:35], v18 offset:10752
    s_waitcnt lgkmcnt(10)
    v_mfma_f32_32x32x16_bf16 v[72:87], v[176:179], v[44:47], v[72:87]
    ds_read_b64_tr_b16 v[36:37], v21 offset:34816
    ds_read_b64_tr_b16 v[38:39], v21 offset:35328
    s_mov_b64 exec, 1
    buffer_store_dword v249, v248, s[16:19], 0 offen sc1
    s_mov_b64 exec, -1
    s_waitcnt lgkmcnt(10)
    v_mfma_f32_32x32x16_bf16 v[56:71], v[196:199], v[48:51], v[56:71]
    ds_read_b64_tr_b16 v[40:41], v18 offset:12288
    ds_read_b64_tr_b16 v[42:43], v18 offset:12800
    s_waitcnt lgkmcnt(10)
    v_mfma_f32_32x32x16_bf16 v[72:87], v[180:183], v[52:55], v[72:87]
    ds_read_b64_tr_b16 v[44:45], v21 offset:36864
    ds_read_b64_tr_b16 v[46:47], v21 offset:37376
    s_waitcnt lgkmcnt(10)
    v_mfma_f32_32x32x16_bf16 v[56:71], v[200:203], v[24:27], v[56:71]
    ds_read_b64_tr_b16 v[48:49], v18 offset:14336
    ds_read_b64_tr_b16 v[50:51], v18 offset:14848
    s_waitcnt lgkmcnt(10)
    v_mfma_f32_32x32x16_bf16 v[72:87], v[184:187], v[28:31], v[72:87]
    ds_read_b64_tr_b16 v[52:53], v21 offset:38912
    ds_read_b64_tr_b16 v[54:55], v21 offset:39424
    s_waitcnt lgkmcnt(10)
    v_mfma_f32_32x32x16_bf16 v[56:71], v[204:207], v[32:35], v[56:71]
    s_waitcnt vmcnt(4)
    s_barrier
    ds_read_b64_tr_b16 v[24:25], v18 offset:32768
    ds_read_b64_tr_b16 v[26:27], v18 offset:33280
    s_waitcnt lgkmcnt(10)
    v_mfma_f32_32x32x16_bf16 v[72:87], v[188:191], v[36:39], v[72:87]
    ds_read_b64_tr_b16 v[28:29], v19 offset:8192
    ds_read_b64_tr_b16 v[30:31], v19 offset:8704
    s_waitcnt lgkmcnt(10)
    v_mfma_f32_32x32x16_bf16 v[56:71], v[208:211], v[40:43], v[56:71]
    ds_read_b64_tr_b16 v[32:33], v18 offset:34816
    ds_read_b64_tr_b16 v[34:35], v18 offset:35328
    s_waitcnt lgkmcnt(10)
    v_mfma_f32_32x32x16_bf16 v[72:87], v[192:195], v[44:47], v[72:87]
    ds_read_b64_tr_b16 v[36:37], v19 offset:10240
    ds_read_b64_tr_b16 v[38:39], v19 offset:10752
    s_waitcnt lgkmcnt(10)
    v_mfma_f32_32x32x16_bf16 v[56:71], v[212:215], v[48:51], v[56:71]
    ds_read_b64_tr_b16 v[40:41], v18 offset:36864
    ds_read_b64_tr_b16 v[42:43], v18 offset:37376
    s_waitcnt lgkmcnt(10)
    v_mfma_f32_32x32x16_bf16 v[72:87], v[196:199], v[52:55], v[72:87]
    ds_read_b64_tr_b16 v[44:45], v19 offset:12288
    ds_read_b64_tr_b16 v[46:47], v19 offset:12800
    s_waitcnt lgkmcnt(10)
    v_mfma_f32_32x32x16_bf16 v[56:71], v[216:219], v[24:27], v[56:71]
    ds_read_b64_tr_b16 v[48:49], v18 offset:38912
    ds_read_b64_tr_b16 v[50:51], v18 offset:39424
    s_waitcnt lgkmcnt(10)
    v_mfma_f32_32x32x16_bf16 v[72:87], v[200:203], v[28:31], v[72:87]
    ds_read_b64_tr_b16 v[52:53], v19 offset:14336
    ds_read_b64_tr_b16 v[54:55], v19 offset:14848
    s_waitcnt lgkmcnt(10)
    v_mfma_f32_32x32x16_bf16 v[56:71], v[220:223], v[32:35], v[56:71]
    s_waitcnt vmcnt(2)
    s_barrier
    ds_read_b64_tr_b16 v[24:25], v20 offset:0
    ds_read_b64_tr_b16 v[26:27], v20 offset:512
    s_waitcnt lgkmcnt(10)
    v_mfma_f32_32x32x16_bf16 v[72:87], v[204:207], v[36:39], v[72:87]
    ds_read_b64_tr_b16 v[28:29], v19 offset:32768
    ds_read_b64_tr_b16 v[30:31], v19 offset:33280
    s_waitcnt lgkmcnt(10)
    v_mfma_f32_32x32x16_bf16 v[56:71], v[224:227], v[40:43], v[56:71]
    ds_read_b64_tr_b16 v[32:33], v20 offset:2048
    ds_read_b64_tr_b16 v[34:35], v20 offset:2560
    s_waitcnt lgkmcnt(10)
    v_mfma_f32_32x32x16_bf16 v[72:87], v[208:211], v[44:47], v[72:87]
    ds_read_b64_tr_b16 v[36:37], v19 offset:34816
    ds_read_b64_tr_b16 v[38:39], v19 offset:35328
    s_waitcnt lgkmcnt(10)
    v_mfma_f32_32x32x16_bf16 v[56:71], v[228:231], v[48:51], v[56:71]
    ds_read_b64_tr_b16 v[40:41], v20 offset:4096
    ds_read_b64_tr_b16 v[42:43], v20 offset:4608
    s_waitcnt lgkmcnt(10)
    v_mfma_f32_32x32x16_bf16 v[72:87], v[212:215], v[52:55], v[72:87]
    ds_read_b64_tr_b16 v[44:45], v19 offset:36864
    ds_read_b64_tr_b16 v[46:47], v19 offset:37376
    s_waitcnt lgkmcnt(10)
    v_mfma_f32_32x32x16_bf16 v[56:71], v[232:235], v[24:27], v[56:71]
    ds_read_b64_tr_b16 v[48:49], v20 offset:6144
    ds_read_b64_tr_b16 v[50:51], v20 offset:6656
    s_waitcnt lgkmcnt(10)
    v_mfma_f32_32x32x16_bf16 v[72:87], v[216:219], v[28:31], v[72:87]
    ds_read_b64_tr_b16 v[52:53], v19 offset:38912
    ds_read_b64_tr_b16 v[54:55], v19 offset:39424
    s_waitcnt lgkmcnt(10)
    v_mfma_f32_32x32x16_bf16 v[56:71], v[236:239], v[32:35], v[56:71]
    s_waitcnt lgkmcnt(8)
    v_mfma_f32_32x32x16_bf16 v[72:87], v[220:223], v[36:39], v[72:87]
    ds_read_b64_tr_b16 v[28:29], v21 offset:0
    ds_read_b64_tr_b16 v[30:31], v21 offset:512
    s_waitcnt lgkmcnt(8)
    v_mfma_f32_32x32x16_bf16 v[56:71], v[240:243], v[40:43], v[56:71]
    s_waitcnt lgkmcnt(6)
    v_mfma_f32_32x32x16_bf16 v[72:87], v[224:227], v[44:47], v[72:87]
    ds_read_b64_tr_b16 v[36:37], v21 offset:2048
    ds_read_b64_tr_b16 v[38:39], v21 offset:2560
    s_waitcnt lgkmcnt(6)
    v_mfma_f32_32x32x16_bf16 v[56:71], v[244:247], v[48:51], v[56:71]
    s_waitcnt lgkmcnt(4)
    v_mfma_f32_32x32x16_bf16 v[72:87], v[228:231], v[52:55], v[72:87]
    ds_read_b64_tr_b16 v[44:45], v21 offset:4096
    ds_read_b64_tr_b16 v[46:47], v21 offset:4608
    s_mov_b64 exec, s[34:35]
    buffer_load_dword v2, v254, s[16:19], 0 offen sc1
    s_mov_b64 exec, -1
    s_waitcnt lgkmcnt(4)
    v_mfma_f32_32x32x16_bf16 v[72:87], v[232:235], v[28:31], v[72:87]
    ds_read_b64_tr_b16 v[52:53], v21 offset:6144
    ds_read_b64_tr_b16 v[54:55], v21 offset:6656
    s_waitcnt lgkmcnt(4)
    v_mfma_f32_32x32x16_bf16 v[72:87], v[236:239], v[36:39], v[72:87]
    s_nop 5
    v_cvt_pk_bf16_f32 v8, v56, v57
    v_cvt_pk_bf16_f32 v9, v58, v59
    v_cvt_pk_bf16_f32 v10, v60, v61
    s_waitcnt lgkmcnt(2)
    v_mfma_f32_32x32x16_bf16 v[72:87], v[240:243], v[44:47], v[72:87]
    v_cvt_pk_bf16_f32 v11, v62, v63
    v_cvt_pk_bf16_f32 v12, v64, v65
    v_cvt_pk_bf16_f32 v13, v66, v67
    s_waitcnt lgkmcnt(0)
    v_mfma_f32_32x32x16_bf16 v[72:87], v[244:247], v[52:55], v[72:87]
    v_cvt_pk_bf16_f32 v14, v68, v69
    v_cvt_pk_bf16_f32 v15, v70, v71
    s_nop 9
    v_cvt_pk_bf16_f32 v240, v72, v73
    v_cvt_pk_bf16_f32 v241, v74, v75
    v_cvt_pk_bf16_f32 v242, v76, v77
    v_cvt_pk_bf16_f32 v243, v78, v79
    v_cvt_pk_bf16_f32 v244, v80, v81
    v_cvt_pk_bf16_f32 v245, v82, v83
    v_cvt_pk_bf16_f32 v246, v84, v85
    v_cvt_pk_bf16_f32 v247, v86, v87
at_start_6:
    s_waitcnt vmcnt(0)
    v_cmp_ne_u32 vcc, 0x1010101, v2
    s_and_b64 s[34:35], s[34:35], vcc
    s_cbranch_scc0 at_go_14
    s_mov_b64 exec, s[34:35]
    buffer_load_dword v2, v254, s[16:19], 0 offen sc1
    s_mov_b64 exec, -1
    s_mov_b64 exec, s[34:35]
    s_mov_b32 s58, 0x40000
poll_top_15:
    s_waitcnt vmcnt(0)
    v_cmp_ne_u32 vcc, 0x1010101, v2
    s_cbranch_vccz poll_ok_16
    s_mov_b64 exec, vcc
    s_sub_u32 s58, s58, 1
    s_cbranch_scc1 poll_ok_16
    s_sleep 1
    buffer_load_dword v2, v254, s[16:19], 0 offen sc1
    s_branch poll_top_15
poll_ok_16:
    s_mov_b64 exec, -1
at_go_14:
    buffer_load_dwordx4 v[172:175], v250, s[16:19], s47 offen offset:0 sc1
    buffer_load_dwordx2 v[220:221], v253, s[16:19], s47 offen offset:0 sc1
    buffer_load_dwordx2 v[168:169], v253, s[16:19], s60 offen sc1
    buffer_load_dwordx4 v[152:155], v250, s[16:19], s60 offen offset:0 sc1
    buffer_load_dwordx4 v[156:159], v250, s[16:19], s60 offen offset:512 sc1
    buffer_load_dwordx2 v[170:171], v253, s[16:19], s61 offen sc1
    buffer_load_dwordx4 v[160:163], v250, s[16:19], s61 offen offset:0 sc1
    buffer_load_dwordx4 v[164:167], v250, s[16:19], s61 offen offset:512 sc1
    buffer_load_dwordx4 v[176:179], v252, s[16:19], s49 offen sc1
    buffer_load_dwordx4 v[180:183], v252, s[16:19], s49 offen offset:2176 sc1
    s_add_u32 s49, s49, 8704
    buffer_load_dwordx4 v[184:187], v250, s[16:19], s47 offen offset:512 sc1
    v_mov_b32 v249, 9
    s_add_u32 s3, s56, s54
    s_and_b32 s3, s3, 7
    s_lshl_b32 s34, 0x1010101, s3
    buffer_store_dwordx4 v[8:11], v22, s[16:19], s20 offen sc1
    buffer_store_dwordx4 v[12:15], v22, s[16:19], s21 offen sc1
    buffer_store_dwordx4 v[240:243], v22, s[16:19], s22 offen sc1
    s_waitcnt vmcnt(9)
    v_mfma_f32_32x32x4_2b_bf16 v[24:55], v[220:221], v[168:169], 0 cbsz:1 abid:0
    s_nop 15
    s_nop 1
    v_mfma_f32_32x32x16_bf16 v[24:39], v[172:175], v[152:155], v[24:39]
    v_mfma_f32_32x32x16_bf16 v[40:55], v[172:175], v[156:159], v[40:55]
    s_nop 9
    s_waitcnt vmcnt(6)
    v_mfma_f32_32x32x4_2b_bf16 v[56:87], v[220:221], v[170:171], 0 cbsz:1 abid:0
    buffer_load_dwordx4 v[188:191], v252, s[16:19], s49 offen sc1
    v_exp_f32 v24, v24
    v_exp_f32 v25, v25
    v_exp_f32 v26, v26
    v_exp_f32 v27, v27
    v_exp_f32 v28, v28
    v_exp_f32 v29, v29
    v_exp_f32 v30, v30
    s_waitcnt vmcnt(5)
    v_exp_f32 v31, v31
    v_cvt_pk_bf16_f32 v224, v24, v25
    v_cvt_pk_bf16_f32 v225, v26, v27
    v_cvt_pk_bf16_f32 v226, v28, v29
    v_cvt_pk_bf16_f32 v227, v30, v31
    v_exp_f32 v32, v32
    v_exp_f32 v33, v33
    v_mfma_f32_32x32x16_bf16 v[88:103], v[176:179], v[224:227], 0
    buffer_load_dwordx4 v[192:195], v252, s[16:19], s49 offen offset:2176 sc1
    s_add_u32 s49, s49, 8704
    v_exp_f32 v34, v34
    v_exp_f32 v35, v35
    v_exp_f32 v36, v36
    v_exp_f32 v37, v37
    v_exp_f32 v38, v38
    v_mfma_f32_32x32x16_bf16 v[56:71], v[172:175], v[160:163], v[56:71]
    buffer_load_dwordx4 v[196:199], v250, s[16:19], s47 offen offset:1024 sc1
    v_exp_f32 v39, v39
    v_cvt_pk_bf16_f32 v228, v32, v33
    v_cvt_pk_bf16_f32 v229, v34, v35
    v_cvt_pk_bf16_f32 v230, v36, v37
    v_cvt_pk_bf16_f32 v231, v38, v39
    v_exp_f32 v40, v40
    v_exp_f32 v41, v41
    v_mfma_f32_32x32x16_bf16 v[88:103], v[180:183], v[228:231], v[88:103]
    buffer_load_dwordx2 v[222:223], v253, s[16:19], s47 offen offset:1024 sc1
    v_exp_f32 v42, v42
    v_exp_f32 v43, v43
    v_exp_f32 v44, v44
    v_exp_f32 v45, v45
    v_exp_f32 v46, v46
    v_mfma_f32_32x32x16_bf16 v[72:87], v[172:175], v[164:167], v[72:87]
    buffer_store_dwordx4 v[244:247], v22, s[16:19], s23 offen sc1
    v_exp_f32 v47, v47
    v_cvt_pk_bf16_f32 v232, v40, v41
    v_cvt_pk_bf16_f32 v233, v42, v43
    v_cvt_pk_bf16_f32 v234, v44, v45
    v_cvt_pk_bf16_f32 v235, v46, v47
    v_exp_f32 v48, v48
    v_exp_f32 v49, v49
    v_exp_f32 v50, v50
    v_mfma_f32_32x32x16_bf16 v[104:119], v[176:179], v[232:235], 0
    s_waitcnt vmcnt(8)
    v_exp_f32 v51, v51
    v_exp_f32 v52, v52
    v_exp_f32 v53, v53
    v_exp_f32 v54, v54
    v_exp_f32 v55, v55
    v_cvt_pk_bf16_f32 v236, v48, v49
    v_cvt_pk_bf16_f32 v237, v50, v51
    v_cvt_pk_bf16_f32 v238, v52, v53
    v_cvt_pk_bf16_f32 v239, v54, v55
    v_mfma_f32_32x32x4_2b_bf16 v[24:55], v[220:221], v[168:169], 0 cbsz:1 abid:1
    s_mov_b32 exec_hi, 0
    buffer_store_dwordx4 v[4:7], v255, s[16:19], s24 offen offset:2048 sc1
    s_mov_b32 exec_hi, -1
    v_exp_f32 v56, v56
    v_exp_f32 v57, v57
    v_exp_f32 v58, v58
    v_exp_f32 v59, v59
    v_exp_f32 v60, v60
    v_exp_f32 v61, v61
    v_exp_f32 v62, v62
    v_mfma_f32_32x32x16_bf16 v[104:119], v[180:183], v[236:239], v[104:119]
    buffer_load_dwordx4 v[200:203], v252, s[16:19], s49 offen sc1
    v_exp_f32 v63, v63
    v_cvt_pk_bf16_f32 v224, v56, v57
    v_cvt_pk_bf16_f32 v225, v58, v59
    v_cvt_pk_bf16_f32 v226, v60, v61
    v_cvt_pk_bf16_f32 v227, v62, v63
    v_exp_f32 v64, v64
    v_exp_f32 v65, v65
    v_mfma_f32_32x32x16_bf16 v[120:135], v[176:179], v[224:227], 0
    buffer_load_dwordx4 v[204:207], v252, s[16:19], s49 offen offset:2176 sc1
    s_add_u32 s49, s49, 8704
    v_exp_f32 v66, v66
    v_exp_f32 v67, v67
    v_exp_f32 v68, v68
    v_exp_f32 v69, v69
    v_exp_f32 v70, v70
    v_mfma_f32_32x32x16_bf16 v[24:39], v[184:187], v[152:155], v[24:39]
    buffer_load_dwordx4 v[208:211], v250, s[16:19], s47 offen offset:1536 sc1
    v_exp_f32 v71, v71
    v_cvt_pk_bf16_f32 v228, v64, v65
    v_cvt_pk_bf16_f32 v229, v66, v67
    v_cvt_pk_bf16_f32 v230, v68, v69
    v_cvt_pk_bf16_f32 v231, v70, v71
    v_exp_f32 v72, v72
    v_exp_f32 v73, v73
    v_mfma_f32_32x32x16_bf16 v[120:135], v[180:183], v[228:231], v[120:135]
    v_exp_f32 v74, v74
    v_exp_f32 v75, v75
    v_exp_f32 v76, v76
    v_exp_f32 v77, v77
    v_exp_f32 v78, v78
    v_mfma_f32_32x32x16_bf16 v[40:55], v[184:187], v[156:159], v[40:55]
    v_exp_f32 v79, v79
    v_cvt_pk_bf16_f32 v232, v72, v73
    v_cvt_pk_bf16_f32 v233, v74, v75
    v_cvt_pk_bf16_f32 v234, v76, v77
    v_cvt_pk_bf16_f32 v235, v78, v79
    v_exp_f32 v80, v80
    v_exp_f32 v81, v81
    v_exp_f32 v82, v82
    v_mfma_f32_32x32x16_bf16 v[136:151], v[176:179], v[232:235], 0
    v_exp_f32 v83, v83
    v_exp_f32 v84, v84
    v_exp_f32 v85, v85
    v_exp_f32 v86, v86
    v_exp_f32 v87, v87
    v_cvt_pk_bf16_f32 v236, v80, v81
    v_cvt_pk_bf16_f32 v237, v82, v83
    v_cvt_pk_bf16_f32 v238, v84, v85
    v_cvt_pk_bf16_f32 v239, v86, v87
    v_mfma_f32_32x32x4_2b_bf16 v[56:87], v[220:221], v[170:171], 0 cbsz:1 abid:1
    v_exp_f32 v24, v24
    v_exp_f32 v25, v25
    v_exp_f32 v26, v26
    v_exp_f32 v27, v27
    v_exp_f32 v28, v28
    v_exp_f32 v29, v29
    v_exp_f32 v30, v30
    v_mfma_f32_32x32x16_bf16 v[136:151], v[180:183], v[236:239], v[136:151]
    s_waitcnt vmcnt(7)
    v_exp_f32 v31, v31
    v_cvt_pk_bf16_f32 v224, v24, v25
    v_cvt_pk_bf16_f32 v225, v26, v27
    v_cvt_pk_bf16_f32 v226, v28, v29
    v_cvt_pk_bf16_f32 v227, v30, v31
    v_exp_f32 v32, v32
    v_exp_f32 v33, v33
    v_mfma_f32_32x32x16_bf16 v[88:103], v[188:191], v[224:227], v[88:103]
    buffer_load_dwordx4 v[212:215], v252, s[16:19], s49 offen sc1
    v_exp_f32 v34, v34
    v_exp_f32 v35, v35
    v_exp_f32 v36, v36
    v_exp_f32 v37, v37
    v_exp_f32 v38, v38
    v_mfma_f32_32x32x16_bf16 v[56:71], v[184:187], v[160:163], v[56:71]
    buffer_load_dwordx4 v[216:219], v252, s[16:19], s49 offen offset:2176 sc1
    v_exp_f32 v39, v39
    v_cvt_pk_bf16_f32 v228, v32, v33
    v_cvt_pk_bf16_f32 v229, v34, v35
    v_cvt_pk_bf16_f32 v230, v36, v37
    v_cvt_pk_bf16_f32 v231, v38, v39
    v_exp_f32 v40, v40
    v_exp_f32 v41, v41
    v_mfma_f32_32x32x16_bf16 v[88:103], v[192:195], v[228:231], v[88:103]
    s_mul_i32 s49, s50, 34816
    v_exp_f32 v42, v42
    v_exp_f32 v43, v43
    v_exp_f32 v44, v44
    v_exp_f32 v45, v45
    v_exp_f32 v46, v46
    v_mfma_f32_32x32x16_bf16 v[72:87], v[184:187], v[164:167], v[72:87]
    s_waitcnt vmcnt(5)
    s_barrier
    s_mov_b64 exec, 1
    buffer_store_dword v3, off, s[16:19], s26 sc1
    s_mov_b64 exec, -1
    v_exp_f32 v47, v47
    v_cvt_pk_bf16_f32 v232, v40, v41
    v_cvt_pk_bf16_f32 v233, v42, v43
    v_cvt_pk_bf16_f32 v234, v44, v45
    v_cvt_pk_bf16_f32 v235, v46, v47
    v_exp_f32 v48, v48
    v_exp_f32 v49, v49
    v_exp_f32 v50, v50
    v_mfma_f32_32x32x16_bf16 v[104:119], v[188:191], v[232:235], v[104:119]
    s_waitcnt vmcnt(8)
    v_exp_f32 v51, v51
    v_exp_f32 v52, v52
    v_exp_f32 v53, v53
    v_exp_f32 v54, v54
    v_exp_f32 v55, v55
    v_cvt_pk_bf16_f32 v236, v48, v49
    v_cvt_pk_bf16_f32 v237, v50, v51
    v_cvt_pk_bf16_f32 v238, v52, v53
    v_cvt_pk_bf16_f32 v239, v54, v55
    v_mfma_f32_32x32x4_2b_bf16 v[24:55], v[222:223], v[168:169], 0 cbsz:1 abid:0
    buffer_load_dwordx4 v[172:175], v250, s[16:19], s48 offen offset:0 sc1
    v_exp_f32 v56, v56
    v_exp_f32 v57, v57
    v_exp_f32 v58, v58
    v_exp_f32 v59, v59
    v_exp_f32 v60, v60
    v_exp_f32 v61, v61
    v_exp_f32 v62, v62
    v_mfma_f32_32x32x16_bf16 v[104:119], v[192:195], v[236:239], v[104:119]
    buffer_load_dwordx2 v[220:221], v253, s[16:19], s48 offen offset:0 sc1
    v_exp_f32 v63, v63
    v_cvt_pk_bf16_f32 v224, v56, v57
    v_cvt_pk_bf16_f32 v225, v58, v59
    v_cvt_pk_bf16_f32 v226, v60, v61
    v_cvt_pk_bf16_f32 v227, v62, v63
    v_exp_f32 v64, v64
    v_exp_f32 v65, v65
    v_mfma_f32_32x32x16_bf16 v[120:135], v[188:191], v[224:227], v[120:135]
    v_exp_f32 v66, v66
    v_exp_f32 v67, v67
    v_exp_f32 v68, v68
    v_exp_f32 v69, v69
    v_exp_f32 v70, v70
    v_mfma_f32_32x32x16_bf16 v[24:39], v[196:199], v[152:155], v[24:39]
    v_exp_f32 v71, v71
    v_cvt_pk_bf16_f32 v228, v64, v65
    v_cvt_pk_bf16_f32 v229, v66, v67
    v_cvt_pk_bf16_f32 v230, v68, v69
    v_cvt_pk_bf16_f32 v231, v70, v71
    v_exp_f32 v72, v72
    v_exp_f32 v73, v73
    v_mfma_f32_32x32x16_bf16 v[120:135], v[192:195], v[228:231], v[120:135]
    v_exp_f32 v74, v74
    v_exp_f32 v75, v75
    v_exp_f32 v76, v76
    v_exp_f32 v77, v77
    v_exp_f32 v78, v78
    v_mfma_f32_32x32x16_bf16 v[40:55], v[196:199], v[156:159], v[40:55]
    v_exp_f32 v79, v79
    v_cvt_pk_bf16_f32 v232, v72, v73
    v_cvt_pk_bf16_f32 v233, v74, v75
    v_cvt_pk_bf16_f32 v234, v76, v77
    v_cvt_pk_bf16_f32 v235, v78, v79
    v_exp_f32 v80, v80
    v_exp_f32 v81, v81
    v_exp_f32 v82, v82
    v_mfma_f32_32x32x16_bf16 v[136:151], v[188:191], v[232:235], v[136:151]
    v_exp_f32 v83, v83
    v_exp_f32 v84, v84
    v_exp_f32 v85, v85
    v_exp_f32 v86, v86
    v_exp_f32 v87, v87
    v_cvt_pk_bf16_f32 v236, v80, v81
    v_cvt_pk_bf16_f32 v237, v82, v83
    v_cvt_pk_bf16_f32 v238, v84, v85
    v_cvt_pk_bf16_f32 v239, v86, v87
    v_mfma_f32_32x32x4_2b_bf16 v[56:87], v[222:223], v[170:171], 0 cbsz:1 abid:0
    v_exp_f32 v24, v24
    v_exp_f32 v25, v25
    v_exp_f32 v26, v26
    v_exp_f32 v27, v27
    v_exp_f32 v28, v28
    v_exp_f32 v29, v29
    v_exp_f32 v30, v30
    v_mfma_f32_32x32x16_bf16 v[136:151], v[192:195], v[236:239], v[136:151]
    s_waitcnt vmcnt(6)
    v_exp_f32 v31, v31
    v_cvt_pk_bf16_f32 v224, v24, v25
    v_cvt_pk_bf16_f32 v225, v26, v27
    v_cvt_pk_bf16_f32 v226, v28, v29
    v_cvt_pk_bf16_f32 v227, v30, v31
    v_exp_f32 v32, v32
    v_exp_f32 v33, v33
    v_mfma_f32_32x32x16_bf16 v[88:103], v[200:203], v[224:227], v[88:103]
    buffer_load_dwordx4 v[176:179], v252, s[16:19], s49 offen sc1
    v_exp_f32 v34, v34
    v_exp_f32 v35, v35
    v_exp_f32 v36, v36
    v_exp_f32 v37, v37
    v_exp_f32 v38, v38
    v_mfma_f32_32x32x16_bf16 v[56:71], v[196:199], v[160:163], v[56:71]
    buffer_load_dwordx4 v[180:183], v252, s[16:19], s49 offen offset:2176 sc1
    v_exp_f32 v39, v39
    v_cvt_pk_bf16_f32 v228, v32, v33
    v_cvt_pk_bf16_f32 v229, v34, v35
    v_cvt_pk_bf16_f32 v230, v36, v37
    v_cvt_pk_bf16_f32 v231, v38, v39
    v_exp_f32 v40, v40
    v_exp_f32 v41, v41
    v_mfma_f32_32x32x16_bf16 v[88:103], v[204:207], v[228:231], v[88:103]
    s_add_u32 s49, s49, 8704
    v_exp_f32 v42, v42
    v_exp_f32 v43, v43
    v_exp_f32 v44, v44
    v_exp_f32 v45, v45
    v_exp_f32 v46, v46
    v_mfma_f32_32x32x16_bf16 v[72:87], v[196:199], v[164:167], v[72:87]
    v_exp_f32 v47, v47
    v_cvt_pk_bf16_f32 v232, v40, v41
    v_cvt_pk_bf16_f32 v233, v42, v43
    v_cvt_pk_bf16_f32 v234, v44, v45
    v_cvt_pk_bf16_f32 v235, v46, v47
    v_exp_f32 v48, v48
    v_exp_f32 v49, v49
    v_exp_f32 v50, v50
    v_mfma_f32_32x32x16_bf16 v[104:119], v[200:203], v[232:235], v[104:119]
    s_waitcnt vmcnt(7)
    v_exp_f32 v51, v51
    v_exp_f32 v52, v52
    v_exp_f32 v53, v53
    v_exp_f32 v54, v54
    v_exp_f32 v55, v55
    v_cvt_pk_bf16_f32 v236, v48, v49
    v_cvt_pk_bf16_f32 v237, v50, v51
    v_cvt_pk_bf16_f32 v238, v52, v53
    v_cvt_pk_bf16_f32 v239, v54, v55
    v_mfma_f32_32x32x4_2b_bf16 v[24:55], v[222:223], v[168:169], 0 cbsz:1 abid:1
    buffer_load_dwordx4 v[184:187], v250, s[16:19], s48 offen offset:512 sc1
    v_exp_f32 v56, v56
    v_exp_f32 v57, v57
    v_exp_f32 v58, v58
    v_exp_f32 v59, v59
    v_exp_f32 v60, v60
    v_exp_f32 v61, v61
    v_exp_f32 v62, v62
    v_mfma_f32_32x32x16_bf16 v[104:119], v[204:207], v[236:239], v[104:119]
    v_exp_f32 v63, v63
    v_cvt_pk_bf16_f32 v224, v56, v57
    v_cvt_pk_bf16_f32 v225, v58, v59
    v_cvt_pk_bf16_f32 v226, v60, v61
    v_cvt_pk_bf16_f32 v227, v62, v63
    v_exp_f32 v64, v64
    v_exp_f32 v65, v65
    v_mfma_f32_32x32x16_bf16 v[120:135], v[200:203], v[224:227], v[120:135]
    s_add_u32 s3, s56, s54
    v_exp_f32 v66, v66
    v_exp_f32 v67, v67
    v_exp_f32 v68, v68
    v_exp_f32 v69, v69
    v_exp_f32 v70, v70
    v_mfma_f32_32x32x16_bf16 v[24:39], v[208:211], v[152:155], v[24:39]
    s_and_b32 s3, s3, 7
    v_exp_f32 v71, v71
    v_cvt_pk_bf16_f32 v228, v64, v65
    v_cvt_pk_bf16_f32 v229, v66, v67
    v_cvt_pk_bf16_f32 v230, v68, v69
    v_cvt_pk_bf16_f32 v231, v70, v71
    v_exp_f32 v72, v72
    v_exp_f32 v73, v73
    v_mfma_f32_32x32x16_bf16 v[120:135], v[204:207], v[228:231], v[120:135]
    s_lshl3_add_u32 s50, s57, s3
    v_exp_f32 v74, v74
    v_exp_f32 v75, v75
    v_exp_f32 v76, v76
    v_exp_f32 v77, v77
    v_exp_f32 v78, v78
    v_mfma_f32_32x32x16_bf16 v[40:55], v[208:211], v[156:159], v[40:55]
    s_lshl_b32 s59, s50, 11
    v_exp_f32 v79, v79
    v_cvt_pk_bf16_f32 v232, v72, v73
    v_cvt_pk_bf16_f32 v233, v74, v75
    v_cvt_pk_bf16_f32 v234, v76, v77
    v_cvt_pk_bf16_f32 v235, v78, v79
    v_exp_f32 v80, v80
    v_exp_f32 v81, v81
    v_exp_f32 v82, v82
    v_mfma_f32_32x32x16_bf16 v[136:151], v[200:203], v[232:235], v[136:151]
    s_add_u32 s59, s59, 2621440
    v_exp_f32 v83, v83
    v_exp_f32 v84, v84
    v_exp_f32 v85, v85
    v_exp_f32 v86, v86
    v_exp_f32 v87, v87
    v_cvt_pk_bf16_f32 v236, v80, v81
    v_cvt_pk_bf16_f32 v237, v82, v83
    v_cvt_pk_bf16_f32 v238, v84, v85
    v_cvt_pk_bf16_f32 v239, v86, v87
    v_mfma_f32_32x32x4_2b_bf16 v[56:87], v[222:223], v[170:171], 0 cbsz:1 abid:1
    v_mov_b32 v249, 11
    s_mov_b64 exec, 1
    buffer_store_dword v249, v248, s[16:19], 0 offen sc1
    s_mov_b64 exec, -1
    v_exp_f32 v24, v24
    v_exp_f32 v25, v25
    v_exp_f32 v26, v26
    v_exp_f32 v27, v27
    v_exp_f32 v28, v28
    v_exp_f32 v29, v29
    v_exp_f32 v30, v30
    v_mfma_f32_32x32x16_bf16 v[136:151], v[204:207], v[236:239], v[136:151]
    s_waitcnt vmcnt(7)
    v_exp_f32 v31, v31
    v_cvt_pk_bf16_f32 v224, v24, v25
    v_cvt_pk_bf16_f32 v225, v26, v27
    v_cvt_pk_bf16_f32 v226, v28, v29
    v_cvt_pk_bf16_f32 v227, v30, v31
    v_exp_f32 v32, v32
    v_exp_f32 v33, v33
    v_mfma_f32_32x32x16_bf16 v[88:103], v[212:215], v[224:227], v[88:103]
    buffer_load_dwordx4 v[188:191], v252, s[16:19], s49 offen sc1
    v_exp_f32 v34, v34
    v_exp_f32 v35, v35
    v_exp_f32 v36, v36
    v_exp_f32 v37, v37
    v_exp_f32 v38, v38
    v_mfma_f32_32x32x16_bf16 v[56:71], v[208:211], v[160:163], v[56:71]
    buffer_load_dwordx4 v[192:195], v252, s[16:19], s49 offen offset:2176 sc1
    v_exp_f32 v39, v39
    v_cvt_pk_bf16_f32 v228, v32, v33
    v_cvt_pk_bf16_f32 v229, v34, v35
    v_cvt_pk_bf16_f32 v230, v36, v37
    v_cvt_pk_bf16_f32 v231, v38, v39
    v_exp_f32 v40, v40
    v_exp_f32 v41, v41
    v_mfma_f32_32x32x16_bf16 v[88:103], v[216:219], v[228:231], v[88:103]
    s_add_u32 s49, s49, 8704
    v_exp_f32 v42, v42
    v_exp_f32 v43, v43
    v_exp_f32 v44, v44
    v_exp_f32 v45, v45
    v_exp_f32 v46, v46
    v_mfma_f32_32x32x16_bf16 v[72:87], v[208:211], v[164:167], v[72:87]
    v_exp_f32 v47, v47
    v_cvt_pk_bf16_f32 v232, v40, v41
    v_cvt_pk_bf16_f32 v233, v42, v43
    v_cvt_pk_bf16_f32 v234, v44, v45
    v_cvt_pk_bf16_f32 v235, v46, v47
    v_exp_f32 v48, v48
    v_exp_f32 v49, v49
    v_exp_f32 v50, v50
    v_mfma_f32_32x32x16_bf16 v[104:119], v[212:215], v[232:235], v[104:119]
    s_waitcnt vmcnt(6)
    v_exp_f32 v51, v51
    v_exp_f32 v52, v52
    v_exp_f32 v53, v53
    v_exp_f32 v54, v54
    v_exp_f32 v55, v55
    v_cvt_pk_bf16_f32 v236, v48, v49
    v_cvt_pk_bf16_f32 v237, v50, v51
    v_cvt_pk_bf16_f32 v238, v52, v53
    v_cvt_pk_bf16_f32 v239, v54, v55
    v_mfma_f32_32x32x4_2b_bf16 v[24:55], v[220:221], v[168:169], 0 cbsz:1 abid:0
    buffer_load_dwordx4 v[196:199], v250, s[16:19], s48 offen offset:1024 sc1
    v_exp_f32 v56, v56
    v_exp_f32 v57, v57
    v_exp_f32 v58, v58
    v_exp_f32 v59, v59
    v_exp_f32 v60, v60
    v_exp_f32 v61, v61
    v_exp_f32 v62, v62
    v_mfma_f32_32x32x16_bf16 v[104:119], v[216:219], v[236:239], v[104:119]
    buffer_load_dwordx2 v[222:223], v253, s[16:19], s48 offen offset:1024 sc1
    v_exp_f32 v63, v63
    v_cvt_pk_bf16_f32 v224, v56, v57
    v_cvt_pk_bf16_f32 v225, v58, v59
    v_cvt_pk_bf16_f32 v226, v60, v61
    v_cvt_pk_bf16_f32 v227, v62, v63
    v_exp_f32 v64, v64
    v_exp_f32 v65, v65
    v_mfma_f32_32x32x16_bf16 v[120:135], v[212:215], v[224:227], v[120:135]
    s_mov_b32 s47, s48
    v_exp_f32 v66, v66
    v_exp_f32 v67, v67
    v_exp_f32 v68, v68
    v_exp_f32 v69, v69
    v_exp_f32 v70, v70
    v_mfma_f32_32x32x16_bf16 v[24:39], v[172:175], v[152:155], v[24:39]
    s_mov_b32 s48, s59
    v_exp_f32 v71, v71
    v_cvt_pk_bf16_f32 v228, v64, v65
    v_cvt_pk_bf16_f32 v229, v66, v67
    v_cvt_pk_bf16_f32 v230, v68, v69
    v_cvt_pk_bf16_f32 v231, v70, v71
    v_exp_f32 v72, v72
    v_exp_f32 v73, v73
    v_mfma_f32_32x32x16_bf16 v[120:135], v[216:219], v[228:231], v[120:135]
    v_exp_f32 v74, v74
    v_exp_f32 v75, v75
    v_exp_f32 v76, v76
    v_exp_f32 v77, v77
    v_exp_f32 v78, v78
    v_mfma_f32_32x32x16_bf16 v[40:55], v[172:175], v[156:159], v[40:55]
    v_exp_f32 v79, v79
    v_cvt_pk_bf16_f32 v232, v72, v73
    v_cvt_pk_bf16_f32 v233, v74, v75
    v_cvt_pk_bf16_f32 v234, v76, v77
    v_cvt_pk_bf16_f32 v235, v78, v79
    v_exp_f32 v80, v80
    v_exp_f32 v81, v81
    v_exp_f32 v82, v82
    v_mfma_f32_32x32x16_bf16 v[136:151], v[212:215], v[232:235], v[136:151]
    v_exp_f32 v83, v83
    v_exp_f32 v84, v84
    v_exp_f32 v85, v85
    v_exp_f32 v86, v86
    v_exp_f32 v87, v87
    v_cvt_pk_bf16_f32 v236, v80, v81
    v_cvt_pk_bf16_f32 v237, v82, v83
    v_cvt_pk_bf16_f32 v238, v84, v85
    v_cvt_pk_bf16_f32 v239, v86, v87
    v_mfma_f32_32x32x4_2b_bf16 v[56:87], v[220:221], v[170:171], 0 cbsz:1 abid:0
    buffer_load_dword v2, v254, s[16:19], 0 offen sc1
    v_exp_f32 v24, v24
    v_exp_f32 v25, v25
    v_exp_f32 v26, v26
    v_exp_f32 v27, v27
    v_exp_f32 v28, v28
    v_exp_f32 v29, v29
    v_exp_f32 v30, v30
    v_mfma_f32_32x32x16_bf16 v[136:151], v[216:219], v[236:239], v[136:151]
    s_waitcnt vmcnt(7)
    v_exp_f32 v31, v31
    v_cvt_pk_bf16_f32 v224, v24, v25
    v_cvt_pk_bf16_f32 v225, v26, v27
    v_cvt_pk_bf16_f32 v226, v28, v29
    v_cvt_pk_bf16_f32 v227, v30, v31
    v_exp_f32 v32, v32
    v_exp_f32 v33, v33
    v_mfma_f32_32x32x16_bf16 v[88:103], v[176:179], v[224:227], v[88:103]
    buffer_load_dwordx4 v[200:203], v252, s[16:19], s49 offen sc1
    v_exp_f32 v34, v34
    v_exp_f32 v35, v35
    v_exp_f32 v36, v36
    v_exp_f32 v37, v37
    v_exp_f32 v38, v38
    v_mfma_f32_32x32x16_bf16 v[56:71], v[172:175], v[160:163], v[56:71]
    buffer_load_dwordx4 v[204:207], v252, s[16:19], s49 offen offset:2176 sc1
    v_exp_f32 v39, v39
    v_cvt_pk_bf16_f32 v228, v32, v33
    v_cvt_pk_bf16_f32 v229, v34, v35
    v_cvt_pk_bf16_f32 v230, v36, v37
    v_cvt_pk_bf16_f32 v231, v38, v39
    v_exp_f32 v40, v40
    v_exp_f32 v41, v41
    v_mfma_f32_32x32x16_bf16 v[88:103], v[180:183], v[228:231], v[88:103]
    s_add_u32 s49, s49, 8704
    v_exp_f32 v42, v42
    v_exp_f32 v43, v43
    v_exp_f32 v44, v44
    v_exp_f32 v45, v45
    v_exp_f32 v46, v46
    v_mfma_f32_32x32x16_bf16 v[72:87], v[172:175], v[164:167], v[72:87]
    v_exp_f32 v47, v47
    v_cvt_pk_bf16_f32 v232, v40, v41
    v_cvt_pk_bf16_f32 v233, v42, v43
    v_cvt_pk_bf16_f32 v234, v44, v45
    v_cvt_pk_bf16_f32 v235, v46, v47
    v_exp_f32 v48, v48
    v_exp_f32 v49, v49
    v_exp_f32 v50, v50
    v_mfma_f32_32x32x16_bf16 v[104:119], v[176:179], v[232:235], v[104:119]
    s_waitcnt vmcnt(8)
    v_exp_f32 v51, v51
    v_exp_f32 v52, v52
    v_exp_f32 v53, v53
    v_exp_f32 v54, v54
    v_exp_f32 v55, v55
    v_cvt_pk_bf16_f32 v236, v48, v49
    v_cvt_pk_bf16_f32 v237, v50, v51
    v_cvt_pk_bf16_f32 v238, v52, v53
    v_cvt_pk_bf16_f32 v239, v54, v55
    v_mfma_f32_32x32x4_2b_bf16 v[24:55], v[220:221], v[168:169], 0 cbsz:1 abid:1
    buffer_load_dwordx4 v[208:211], v250, s[16:19], s47 offen offset:1536 sc1
    v_exp_f32 v56, v56
    v_exp_f32 v57, v57
    v_exp_f32 v58, v58
    v_exp_f32 v59, v59
    v_exp_f32 v60, v60
    v_exp_f32 v61, v61
    v_exp_f32 v62, v62
    v_mfma_f32_32x32x16_bf16 v[104:119], v[180:183], v[236:239], v[104:119]
    v_exp_f32 v63, v63
    v_cvt_pk_bf16_f32 v224, v56, v57
    v_cvt_pk_bf16_f32 v225, v58, v59
    v_cvt_pk_bf16_f32 v226, v60, v61
    v_cvt_pk_bf16_f32 v227, v62, v63
    v_exp_f32 v64, v64
    v_exp_f32 v65, v65
    v_mfma_f32_32x32x16_bf16 v[120:135], v[176:179], v[224:227], v[120:135]
    v_exp_f32 v66, v66
    v_exp_f32 v67, v67
    v_exp_f32 v68, v68
    v_exp_f32 v69, v69
    v_exp_f32 v70, v70
    v_mfma_f32_32x32x16_bf16 v[24:39], v[184:187], v[152:155], v[24:39]
    v_exp_f32 v71, v71
    v_cvt_pk_bf16_f32 v228, v64, v65
    v_cvt_pk_bf16_f32 v229, v66, v67
    v_cvt_pk_bf16_f32 v230, v68, v69
    v_cvt_pk_bf16_f32 v231, v70, v71
    v_exp_f32 v72, v72
    v_exp_f32 v73, v73
    v_mfma_f32_32x32x16_bf16 v[120:135], v[180:183], v[228:231], v[120:135]
    v_exp_f32 v74, v74
    v_exp_f32 v75, v75
    v_exp_f32 v76, v76
    v_exp_f32 v77, v77
    v_exp_f32 v78, v78
    v_mfma_f32_32x32x16_bf16 v[40:55], v[184:187], v[156:159], v[40:55]
    v_exp_f32 v79, v79
    v_cvt_pk_bf16_f32 v232, v72, v73
    v_cvt_pk_bf16_f32 v233, v74, v75
    v_cvt_pk_bf16_f32 v234, v76, v77
    v_cvt_pk_bf16_f32 v235, v78, v79
    v_exp_f32 v80, v80
    v_exp_f32 v81, v81
    v_exp_f32 v82, v82
    v_mfma_f32_32x32x16_bf16 v[136:151], v[176:179], v[232:235], v[136:151]
    v_exp_f32 v83, v83
    v_exp_f32 v84, v84
    v_exp_f32 v85, v85
    v_exp_f32 v86, v86
    v_exp_f32 v87, v87
    v_cvt_pk_bf16_f32 v236, v80, v81
    v_cvt_pk_bf16_f32 v237, v82, v83
    v_cvt_pk_bf16_f32 v238, v84, v85
    v_cvt_pk_bf16_f32 v239, v86, v87
    v_mfma_f32_32x32x4_2b_bf16 v[56:87], v[220:221], v[170:171], 0 cbsz:1 abid:1
    v_exp_f32 v24, v24
    v_exp_f32 v25, v25
    v_exp_f32 v26, v26
    v_exp_f32 v27, v27
    v_exp_f32 v28, v28
    v_exp_f32 v29, v29
    v_exp_f32 v30, v30
    v_mfma_f32_32x32x16_bf16 v[136:151], v[180:183], v[236:239], v[136:151]
    s_waitcnt vmcnt(6)
    v_exp_f32 v31, v31
    v_cvt_pk_bf16_f32 v224, v24, v25
    v_cvt_pk_bf16_f32 v225, v26, v27
    v_cvt_pk_bf16_f32 v226, v28, v29
    v_cvt_pk_bf16_f32 v227, v30, v31
    v_exp_f32 v32, v32
    v_exp_f32 v33, v33
    v_mfma_f32_32x32x16_bf16 v[88:103], v[188:191], v[224:227], v[88:103]
    buffer_load_dwordx4 v[212:215], v252, s[16:19], s49 offen sc1
    v_exp_f32 v34, v34
    v_exp_f32 v35, v35
    v_exp_f32 v36, v36
    v_exp_f32 v37, v37
    v_exp_f32 v38, v38
    v_mfma_f32_32x32x16_bf16 v[56:71], v[184:187], v[160:163], v[56:71]
    buffer_load_dwordx4 v[216:219], v252, s[16:19], s49 offen offset:2176 sc1
    v_exp_f32 v39, v39
    v_cvt_pk_bf16_f32 v228, v32, v33
    v_cvt_pk_bf16_f32 v229, v34, v35
    v_cvt_pk_bf16_f32 v230, v36, v37
    v_cvt_pk_bf16_f32 v231, v38, v39
    v_exp_f32 v40, v40
    v_exp_f32 v41, v41
    v_mfma_f32_32x32x16_bf16 v[88:103], v[192:195], v[228:231], v[88:103]
    s_mul_i32 s49, s50, 34816
    v_exp_f32 v42, v42
    v_exp_f32 v43, v43
    v_exp_f32 v44, v44
    v_exp_f32 v45, v45
    v_exp_f32 v46, v46
    v_mfma_f32_32x32x16_bf16 v[72:87], v[184:187], v[164:167], v[72:87]
    v_exp_f32 v47, v47
    v_cvt_pk_bf16_f32 v232, v40, v41
    v_cvt_pk_bf16_f32 v233, v42, v43
    v_cvt_pk_bf16_f32 v234, v44, v45
    v_cvt_pk_bf16_f32 v235, v46, v47
    v_exp_f32 v48, v48
    v_exp_f32 v49, v49
    v_exp_f32 v50, v50
    v_mfma_f32_32x32x16_bf16 v[104:119], v[188:191], v[232:235], v[104:119]
    s_waitcnt vmcnt(5)
    v_cmp_ne_u32 vcc, 0x1010101, v2
    s_and_b32 s34, s34, vcc_lo
    s_cbranch_scc1 at_late_17
at_late_back_18:
    v_exp_f32 v51, v51
    v_exp_f32 v52, v52
    v_exp_f32 v53, v53
    v_exp_f32 v54, v54
    v_exp_f32 v55, v55
    v_cvt_pk_bf16_f32 v236, v48, v49
    v_cvt_pk_bf16_f32 v237, v50, v51
    v_cvt_pk_bf16_f32 v238, v52, v53
    v_cvt_pk_bf16_f32 v239, v54, v55
    v_mfma_f32_32x32x4_2b_bf16 v[24:55], v[222:223], v[168:169], 0 cbsz:1 abid:0
    buffer_load_dwordx4 v[172:175], v250, s[16:19], s48 offen offset:0 sc1
    v_exp_f32 v56, v56
    v_exp_f32 v57, v57
    v_exp_f32 v58, v58
    v_exp_f32 v59, v59
    v_exp_f32 v60, v60
    v_exp_f32 v61, v61
    v_exp_f32 v62, v62
    v_mfma_f32_32x32x16_bf16 v[104:119], v[192:195], v[236:239], v[104:119]
    buffer_load_dwordx2 v[220:221], v253, s[16:19], s48 offen offset:0 sc1
    v_exp_f32 v63, v63
    v_cvt_pk_bf16_f32 v224, v56, v57
    v_cvt_pk_bf16_f32 v225, v58, v59
    v_cvt_pk_bf16_f32 v226, v60, v61
    v_cvt_pk_bf16_f32 v227, v62, v63
    v_exp_f32 v64, v64
    v_exp_f32 v65, v65
    v_mfma_f32_32x32x16_bf16 v[120:135], v[188:191], v[224:227], v[120:135]
    s_add_u32 s54, s54, 1
    v_exp_f32 v66, v66
    v_exp_f32 v67, v67
    v_exp_f32 v68, v68
    v_exp_f32 v69, v69
    v_exp_f32 v70, v70
    v_mfma_f32_32x32x16_bf16 v[24:39], v[196:199], v[152:155], v[24:39]
    s_cmp_eq_u32 s54, 6
    v_exp_f32 v71, v71
    v_cvt_pk_bf16_f32 v228, v64, v65
    v_cvt_pk_bf16_f32 v229, v66, v67
    v_cvt_pk_bf16_f32 v230, v68, v69
    v_cvt_pk_bf16_f32 v231, v70, v71
    v_exp_f32 v72, v72
    v_exp_f32 v73, v73
    v_mfma_f32_32x32x16_bf16 v[120:135], v[192:195], v[228:231], v[120:135]
    s_cselect_b32 s54, 0, s54
    v_exp_f32 v74, v74
    v_exp_f32 v75, v75
    v_exp_f32 v76, v76
    v_exp_f32 v77, v77
    v_exp_f32 v78, v78
    v_mfma_f32_32x32x16_bf16 v[40:55], v[196:199], v[156:159], v[40:55]
    v_exp_f32 v79, v79
    v_cvt_pk_bf16_f32 v232, v72, v73
    v_cvt_pk_bf16_f32 v233, v74, v75
    v_cvt_pk_bf16_f32 v234, v76, v77
    v_cvt_pk_bf16_f32 v235, v78, v79
    v_exp_f32 v80, v80
    v_exp_f32 v81, v81
    v_exp_f32 v82, v82
    v_mfma_f32_32x32x16_bf16 v[136:151], v[188:191], v[232:235], v[136:151]
    v_exp_f32 v83, v83
    v_exp_f32 v84, v84
    v_exp_f32 v85, v85
    v_exp_f32 v86, v86
    v_exp_f32 v87, v87
    v_cvt_pk_bf16_f32 v236, v80, v81
    v_cvt_pk_bf16_f32 v237, v82, v83
    v_cvt_pk_bf16_f32 v238, v84, v85
    v_cvt_pk_bf16_f32 v239, v86, v87
    v_mfma_f32_32x32x4_2b_bf16 v[56:87], v[222:223], v[170:171], 0 cbsz:1 abid:0
    buffer_load_dword v2, v254, s[16:19], 0 offen sc1
    v_exp_f32 v24, v24
    v_exp_f32 v25, v25
    v_exp_f32 v26, v26
    v_exp_f32 v27, v27
    v_exp_f32 v28, v28
    v_exp_f32 v29, v29
    v_exp_f32 v30, v30
    v_mfma_f32_32x32x16_bf16 v[136:151], v[192:195], v[236:239], v[136:151]
    s_waitcnt vmcnt(6)
    v_exp_f32 v31, v31
    v_cvt_pk_bf16_f32 v224, v24, v25
    v_cvt_pk_bf16_f32 v225, v26, v27
    v_cvt_pk_bf16_f32 v226, v28, v29
    v_cvt_pk_bf16_f32 v227, v30, v31
    v_exp_f32 v32, v32
    v_exp_f32 v33, v33
    v_mfma_f32_32x32x16_bf16 v[88:103], v[200:203], v[224:227], v[88:103]
    buffer_load_dwordx4 v[176:179], v252, s[16:19], s49 offen sc1
    v_exp_f32 v34, v34
    v_exp_f32 v35, v35
    v_exp_f32 v36, v36
    v_exp_f32 v37, v37
    v_exp_f32 v38, v38
    v_mfma_f32_32x32x16_bf16 v[56:71], v[196:199], v[160:163], v[56:71]
    buffer_load_dwordx4 v[180:183], v252, s[16:19], s49 offen offset:2176 sc1
    v_exp_f32 v39, v39
    v_cvt_pk_bf16_f32 v228, v32, v33
    v_cvt_pk_bf16_f32 v229, v34, v35
    v_cvt_pk_bf16_f32 v230, v36, v37
    v_cvt_pk_bf16_f32 v231, v38, v39
    v_exp_f32 v40, v40
    v_exp_f32 v41, v41
    v_mfma_f32_32x32x16_bf16 v[88:103], v[204:207], v[228:231], v[88:103]
    s_add_u32 s49, s49, 8704
    v_exp_f32 v42, v42
    v_exp_f32 v43, v43
    v_exp_f32 v44, v44
    v_exp_f32 v45, v45
    v_exp_f32 v46, v46
    v_mfma_f32_32x32x16_bf16 v[72:87], v[196:199], v[164:167], v[72:87]
    v_exp_f32 v47, v47
    v_cvt_pk_bf16_f32 v232, v40, v41
    v_cvt_pk_bf16_f32 v233, v42, v43
    v_cvt_pk_bf16_f32 v234, v44, v45
    v_cvt_pk_bf16_f32 v235, v46, v47
    v_exp_f32 v48, v48
    v_exp_f32 v49, v49
    v_exp_f32 v50, v50
    v_mfma_f32_32x32x16_bf16 v[104:119], v[200:203], v[232:235], v[104:119]
    s_waitcnt vmcnt(7)
    v_exp_f32 v51, v51
    v_exp_f32 v52, v52
    v_exp_f32 v53, v53
    v_exp_f32 v54, v54
    v_exp_f32 v55, v55
    v_cvt_pk_bf16_f32 v236, v48, v49
    v_cvt_pk_bf16_f32 v237, v50, v51
    v_cvt_pk_bf16_f32 v238, v52, v53
    v_cvt_pk_bf16_f32 v239, v54, v55
    v_mfma_f32_32x32x4_2b_bf16 v[24:55], v[222:223], v[168:169], 0 cbsz:1 abid:1
    buffer_load_dwordx4 v[184:187], v250, s[16:19], s48 offen offset:512 sc1
    v_exp_f32 v56, v56
    v_exp_f32 v57, v57
    v_exp_f32 v58, v58
    v_exp_f32 v59, v59
    v_exp_f32 v60, v60
    v_exp_f32 v61, v61
    v_exp_f32 v62, v62
    v_mfma_f32_32x32x16_bf16 v[104:119], v[204:207], v[236:239], v[104:119]
    v_exp_f32 v63, v63
    v_cvt_pk_bf16_f32 v224, v56, v57
    v_cvt_pk_bf16_f32 v225, v58, v59
    v_cvt_pk_bf16_f32 v226, v60, v61
    v_cvt_pk_bf16_f32 v227, v62, v63
    v_exp_f32 v64, v64
    v_exp_f32 v65, v65
    v_mfma_f32_32x32x16_bf16 v[120:135], v[200:203], v[224:227], v[120:135]
    s_add_u32 s3, s56, s54
    v_exp_f32 v66, v66
    v_exp_f32 v67, v67
    v_exp_f32 v68, v68
    v_exp_f32 v69, v69
    v_exp_f32 v70, v70
    v_mfma_f32_32x32x16_bf16 v[24:39], v[208:211], v[152:155], v[24:39]
    s_and_b32 s3, s3, 7
    v_exp_f32 v71, v71
    v_cvt_pk_bf16_f32 v228, v64, v65
    v_cvt_pk_bf16_f32 v229, v66, v67
    v_cvt_pk_bf16_f32 v230, v68, v69
    v_cvt_pk_bf16_f32 v231, v70, v71
    v_exp_f32 v72, v72
    v_exp_f32 v73, v73
    v_mfma_f32_32x32x16_bf16 v[120:135], v[204:207], v[228:231], v[120:135]
    s_lshl3_add_u32 s50, s57, s3
    v_exp_f32 v74, v74
    v_exp_f32 v75, v75
    v_exp_f32 v76, v76
    v_exp_f32 v77, v77
    v_exp_f32 v78, v78
    v_mfma_f32_32x32x16_bf16 v[40:55], v[208:211], v[156:159], v[40:55]
    s_lshl_b32 s59, s50, 11
    v_exp_f32 v79, v79
    v_cvt_pk_bf16_f32 v232, v72, v73
    v_cvt_pk_bf16_f32 v233, v74, v75
    v_cvt_pk_bf16_f32 v234, v76, v77
    v_cvt_pk_bf16_f32 v235, v78, v79
    v_exp_f32 v80, v80
    v_exp_f32 v81, v81
    v_exp_f32 v82, v82
    v_mfma_f32_32x32x16_bf16 v[136:151], v[200:203], v[232:235], v[136:151]
    s_add_u32 s59, s59, 2621440
    v_exp_f32 v83, v83
    v_exp_f32 v84, v84
    v_exp_f32 v85, v85
    v_exp_f32 v86, v86
    v_exp_f32 v87, v87
    v_cvt_pk_bf16_f32 v236, v80, v81
    v_cvt_pk_bf16_f32 v237, v82, v83
    v_cvt_pk_bf16_f32 v238, v84, v85
    v_cvt_pk_bf16_f32 v239, v86, v87
    v_mfma_f32_32x32x4_2b_bf16 v[56:87], v[222:223], v[170:171], 0 cbsz:1 abid:1
    v_exp_f32 v24, v24
    v_exp_f32 v25, v25
    v_exp_f32 v26, v26
    v_exp_f32 v27, v27
    v_exp_f32 v28, v28
    v_exp_f32 v29, v29
    v_exp_f32 v30, v30
    v_mfma_f32_32x32x16_bf16 v[136:151], v[204:207], v[236:239], v[136:151]
    s_waitcnt vmcnt(6)
    v_exp_f32 v31, v31
    v_cvt_pk_bf16_f32 v224, v24, v25
    v_cvt_pk_bf16_f32 v225, v26, v27
    v_cvt_pk_bf16_f32 v226, v28, v29
    v_cvt_pk_bf16_f32 v227, v30, v31
    v_exp_f32 v32, v32
    v_exp_f32 v33, v33
    v_mfma_f32_32x32x16_bf16 v[88:103], v[212:215], v[224:227], v[88:103]
    buffer_load_dwordx4 v[188:191], v252, s[16:19], s49 offen sc1
    v_exp_f32 v34, v34
    v_exp_f32 v35, v35
    v_exp_f32 v36, v36
    v_exp_f32 v37, v37
    v_exp_f32 v38, v38
    v_mfma_f32_32x32x16_bf16 v[56:71], v[208:211], v[160:163], v[56:71]
    buffer_load_dwordx4 v[192:195], v252, s[16:19], s49 offen offset:2176 sc1
    v_exp_f32 v39, v39
    v_cvt_pk_bf16_f32 v228, v32, v33
    v_cvt_pk_bf16_f32 v229, v34, v35
    v_cvt_pk_bf16_f32 v230, v36, v37
    v_cvt_pk_bf16_f32 v231, v38, v39
    v_exp_f32 v40, v40
    v_exp_f32 v41, v41
    v_mfma_f32_32x32x16_bf16 v[88:103], v[216:219], v[228:231], v[88:103]
    s_add_u32 s49, s49, 8704
    v_exp_f32 v42, v42
    v_exp_f32 v43, v43
    v_exp_f32 v44, v44
    v_exp_f32 v45, v45
    v_exp_f32 v46, v46
    v_mfma_f32_32x32x16_bf16 v[72:87], v[208:211], v[164:167], v[72:87]
    buffer_store_dwordx4 v[8:11], v253, s[16:19], s55 offen sc1
    v_exp_f32 v47, v47
    v_cvt_pk_bf16_f32 v232, v40, v41
    v_cvt_pk_bf16_f32 v233, v42, v43
    v_cvt_pk_bf16_f32 v234, v44, v45
    v_cvt_pk_bf16_f32 v235, v46, v47
    v_exp_f32 v48, v48
    v_exp_f32 v49, v49
    v_exp_f32 v50, v50
    v_mfma_f32_32x32x16_bf16 v[104:119], v[212:215], v[232:235], v[104:119]
    s_waitcnt vmcnt(6)
    v_cmp_ne_u32 vcc, 0x1010101, v2
    s_cbranch_vccnz at_late_17b
at_late_back_18b:
    v_exp_f32 v51, v51
    v_exp_f32 v52, v52
    v_exp_f32 v53, v53
    v_exp_f32 v54, v54
    v_exp_f32 v55, v55
    v_cvt_pk_bf16_f32 v236, v48, v49
    v_cvt_pk_bf16_f32 v237, v50, v51
    v_cvt_pk_bf16_f32 v238, v52, v53
    v_cvt_pk_bf16_f32 v239, v54, v55
    v_mfma_f32_32x32x4_2b_bf16 v[24:55], v[220:221], v[168:169], 0 cbsz:1 abid:0
    buffer_load_dwordx4 v[196:199], v250, s[16:19], s48 offen offset:1024 sc1
    v_exp_f32 v56, v56
    v_exp_f32 v57, v57
    v_exp_f32 v58, v58
    v_exp_f32 v59, v59
    v_exp_f32 v60, v60
    v_exp_f32 v61, v61
    v_exp_f32 v62, v62
    v_mfma_f32_32x32x16_bf16 v[104:119], v[216:219], v[236:239], v[104:119]
    buffer_load_dwordx2 v[222:223], v253, s[16:19], s48 offen offset:1024 sc1
    v_exp_f32 v63, v63
    v_cvt_pk_bf16_f32 v224, v56, v57
    v_cvt_pk_bf16_f32 v225, v58, v59
    v_cvt_pk_bf16_f32 v226, v60, v61
    v_cvt_pk_bf16_f32 v227, v62, v63
    v_exp_f32 v64, v64
    v_exp_f32 v65, v65
    v_mfma_f32_32x32x16_bf16 v[120:135], v[212:215], v[224:227], v[120:135]
    s_mov_b32 s47, s48
    v_exp_f32 v66, v66
    v_exp_f32 v67, v67
    v_exp_f32 v68, v68
    v_exp_f32 v69, v69
    v_exp_f32 v70, v70
    v_mfma_f32_32x32x16_bf16 v[24:39], v[172:175], v[152:155], v[24:39]
    s_mov_b32 s48, s59
    v_exp_f32 v71, v71
    v_cvt_pk_bf16_f32 v228, v64, v65
    v_cvt_pk_bf16_f32 v229, v66, v67
    v_cvt_pk_bf16_f32 v230, v68, v69
    v_cvt_pk_bf16_f32 v231, v70, v71
    v_exp_f32 v72, v72
    v_exp_f32 v73, v73
    v_mfma_f32_32x32x16_bf16 v[120:135], v[216:219], v[228:231], v[120:135]
    v_exp_f32 v74, v74
    v_exp_f32 v75, v75
    v_exp_f32 v76, v76
    v_exp_f32 v77, v77
    v_exp_f32 v78, v78
    v_mfma_f32_32x32x16_bf16 v[40:55], v[172:175], v[156:159], v[40:55]
    v_exp_f32 v79, v79
    v_cvt_pk_bf16_f32 v232, v72, v73
    v_cvt_pk_bf16_f32 v233, v74, v75
    v_cvt_pk_bf16_f32 v234, v76, v77
    v_cvt_pk_bf16_f32 v235, v78, v79
    v_exp_f32 v80, v80
    v_exp_f32 v81, v81
    v_exp_f32 v82, v82
    v_mfma_f32_32x32x16_bf16 v[136:151], v[212:215], v[232:235], v[136:151]
    v_exp_f32 v83, v83
    v_exp_f32 v84, v84
    v_exp_f32 v85, v85
    v_exp_f32 v86, v86
    v_exp_f32 v87, v87
    v_cvt_pk_bf16_f32 v236, v80, v81
    v_cvt_pk_bf16_f32 v237, v82, v83
    v_cvt_pk_bf16_f32 v238, v84, v85
    v_cvt_pk_bf16_f32 v239, v86, v87
.p2align 6
at_loop_19:
    v_mfma_f32_32x32x4_2b_bf16 v[56:87], v[220:221], v[170:171], 0 cbsz:1 abid:0
    v_exp_f32 v24, v24
    v_exp_f32 v25, v25
    v_exp_f32 v26, v26
    v_exp_f32 v27, v27
    v_exp_f32 v28, v28
    v_exp_f32 v29, v29
    v_exp_f32 v30, v30
    v_mfma_f32_32x32x16_bf16 v[136:151], v[216:219], v[236:239], v[136:151]
    s_waitcnt vmcnt(5)
    v_exp_f32 v31, v31
    v_cvt_pk_bf16_f32 v224, v24, v25
    v_cvt_pk_bf16_f32 v225, v26, v27
    v_cvt_pk_bf16_f32 v226, v28, v29
    v_cvt_pk_bf16_f32 v227, v30, v31
    v_exp_f32 v32, v32
    v_exp_f32 v33, v33
    v_mfma_f32_32x32x16_bf16 v[88:103], v[176:179], v[224:227], v[88:103]
    buffer_load_dwordx4 v[200:203], v252, s[16:19], s49 offen sc1
    v_exp_f32 v34, v34
    v_exp_f32 v35, v35
    v_exp_f32 v36, v36
    v_exp_f32 v37, v37
    v_exp_f32 v38, v38
    v_mfma_f32_32x32x16_bf16 v[56:71], v[172:175], v[160:163], v[56:71]
    buffer_load_dwordx4 v[204:207], v252, s[16:19], s49 offen offset:2176 sc1
    v_exp_f32 v39, v39
    v_cvt_pk_bf16_f32 v228, v32, v33
    v_cvt_pk_bf16_f32 v229, v34, v35
    v_cvt_pk_bf16_f32 v230, v36, v37
    v_cvt_pk_bf16_f32 v231, v38, v39
    v_exp_f32 v40, v40
    v_exp_f32 v41, v41
    v_mfma_f32_32x32x16_bf16 v[88:103], v[180:183], v[228:231], v[88:103]
    s_add_u32 s49, s49, 8704
    v_exp_f32 v42, v42
    v_exp_f32 v43, v43
    v_exp_f32 v44, v44
    v_exp_f32 v45, v45
    v_exp_f32 v46, v46
    v_mfma_f32_32x32x16_bf16 v[72:87], v[172:175], v[164:167], v[72:87]
    v_exp_f32 v47, v47
    v_cvt_pk_bf16_f32 v232, v40, v41
    v_cvt_pk_bf16_f32 v233, v42, v43
    v_cvt_pk_bf16_f32 v234, v44, v45
    v_cvt_pk_bf16_f32 v235, v46, v47
    v_exp_f32 v48, v48
    v_exp_f32 v49, v49
    v_exp_f32 v50, v50
    v_mfma_f32_32x32x16_bf16 v[104:119], v[176:179], v[232:235], v[104:119]
    s_waitcnt vmcnt(6)
    v_exp_f32 v51, v51
    v_exp_f32 v52, v52
    v_exp_f32 v53, v53
    v_exp_f32 v54, v54
    v_exp_f32 v55, v55
    v_cvt_pk_bf16_f32 v236, v48, v49
    v_cvt_pk_bf16_f32 v237, v50, v51
    v_cvt_pk_bf16_f32 v238, v52, v53
    v_cvt_pk_bf16_f32 v239, v54, v55
    v_mfma_f32_32x32x4_2b_bf16 v[24:55], v[220:221], v[168:169], 0 cbsz:1 abid:1
    buffer_load_dwordx4 v[208:211], v250, s[16:19], s47 offen offset:1536 sc1
    v_exp_f32 v56, v56
    v_exp_f32 v57, v57
    v_exp_f32 v58, v58
    v_exp_f32 v59, v59
    v_exp_f32 v60, v60
    v_exp_f32 v61, v61
    v_exp_f32 v62, v62
    v_mfma_f32_32x32x16_bf16 v[104:119], v[180:183], v[236:239], v[104:119]
    v_exp_f32 v63, v63
    v_cvt_pk_bf16_f32 v224, v56, v57
    v_cvt_pk_bf16_f32 v225, v58, v59
    v_cvt_pk_bf16_f32 v226, v60, v61
    v_cvt_pk_bf16_f32 v227, v62, v63
    v_exp_f32 v64, v64
    v_exp_f32 v65, v65
    v_mfma_f32_32x32x16_bf16 v[120:135], v[176:179], v[224:227], v[120:135]
    v_exp_f32 v66, v66
    v_exp_f32 v67, v67
    v_exp_f32 v68, v68
    v_exp_f32 v69, v69
    v_exp_f32 v70, v70
    v_mfma_f32_32x32x16_bf16 v[24:39], v[184:187], v[152:155], v[24:39]
    v_exp_f32 v71, v71
    v_cvt_pk_bf16_f32 v228, v64, v65
    v_cvt_pk_bf16_f32 v229, v66, v67
    v_cvt_pk_bf16_f32 v230, v68, v69
    v_cvt_pk_bf16_f32 v231, v70, v71
    v_exp_f32 v72, v72
    v_exp_f32 v73, v73
    v_mfma_f32_32x32x16_bf16 v[120:135], v[180:183], v[228:231], v[120:135]
    v_exp_f32 v74, v74
    v_exp_f32 v75, v75
    v_exp_f32 v76, v76
    v_exp_f32 v77, v77
    v_exp_f32 v78, v78
    v_mfma_f32_32x32x16_bf16 v[40:55], v[184:187], v[156:159], v[40:55]
    v_exp_f32 v79, v79
    v_cvt_pk_bf16_f32 v232, v72, v73
    v_cvt_pk_bf16_f32 v233, v74, v75
    v_cvt_pk_bf16_f32 v234, v76, v77
    v_cvt_pk_bf16_f32 v235, v78, v79
    v_exp_f32 v80, v80
    v_exp_f32 v81, v81
    v_exp_f32 v82, v82
    v_mfma_f32_32x32x16_bf16 v[136:151], v[176:179], v[232:235], v[136:151]
    v_exp_f32 v83, v83
    v_exp_f32 v84, v84
    v_exp_f32 v85, v85
    v_exp_f32 v86, v86
    v_exp_f32 v87, v87
    v_cvt_pk_bf16_f32 v236, v80, v81
    v_cvt_pk_bf16_f32 v237, v82, v83
    v_cvt_pk_bf16_f32 v238, v84, v85
    v_cvt_pk_bf16_f32 v239, v86, v87
    v_mfma_f32_32x32x4_2b_bf16 v[56:87], v[220:221], v[170:171], 0 cbsz:1 abid:1
    v_exp_f32 v24, v24
    v_exp_f32 v25, v25
    v_exp_f32 v26, v26
    v_exp_f32 v27, v27
    v_exp_f32 v28, v28
    v_exp_f32 v29, v29
    v_exp_f32 v30, v30
    v_mfma_f32_32x32x16_bf16 v[136:151], v[180:183], v[236:239], v[136:151]
    s_waitcnt vmcnt(5)
    v_exp_f32 v31, v31
    v_cvt_pk_bf16_f32 v224, v24, v25
    v_cvt_pk_bf16_f32 v225, v26, v27
    v_cvt_pk_bf16_f32 v226, v28, v29
    v_cvt_pk_bf16_f32 v227, v30, v31
    v_exp_f32 v32, v32
    v_exp_f32 v33, v33
    v_mfma_f32_32x32x16_bf16 v[88:103], v[188:191], v[224:227], v[88:103]
    buffer_load_dwordx4 v[212:215], v252, s[16:19], s49 offen sc1
    v_exp_f32 v34, v34
    v_exp_f32 v35, v35
    v_exp_f32 v36, v36
    v_exp_f32 v37, v37
    v_exp_f32 v38, v38
    v_mfma_f32_32x32x16_bf16 v[56:71], v[184:187], v[160:163], v[56:71]
    buffer_load_dwordx4 v[216:219], v252, s[16:19], s49 offen offset:2176 sc1
    v_exp_f32 v39, v39
    v_cvt_pk_bf16_f32 v228, v32, v33
    v_cvt_pk_bf16_f32 v229, v34, v35
    v_cvt_pk_bf16_f32 v230, v36, v37
    v_cvt_pk_bf16_f32 v231, v38, v39
    v_exp_f32 v40, v40
    v_exp_f32 v41, v41
    v_mfma_f32_32x32x16_bf16 v[88:103], v[192:195], v[228:231], v[88:103]
    s_mul_i32 s49, s50, 34816
    v_exp_f32 v42, v42
    v_exp_f32 v43, v43
    v_exp_f32 v44, v44
    v_exp_f32 v45, v45
    v_exp_f32 v46, v46
    v_mfma_f32_32x32x16_bf16 v[72:87], v[184:187], v[164:167], v[72:87]
    v_exp_f32 v47, v47
    v_cvt_pk_bf16_f32 v232, v40, v41
    v_cvt_pk_bf16_f32 v233, v42, v43
    v_cvt_pk_bf16_f32 v234, v44, v45
    v_cvt_pk_bf16_f32 v235, v46, v47
    v_exp_f32 v48, v48
    v_exp_f32 v49, v49
    v_exp_f32 v50, v50
    v_mfma_f32_32x32x16_bf16 v[104:119], v[188:191], v[232:235], v[104:119]
    s_waitcnt vmcnt(5)
    v_exp_f32 v51, v51
    v_exp_f32 v52, v52
    v_exp_f32 v53, v53
    v_exp_f32 v54, v54
    v_exp_f32 v55, v55
    v_cvt_pk_bf16_f32 v236, v48, v49
    v_cvt_pk_bf16_f32 v237, v50, v51
    v_cvt_pk_bf16_f32 v238, v52, v53
    v_cvt_pk_bf16_f32 v239, v54, v55
    v_mfma_f32_32x32x4_2b_bf16 v[24:55], v[222:223], v[168:169], 0 cbsz:1 abid:0
    buffer_load_dwordx4 v[172:175], v250, s[16:19], s48 offen offset:0 sc1
    v_exp_f32 v56, v56
    v_exp_f32 v57, v57
    v_exp_f32 v58, v58
    v_exp_f32 v59, v59
    v_exp_f32 v60, v60
    v_exp_f32 v61, v61
    v_exp_f32 v62, v62
    v_mfma_f32_32x32x16_bf16 v[104:119], v[192:195], v[236:239], v[104:119]
    buffer_load_dwordx2 v[220:221], v253, s[16:19], s48 offen offset:0 sc1
    v_exp_f32 v63, v63
    v_cvt_pk_bf16_f32 v224, v56, v57
    v_cvt_pk_bf16_f32 v225, v58, v59
    v_cvt_pk_bf16_f32 v226, v60, v61
    v_cvt_pk_bf16_f32 v227, v62, v63
    v_exp_f32 v64, v64
    v_exp_f32 v65, v65
    v_mfma_f32_32x32x16_bf16 v[120:135], v[188:191], v[224:227], v[120:135]
    s_add_u32 s54, s54, 1
    v_exp_f32 v66, v66
    v_exp_f32 v67, v67
    v_exp_f32 v68, v68
    v_exp_f32 v69, v69
    v_exp_f32 v70, v70
    v_mfma_f32_32x32x16_bf16 v[24:39], v[196:199], v[152:155], v[24:39]
    s_cmp_eq_u32 s54, 6
    v_exp_f32 v71, v71
    v_cvt_pk_bf16_f32 v228, v64, v65
    v_cvt_pk_bf16_f32 v229, v66, v67
    v_cvt_pk_bf16_f32 v230, v68, v69
    v_cvt_pk_bf16_f32 v231, v70, v71
    v_exp_f32 v72, v72
    v_exp_f32 v73, v73
    v_mfma_f32_32x32x16_bf16 v[120:135], v[192:195], v[228:231], v[120:135]
    s_cselect_b32 s54, 0, s54
    v_exp_f32 v74, v74
    v_exp_f32 v75, v75
    v_exp_f32 v76, v76
    v_exp_f32 v77, v77
    v_exp_f32 v78, v78
    v_mfma_f32_32x32x16_bf16 v[40:55], v[196:199], v[156:159], v[40:55]
    v_exp_f32 v79, v79
    v_cvt_pk_bf16_f32 v232, v72, v73
    v_cvt_pk_bf16_f32 v233, v74, v75
    v_cvt_pk_bf16_f32 v234, v76, v77
    v_cvt_pk_bf16_f32 v235, v78, v79
    v_exp_f32 v80, v80
    v_exp_f32 v81, v81
    v_exp_f32 v82, v82
    v_mfma_f32_32x32x16_bf16 v[136:151], v[188:191], v[232:235], v[136:151]
    v_exp_f32 v83, v83
    v_exp_f32 v84, v84
    v_exp_f32 v85, v85
    v_exp_f32 v86, v86
    v_exp_f32 v87, v87
    v_cvt_pk_bf16_f32 v236, v80, v81
    v_cvt_pk_bf16_f32 v237, v82, v83
    v_cvt_pk_bf16_f32 v238, v84, v85
    v_cvt_pk_bf16_f32 v239, v86, v87
    v_mfma_f32_32x32x4_2b_bf16 v[56:87], v[222:223], v[170:171], 0 cbsz:1 abid:0
    v_exp_f32 v24, v24
    v_exp_f32 v25, v25
    v_exp_f32 v26, v26
    v_exp_f32 v27, v27
    v_exp_f32 v28, v28
    v_exp_f32 v29, v29
    v_exp_f32 v30, v30
    v_mfma_f32_32x32x16_bf16 v[136:151], v[192:195], v[236:239], v[136:151]
    s_waitcnt vmcnt(5)
    v_exp_f32 v31, v31
    v_cvt_pk_bf16_f32 v224, v24, v25
    v_cvt_pk_bf16_f32 v225, v26, v27
    v_cvt_pk_bf16_f32 v226, v28, v29
    v_cvt_pk_bf16_f32 v227, v30, v31
    v_exp_f32 v32, v32
    v_exp_f32 v33, v33
    v_mfma_f32_32x32x16_bf16 v[88:103], v[200:203], v[224:227], v[88:103]
    buffer_load_dwordx4 v[176:179], v252, s[16:19], s49 offen sc1
    v_exp_f32 v34, v34
    v_exp_f32 v35, v35
    v_exp_f32 v36, v36
    v_exp_f32 v37, v37
    v_exp_f32 v38, v38
    v_mfma_f32_32x32x16_bf16 v[56:71], v[196:199], v[160:163], v[56:71]
    buffer_load_dwordx4 v[180:183], v252, s[16:19], s49 offen offset:2176 sc1
    v_exp_f32 v39, v39
    v_cvt_pk_bf16_f32 v228, v32, v33
    v_cvt_pk_bf16_f32 v229, v34, v35
    v_cvt_pk_bf16_f32 v230, v36, v37
    v_cvt_pk_bf16_f32 v231, v38, v39
    v_exp_f32 v40, v40
    v_exp_f32 v41, v41
    v_mfma_f32_32x32x16_bf16 v[88:103], v[204:207], v[228:231], v[88:103]
    s_add_u32 s49, s49, 8704
    v_exp_f32 v42, v42
    v_exp_f32 v43, v43
    v_exp_f32 v44, v44
    v_exp_f32 v45, v45
    v_exp_f32 v46, v46
    v_mfma_f32_32x32x16_bf16 v[72:87], v[196:199], v[164:167], v[72:87]
    v_exp_f32 v47, v47
    v_cvt_pk_bf16_f32 v232, v40, v41
    v_cvt_pk_bf16_f32 v233, v42, v43
    v_cvt_pk_bf16_f32 v234, v44, v45
    v_cvt_pk_bf16_f32 v235, v46, v47
    v_exp_f32 v48, v48
    v_exp_f32 v49, v49
    v_exp_f32 v50, v50
    v_mfma_f32_32x32x16_bf16 v[104:119], v[200:203], v[232:235], v[104:119]
    s_waitcnt vmcnt(6)
    v_exp_f32 v51, v51
    v_exp_f32 v52, v52
    v_exp_f32 v53, v53
    v_exp_f32 v54, v54
    v_exp_f32 v55, v55
    v_cvt_pk_bf16_f32 v236, v48, v49
    v_cvt_pk_bf16_f32 v237, v50, v51
    v_cvt_pk_bf16_f32 v238, v52, v53
    v_cvt_pk_bf16_f32 v239, v54, v55
    v_mfma_f32_32x32x4_2b_bf16 v[24:55], v[222:223], v[168:169], 0 cbsz:1 abid:1
    buffer_load_dwordx4 v[184:187], v250, s[16:19], s48 offen offset:512 sc1
    v_exp_f32 v56, v56
    v_exp_f32 v57, v57
    v_exp_f32 v58, v58
    v_exp_f32 v59, v59
    v_exp_f32 v60, v60
    v_exp_f32 v61, v61
    v_exp_f32 v62, v62
    v_mfma_f32_32x32x16_bf16 v[104:119], v[204:207], v[236:239], v[104:119]
    v_exp_f32 v63, v63
    v_cvt_pk_bf16_f32 v224, v56, v57
    v_cvt_pk_bf16_f32 v225, v58, v59
    v_cvt_pk_bf16_f32 v226, v60, v61
    v_cvt_pk_bf16_f32 v227, v62, v63
    v_exp_f32 v64, v64
    v_exp_f32 v65, v65
    v_mfma_f32_32x32x16_bf16 v[120:135], v[200:203], v[224:227], v[120:135]
    s_add_u32 s3, s56, s54
    v_exp_f32 v66, v66
    v_exp_f32 v67, v67
    v_exp_f32 v68, v68
    v_exp_f32 v69, v69
    v_exp_f32 v70, v70
    v_mfma_f32_32x32x16_bf16 v[24:39], v[208:211], v[152:155], v[24:39]
    s_and_b32 s3, s3, 7
    v_exp_f32 v71, v71
    v_cvt_pk_bf16_f32 v228, v64, v65
    v_cvt_pk_bf16_f32 v229, v66, v67
    v_cvt_pk_bf16_f32 v230, v68, v69
    v_cvt_pk_bf16_f32 v231, v70, v71
    v_exp_f32 v72, v72
    v_exp_f32 v73, v73
    v_mfma_f32_32x32x16_bf16 v[120:135], v[204:207], v[228:231], v[120:135]
    s_lshl3_add_u32 s50, s57, s3
    v_exp_f32 v74, v74
    v_exp_f32 v75, v75
    v_exp_f32 v76, v76
    v_exp_f32 v77, v77
    v_exp_f32 v78, v78
    v_mfma_f32_32x32x16_bf16 v[40:55], v[208:211], v[156:159], v[40:55]
    s_lshl_b32 s59, s50, 11
    v_exp_f32 v79, v79
    v_cvt_pk_bf16_f32 v232, v72, v73
    v_cvt_pk_bf16_f32 v233, v74, v75
    v_cvt_pk_bf16_f32 v234, v76, v77
    v_cvt_pk_bf16_f32 v235, v78, v79
    v_exp_f32 v80, v80
    v_exp_f32 v81, v81
    v_exp_f32 v82, v82
    v_mfma_f32_32x32x16_bf16 v[136:151], v[200:203], v[232:235], v[136:151]
    s_add_u32 s59, s59, 2621440
    v_exp_f32 v83, v83
    v_exp_f32 v84, v84
    v_exp_f32 v85, v85
    v_exp_f32 v86, v86
    v_exp_f32 v87, v87
    v_cvt_pk_bf16_f32 v236, v80, v81
    v_cvt_pk_bf16_f32 v237, v82, v83
    v_cvt_pk_bf16_f32 v238, v84, v85
    v_cvt_pk_bf16_f32 v239, v86, v87
    v_mfma_f32_32x32x4_2b_bf16 v[56:87], v[222:223], v[170:171], 0 cbsz:1 abid:1
    v_exp_f32 v24, v24
    v_exp_f32 v25, v25
    v_exp_f32 v26, v26
    v_exp_f32 v27, v27
    v_exp_f32 v28, v28
    v_exp_f32 v29, v29
    v_exp_f32 v30, v30
    v_mfma_f32_32x32x16_bf16 v[136:151], v[204:207], v[236:239], v[136:151]
    s_waitcnt vmcnt(5)
    v_exp_f32 v31, v31
    v_cvt_pk_bf16_f32 v224, v24, v25
    v_cvt_pk_bf16_f32 v225, v26, v27
    v_cvt_pk_bf16_f32 v226, v28, v29
    v_cvt_pk_bf16_f32 v227, v30, v31
    v_exp_f32 v32, v32
    v_exp_f32 v33, v33
    v_mfma_f32_32x32x16_bf16 v[88:103], v[212:215], v[224:227], v[88:103]
    buffer_load_dwordx4 v[188:191], v252, s[16:19], s49 offen sc1
    v_exp_f32 v34, v34
    v_exp_f32 v35, v35
    v_exp_f32 v36, v36
    v_exp_f32 v37, v37
    v_exp_f32 v38, v38
    v_mfma_f32_32x32x16_bf16 v[56:71], v[208:211], v[160:163], v[56:71]
    buffer_load_dwordx4 v[192:195], v252, s[16:19], s49 offen offset:2176 sc1
    v_exp_f32 v39, v39
    v_cvt_pk_bf16_f32 v228, v32, v33
    v_cvt_pk_bf16_f32 v229, v34, v35
    v_cvt_pk_bf16_f32 v230, v36, v37
    v_cvt_pk_bf16_f32 v231, v38, v39
    v_exp_f32 v40, v40
    v_exp_f32 v41, v41
    v_mfma_f32_32x32x16_bf16 v[88:103], v[216:219], v[228:231], v[88:103]
    s_add_u32 s49, s49, 8704
    v_exp_f32 v42, v42
    v_exp_f32 v43, v43
    v_exp_f32 v44, v44
    v_exp_f32 v45, v45
    v_exp_f32 v46, v46
    v_mfma_f32_32x32x16_bf16 v[72:87], v[208:211], v[164:167], v[72:87]
    v_exp_f32 v47, v47
    v_cvt_pk_bf16_f32 v232, v40, v41
    v_cvt_pk_bf16_f32 v233, v42, v43
    v_cvt_pk_bf16_f32 v234, v44, v45
    v_cvt_pk_bf16_f32 v235, v46, v47
    v_exp_f32 v48, v48
    v_exp_f32 v49, v49
    v_exp_f32 v50, v50
    v_mfma_f32_32x32x16_bf16 v[104:119], v[212:215], v[232:235], v[104:119]
    s_waitcnt vmcnt(5)
    v_exp_f32 v51, v51
    v_exp_f32 v52, v52
    v_exp_f32 v53, v53
    v_exp_f32 v54, v54
    v_exp_f32 v55, v55
    v_cvt_pk_bf16_f32 v236, v48, v49
    v_cvt_pk_bf16_f32 v237, v50, v51
    v_cvt_pk_bf16_f32 v238, v52, v53
    v_cvt_pk_bf16_f32 v239, v54, v55
    v_mfma_f32_32x32x4_2b_bf16 v[24:55], v[220:221], v[168:169], 0 cbsz:1 abid:0
    buffer_load_dwordx4 v[196:199], v250, s[16:19], s48 offen offset:1024 sc1
    v_exp_f32 v56, v56
    v_exp_f32 v57, v57
    v_exp_f32 v58, v58
    v_exp_f32 v59, v59
    v_exp_f32 v60, v60
    v_exp_f32 v61, v61
    v_exp_f32 v62, v62
    v_mfma_f32_32x32x16_bf16 v[104:119], v[216:219], v[236:239], v[104:119]
    buffer_load_dwordx2 v[222:223], v253, s[16:19], s48 offen offset:1024 sc1
    v_exp_f32 v63, v63
    v_cvt_pk_bf16_f32 v224, v56, v57
    v_cvt_pk_bf16_f32 v225, v58, v59
    v_cvt_pk_bf16_f32 v226, v60, v61
    v_cvt_pk_bf16_f32 v227, v62, v63
    v_exp_f32 v64, v64
    v_exp_f32 v65, v65
    v_mfma_f32_32x32x16_bf16 v[120:135], v[212:215], v[224:227], v[120:135]
    s_mov_b32 s47, s48
    v_exp_f32 v66, v66
    v_exp_f32 v67, v67
    v_exp_f32 v68, v68
    v_exp_f32 v69, v69
    v_exp_f32 v70, v70
    v_mfma_f32_32x32x16_bf16 v[24:39], v[172:175], v[152:155], v[24:39]
    s_mov_b32 s48, s59
    v_exp_f32 v71, v71
    v_cvt_pk_bf16_f32 v228, v64, v65
    v_cvt_pk_bf16_f32 v229, v66, v67
    v_cvt_pk_bf16_f32 v230, v68, v69
    v_cvt_pk_bf16_f32 v231, v70, v71
    v_exp_f32 v72, v72
    v_exp_f32 v73, v73
    v_mfma_f32_32x32x16_bf16 v[120:135], v[216:219], v[228:231], v[120:135]
    s_sub_u32 s46, s46, 1
    v_exp_f32 v74, v74
    v_exp_f32 v75, v75
    v_exp_f32 v76, v76
    v_exp_f32 v77, v77
    v_exp_f32 v78, v78
    v_mfma_f32_32x32x16_bf16 v[40:55], v[172:175], v[156:159], v[40:55]
    v_exp_f32 v79, v79
    v_cvt_pk_bf16_f32 v232, v72, v73
    v_cvt_pk_bf16_f32 v233, v74, v75
    v_cvt_pk_bf16_f32 v234, v76, v77
    v_cvt_pk_bf16_f32 v235, v78, v79
    v_exp_f32 v80, v80
    v_exp_f32 v81, v81
    v_exp_f32 v82, v82
    v_mfma_f32_32x32x16_bf16 v[136:151], v[212:215], v[232:235], v[136:151]
    s_cmp_lg_u32 s46, 0
    v_exp_f32 v83, v83
    v_exp_f32 v84, v84
    v_exp_f32 v85, v85
    v_exp_f32 v86, v86
    v_exp_f32 v87, v87
    v_cvt_pk_bf16_f32 v236, v80, v81
    v_cvt_pk_bf16_f32 v237, v82, v83
    v_cvt_pk_bf16_f32 v238, v84, v85
    v_cvt_pk_bf16_f32 v239, v86, v87
    s_cbranch_scc1 at_loop_19
    s_mul_i32 s3, s32, 6144
    s_add_u32 s3, s3, 0
    v_mfma_f32_32x32x16_bf16 v[136:151], v[216:219], v[236:239], v[136:151]
    v_mov_b32 v249, 15
    s_mov_b64 exec, 1
    buffer_store_dword v249, v248, s[16:19], 0 offen sc1
    s_mov_b64 exec, -1
    v_lshl_add_u32 v4, v1, 4, s3
    ds_write_b128 v4, v[120:123] offset:0
    ds_write_b128 v4, v[124:127] offset:1024
    ds_write_b128 v4, v[128:131] offset:2048
    s_xor_b32 s3, s32, 2
    s_mul_i32 s3, s3, 6144
    s_add_u32 s3, s3, 0
    v_lshl_add_u32 v5, v1, 4, s3
    v_or_b32 v6, 32, v1
    v_lshl_add_u32 v6, v6, 4, s3
    s_add_u32 s60, s60, 8126464
    s_nop 0
    ds_write_b128 v4, v[136:139] offset:3072
    ds_write_b128 v4, v[140:143] offset:4096
    ds_write_b128 v4, v[144:147] offset:5120
    s_waitcnt lgkmcnt(0)
    s_barrier
    ds_read_b32 v132, v6 offset:2048
    ds_read_b128 v[120:123], v5 offset:0
    ds_read_b128 v[124:127], v5 offset:1024
    ds_read_b128 v[128:131], v5 offset:2048
    ds_read_b32 v148, v6 offset:5120
    ds_read_b128 v[136:139], v5 offset:3072
    ds_read_b128 v[140:143], v5 offset:4096
    ds_read_b128 v[144:147], v5 offset:5120
    s_waitcnt lgkmcnt(4)
    v_add_f32 v100, v100, v132
    v_pk_add_f32 v[88:89], v[88:89], v[120:121]
    v_pk_add_f32 v[90:91], v[90:91], v[122:123]
    v_pk_add_f32 v[92:93], v[92:93], v[124:125]
    v_pk_add_f32 v[94:95], v[94:95], v[126:127]
    v_pk_add_f32 v[96:97], v[96:97], v[128:129]
    v_pk_add_f32 v[98:99], v[98:99], v[130:131]
    s_waitcnt lgkmcnt(0)
    v_add_f32 v116, v116, v148
    v_pk_add_f32 v[104:105], v[104:105], v[136:137]
    v_pk_add_f32 v[106:107], v[106:107], v[138:139]
    v_pk_add_f32 v[108:109], v[108:109], v[140:141]
    v_pk_add_f32 v[110:111], v[110:111], v[142:143]
    v_pk_add_f32 v[112:113], v[112:113], v[144:145]
    v_pk_add_f32 v[114:115], v[114:115], v[146:147]
    s_mov_b32 s33, 0
at_back_21:
    v_rcp_f32 v102, v100
    v_rcp_f32 v118, v116
    v_pk_mul_f32 v[88:89], v[88:89], v[102:103] op_sel_hi:[1,0]
    v_pk_mul_f32 v[90:91], v[90:91], v[102:103] op_sel_hi:[1,0]
    v_pk_mul_f32 v[92:93], v[92:93], v[102:103] op_sel_hi:[1,0]
    v_pk_mul_f32 v[94:95], v[94:95], v[102:103] op_sel_hi:[1,0]
    v_pk_mul_f32 v[96:97], v[96:97], v[102:103] op_sel_hi:[1,0]
    v_pk_mul_f32 v[98:99], v[98:99], v[102:103] op_sel_hi:[1,0]
    v_cvt_pk_bf16_f32 v120, v88, v89
    v_cvt_pk_bf16_f32 v121, v90, v91
    v_cvt_pk_bf16_f32 v122, v92, v93
    v_cvt_pk_bf16_f32 v123, v94, v95
    v_cvt_pk_bf16_f32 v124, v96, v97
    v_cvt_pk_bf16_f32 v125, v98, v99
    buffer_store_dwordx4 v[120:123], v250, s[16:19], s60 offen offset:0 sc1
    v_pk_mul_f32 v[104:105], v[104:105], v[118:119] op_sel_hi:[1,0]
    v_pk_mul_f32 v[106:107], v[106:107], v[118:119] op_sel_hi:[1,0]
    v_pk_mul_f32 v[108:109], v[108:109], v[118:119] op_sel_hi:[1,0]
    v_pk_mul_f32 v[110:111], v[110:111], v[118:119] op_sel_hi:[1,0]
    v_pk_mul_f32 v[112:113], v[112:113], v[118:119] op_sel_hi:[1,0]
    v_pk_mul_f32 v[114:115], v[114:115], v[118:119] op_sel_hi:[1,0]
    v_cvt_pk_bf16_f32 v136, v104, v105
    v_cvt_pk_bf16_f32 v137, v106, v107
    v_cvt_pk_bf16_f32 v138, v108, v109
    v_cvt_pk_bf16_f32 v139, v110, v111
    v_cvt_pk_bf16_f32 v140, v112, v113
    v_cvt_pk_bf16_f32 v141, v114, v115
    buffer_store_dwordx4 v[136:139], v250, s[16:19], s60 offen offset:512 sc1
    s_mov_b32 exec_hi, 0
    buffer_store_dwordx2 v[124:125], v251, s[16:19], s60 offen offset:0 sc1
    buffer_store_dwordx2 v[140:141], v251, s[16:19], s60 offen offset:512 sc1
    s_mov_b32 exec_hi, -1
    s_cmp_lg_u32 s33, 0
    s_cbranch_scc1 at_fin_22
    v_pk_add_f32 v[4:5], v[88:89], v[90:91]
    v_pk_add_f32 v[6:7], v[104:105], v[106:107]
    v_pk_add_f32 v[4:5], v[4:5], v[92:93]
    v_pk_add_f32 v[6:7], v[6:7], v[108:109]
    v_pk_add_f32 v[4:5], v[4:5], v[94:95]
    v_pk_add_f32 v[6:7], v[6:7], v[110:111]
    v_pk_add_f32 v[4:5], v[4:5], v[96:97]
    v_pk_add_f32 v[6:7], v[6:7], v[112:113]
    v_pk_add_f32 v[4:5], v[4:5], v[98:99]
    v_pk_add_f32 v[6:7], v[6:7], v[114:115]
    v_min_f32 v8, v100, v116
    v_pk_add_f32 v[4:5], v[4:5], v[6:7]
    v_add_f32 v9, v100, v116
    v_cmp_nlt_f32 vcc, 0x2b800000, v8
    v_add_f32 v4, v4, v5
    s_mov_b64 s[4:5], vcc
    v_fma_f32 v9, v4, 0, v9
    v_cmp_ngt_f32 vcc, 0x53800000, v9
    s_or_b64 s[4:5], s[4:5], vcc
    s_cbranch_scc1 at_slow_20
at_fin_22:
    v_mov_b32 v2, 1
    v_lshlrev_b32 v3, 7, v1
    s_waitcnt vmcnt(0)
    s_barrier
    s_cmp_lg_u32 s32, 0
    s_cbranch_scc1 no_fl_23
    s_mov_b64 exec, 0xffff
    buffer_store_byte v2, v3, s[16:19], s63 offen sc1
    s_mov_b64 exec, -1
no_fl_23:
end_2:
    s_endpgm
aux_1:
    s_sub_u32 s2, s2, 256
    s_cmp_ge_u32 s2, 256
    s_cbranch_scc1 end_2
    s_load_dwordx2 s[12:13], s[0:1], 32
    s_load_dwordx2 s[64:65], s[0:1], 40
    s_load_dwordx2 s[68:69], s[0:1], 48
    s_load_dwordx2 s[72:73], s[0:1], 56
    s_load_dwordx2 s[76:77], s[0:1], 64
    s_load_dwordx2 s[80:81], s[0:1], 72
    s_load_dwordx2 s[8:9], s[0:1], 24
    s_load_dwordx2 s[20:21], s[0:1], 16
    s_load_dwordx2 s[24:25], s[0:1], 80
    s_load_dwordx2 s[28:29], s[0:1], 88
    s_load_dwordx2 s[16:17], s[0:1], 96
    s_mov_b32 s14, 163840
    s_mov_b32 s15, 0x20000
    s_mov_b32 s66, 163840
    s_mov_b32 s67, 0x20000
    s_mov_b32 s70, 163840
    s_mov_b32 s71, 0x20000
    s_mov_b32 s74, 163840
    s_mov_b32 s75, 0x20000
    s_mov_b32 s10, 2621440
    s_mov_b32 s11, 0x20000
    s_mov_b32 s22, 819200
    s_mov_b32 s23, 0x20000
    s_mov_b32 s26, 5242880
    s_mov_b32 s27, 0x20000
    s_mov_b32 s30, 256
    s_mov_b32 s31, 0x20000
    s_mov_b32 s18, 16777216
    s_mov_b32 s19, 0x20000
    s_mov_b32 s57, s2
    s_mov_b32 s33, s57
    s_lshl_b32 s56, s2, 7
    s_add_u32 s56, s56, 16089088
    s_lshl_b32 s52, s32, 28
    s_or_b32 s52, s52, s56
    v_mov_b32 v3, 0
    s_waitcnt lgkmcnt(0)
    s_mov_b64 exec, 1
    buffer_store_dword v3, v3, s[16:19], s52 offen sc1
    s_mov_b64 exec, -1
    s_cmp_ge_u32 s57, 160
    s_cbranch_scc1 aux_l_24
    s_waitcnt vmcnt(0)
    s_cmp_lg_u32 s32, 0
    s_cbranch_scc1 aux_hw_31
    s_mov_b32 s58, 64
spin_top_32:
    s_load_dword s3, s[16:17], s56 glc
    s_waitcnt lgkmcnt(0)
    s_and_b32 s3, s3, 31
    s_cbranch_scc1 spin_ok_33
    s_sub_u32 s58, s58, 1
    s_cbranch_scc1 spin_ok_33
    s_sleep 3
    s_branch spin_top_32
spin_ok_33:
aux_hw_31:
    s_barrier
    s_lshl2_add_u32 s4, s33, s32
    s_lshl_b32 s5, s4, 8
    s_lshr_b32 s4, s4, 1
    s_lshl_b32 s4, s4, 2
    v_lshlrev_b32 v2, 2, v1
    buffer_load_dword v224, v2, s[12:15], s5 offen
    buffer_load_dword v225, v2, s[64:67], s5 offen
    buffer_load_dword v226, v2, s[68:71], s5 offen
    buffer_load_dword v227, v2, s[72:75], s5 offen
    s_load_dword s54, s[76:77], s4
    s_load_dword s55, s[80:81], s4
    s_lshr_b32 s34, s33, 4
    s_and_b32 s35, s33, 15
    s_mul_i32 s40, s32, 20480
    s_mul_i32 s62, s34, 128
    s_add_u32 s62, s62, 16084992
    s_add_u32 s59, s62, s35
    s_add_u32 s59, s59, 1280
    s_and_b32 s3, s32, 1
    s_lshl_b32 s3, s3, 4
    s_waitcnt lgkmcnt(0)
    s_lshr_b32 s54, s54, s3
    s_lshr_b32 s55, s55, s3
    v_mov_b32 v228, s54
    v_mov_b32 v229, s55
    s_waitcnt vmcnt(0)
    v_lshl_add_u32 v219, v1, 3, s40
    v_and_b32 v8, 31, v1
    v_mul_u32_u24 v8, 528, v8
    v_lshrrev_b32 v9, 5, v1
    v_lshl_add_u32 v8, v9, 4, v8
    v_add_u32 v220, s40, v8
    v_lshlrev_b32 v218, 16, v228
    v_lshlrev_b32 v8, 16, v224
    v_and_b32 v9, 0xffff0000, v224
    v_mul_f32 v218, 0x3fb8aa3b, v218
    v_mul_f32 v8, 0x3fb8aa3b, v8
    v_mul_f32 v9, 0x3fb8aa3b, v9
    v_exp_f32 v218, v218
    v_exp_f32 v8, v8
    v_exp_f32 v9, v9
    v_lshlrev_b32 v18, 16, v225
    v_and_b32 v19, 0xffff0000, v225
    v_cvt_pk_bf16_f32 v218, v218, v218
    v_cvt_pk_bf16_f32 v8, v8, v9
    v_and_b32 v218, 0xffff0000, v218
    v_lshlrev_b32 v16, 16, v8
    v_and_b32 v17, 0xffff0000, v8
    v_mul_f32 v16, v16, v218
    v_mul_f32 v17, v17, v218
    v_mul_f32 v18, v18, v218
    v_mul_f32 v19, v19, v218
    v_mul_f32 v16, 0xbfb8aa3b, v16
    v_mul_f32 v17, 0xbfb8aa3b, v17
    v_mul_f32 v18, 0x3e22f983, v18
    v_mul_f32 v19, 0x3e22f983, v19
    v_mul_f32 v12, 0x42000000, v16
    v_mul_f32 v14, 0x42000000, v18
    v_mul_f32 v13, 0x42000000, v17
    v_mul_f32 v15, 0x42000000, v19
    v_exp_f32 v8, v16
    v_fract_f32 v10, v18
    v_exp_f32 v12, v12
    v_fract_f32 v14, v14
    v_exp_f32 v9, v17
    v_fract_f32 v11, v19
    v_exp_f32 v13, v13
    v_fract_f32 v15, v15
    v_cos_f32 v20, v10
    v_sin_f32 v22, v10
    v_cos_f32 v21, v11
    v_sin_f32 v23, v11
    v_cos_f32 v28, v14
    v_sin_f32 v30, v14
    v_cos_f32 v29, v15
    v_sin_f32 v31, v15
    v_and_b32 v58, 0x7fff7fff, v226
    v_and_b32 v59, 0x7fff7fff, v227
    v_pk_max_i16 v58, v58, v59
    v_pk_mul_f32 v[20:21], v[20:21], v[8:9]
    v_pk_mul_f32 v[22:23], v[22:23], v[8:9]
    v_pk_mul_f32 v[28:29], v[28:29], v[12:13]
    v_pk_mul_f32 v[30:31], v[30:31], v[12:13]
    v_lshlrev_b32 v59, 16, v58
    v_max_u32 v58, v58, v59
    v_cvt_pk_f16_f32 v36, v20, v22
    v_cvt_pk_f16_f32 v46, v28, v30
    v_cvt_pk_f16_f32 v37, v21, v23
    v_cvt_pk_f16_f32 v47, v29, v31
    v_pk_mul_f32 v[24:25], v[22:23], v[22:23]
    v_pk_mul_f32 v[32:33], v[30:31], v[30:31]
    v_pk_add_f32 v[26:27], v[20:21], v[20:21]
    v_pk_add_f32 v[34:35], v[28:29], v[28:29]
    v_pk_fma_f32 v[20:21], v[20:21], v[20:21], v[24:25] neg_lo:[0,0,1] neg_hi:[0,0,1]
    v_pk_fma_f32 v[28:29], v[28:29], v[28:29], v[32:33] neg_lo:[0,0,1] neg_hi:[0,0,1]
    v_pk_mul_f32 v[22:23], v[26:27], v[22:23]
    v_pk_mul_f32 v[30:31], v[34:35], v[30:31]
    v_max_u32_dpp v58, v58, v58 row_ror:8 row_mask:0xf bank_mask:0xf
    v_cvt_pk_f16_f32 v38, v20, v22
    v_cvt_pk_f16_f32 v48, v28, v30
    v_cvt_pk_f16_f32 v39, v21, v23
    v_cvt_pk_f16_f32 v49, v29, v31
    v_pk_mul_f32 v[24:25], v[22:23], v[22:23]
    v_pk_mul_f32 v[32:33], v[30:31], v[30:31]
    v_pk_add_f32 v[26:27], v[20:21], v[20:21]
    v_pk_add_f32 v[34:35], v[28:29], v[28:29]
    v_pk_fma_f32 v[20:21], v[20:21], v[20:21], v[24:25] neg_lo:[0,0,1] neg_hi:[0,0,1]
    v_pk_fma_f32 v[28:29], v[28:29], v[28:29], v[32:33] neg_lo:[0,0,1] neg_hi:[0,0,1]
    v_pk_mul_f32 v[22:23], v[26:27], v[22:23]
    v_pk_mul_f32 v[30:31], v[34:35], v[30:31]
    v_max_u32_dpp v58, v58, v58 row_ror:4 row_mask:0xf bank_mask:0xf
    v_cvt_pk_f16_f32 v40, v20, v22
    v_cvt_pk_f16_f32 v50, v28, v30
    v_cvt_pk_f16_f32 v41, v21, v23
    v_cvt_pk_f16_f32 v51, v29, v31
    v_pk_mul_f32 v[24:25], v[22:23], v[22:23]
    v_pk_mul_f32 v[32:33], v[30:31], v[30:31]
    v_pk_add_f32 v[26:27], v[20:21], v[20:21]
    v_pk_add_f32 v[34:35], v[28:29], v[28:29]
    v_pk_fma_f32 v[20:21], v[20:21], v[20:21], v[24:25] neg_lo:[0,0,1] neg_hi:[0,0,1]
    v_pk_fma_f32 v[28:29], v[28:29], v[28:29], v[32:33] neg_lo:[0,0,1] neg_hi:[0,0,1]
    v_pk_mul_f32 v[22:23], v[26:27], v[22:23]
    v_pk_mul_f32 v[30:31], v[34:35], v[30:31]
    v_max_u32_dpp v58, v58, v58 row_ror:2 row_mask:0xf bank_mask:0xf
    v_cvt_pk_f16_f32 v42, v20, v22
    v_cvt_pk_f16_f32 v52, v28, v30
    v_cvt_pk_f16_f32 v43, v21, v23
    v_cvt_pk_f16_f32 v53, v29, v31
    v_pk_mul_f32 v[24:25], v[22:23], v[22:23]
    v_pk_mul_f32 v[32:33], v[30:31], v[30:31]
    v_pk_add_f32 v[26:27], v[20:21], v[20:21]
    v_pk_add_f32 v[34:35], v[28:29], v[28:29]
    v_pk_fma_f32 v[20:21], v[20:21], v[20:21], v[24:25] neg_lo:[0,0,1] neg_hi:[0,0,1]
    v_pk_fma_f32 v[28:29], v[28:29], v[28:29], v[32:33] neg_lo:[0,0,1] neg_hi:[0,0,1]
    v_pk_mul_f32 v[22:23], v[26:27], v[22:23]
    v_pk_mul_f32 v[30:31], v[34:35], v[30:31]
    v_max_u32_dpp v58, v58, v58 row_ror:1 row_mask:0xf bank_mask:0xf
    v_cvt_pk_f16_f32 v44, v20, v22
    v_cvt_pk_f16_f32 v54, v28, v30
    v_cvt_pk_f16_f32 v45, v21, v23
    v_cvt_pk_f16_f32 v55, v29, v31
    v_pk_mul_f32 v[32:33], v[30:31], v[30:31]
    v_pk_add_f32 v[34:35], v[28:29], v[28:29]
    v_pk_fma_f32 v[28:29], v[28:29], v[28:29], v[32:33] neg_lo:[0,0,1] neg_hi:[0,0,1]
    v_pk_mul_f32 v[30:31], v[34:35], v[30:31]
    v_cvt_pk_f16_f32 v56, v28, v30
    v_cvt_pk_f16_f32 v57, v29, v31
    v_readlane_b32 s42, v58, 0
    v_readlane_b32 s43, v58, 16
    v_readlane_b32 s44, v58, 32
    v_readlane_b32 s45, v58, 48
    v_lshlrev_b32 v8, 16, v226
    v_and_b32 v9, 0xffff0000, v226
    v_lshlrev_b32 v10, 16, v227
    v_and_b32 v11, 0xffff0000, v227
    s_max_u32 s42, s42, s43
    s_max_u32 s44, s44, s45
    s_max_u32 s42, s42, s44
    s_lshr_b32 s42, s42, 23
    s_max_u32 s42, s42, 14
    s_min_u32 s42, s42, 254
    s_sub_u32 s43, 267, s42
    s_lshl_b32 s43, s43, 23
    s_sub_u32 s42, s42, 13
    s_lshl_b32 s42, s42, 23
    v_mul_f32 v8, s43, v8
    v_mul_f32 v9, s43, v9
    v_mul_f32 v10, s43, v10
    v_mul_f32 v11, s43, v11
    v_cvt_pk_f16_f32 v58, v8, -v10
    v_cvt_pk_f16_f32 v59, v9, -v11
    v_add_f32 v218, v218, v218
    v_mul_f32 v218, s42, v218
    v_mov_b32 v60, 0x3c00
    v_mov_b32 v61, 0x3c00
    v_pk_mul_f16 v178, v42, v44 op_sel:[0,0] op_sel_hi:[1,0]
    v_pk_mul_f16 v179, v43, v45 op_sel:[0,0] op_sel_hi:[1,0]
    v_pk_fma_f16 v66, v42, v44, v178 op_sel:[1,1,0] op_sel_hi:[0,1,1] neg_lo:[1,0,0]
    v_pk_fma_f16 v67, v43, v45, v179 op_sel:[1,1,0] op_sel_hi:[0,1,1] neg_lo:[1,0,0]
    v_pk_mul_f16 v180, v42, v46 op_sel:[0,0] op_sel_hi:[1,0]
    v_pk_mul_f16 v181, v43, v47 op_sel:[0,0] op_sel_hi:[1,0]
    v_pk_fma_f16 v70, v42, v46, v180 op_sel:[1,1,0] op_sel_hi:[0,1,1] neg_lo:[1,0,0]
    v_pk_fma_f16 v71, v43, v47, v181 op_sel:[1,1,0] op_sel_hi:[0,1,1] neg_lo:[1,0,0]
    v_pk_mul_f16 v182, v44, v46 op_sel:[0,0] op_sel_hi:[1,0]
    v_pk_mul_f16 v183, v45, v47 op_sel:[0,0] op_sel_hi:[1,0]
    v_pk_fma_f16 v72, v44, v46, v182 op_sel:[1,1,0] op_sel_hi:[0,1,1] neg_lo:[1,0,0]
    v_pk_fma_f16 v73, v45, v47, v183 op_sel:[1,1,0] op_sel_hi:[0,1,1] neg_lo:[1,0,0]
    v_pk_mul_f16 v184, v66, v46 op_sel:[0,0] op_sel_hi:[1,0]
    v_pk_mul_f16 v185, v67, v47 op_sel:[0,0] op_sel_hi:[1,0]
    v_pk_fma_f16 v74, v66, v46, v184 op_sel:[1,1,0] op_sel_hi:[0,1,1] neg_lo:[1,0,0]
    v_pk_fma_f16 v75, v67, v47, v185 op_sel:[1,1,0] op_sel_hi:[0,1,1] neg_lo:[1,0,0]
    v_pk_mul_f16 v178, v42, v48 op_sel:[0,0] op_sel_hi:[1,0]
    v_pk_mul_f16 v179, v43, v49 op_sel:[0,0] op_sel_hi:[1,0]
    v_pk_fma_f16 v78, v42, v48, v178 op_sel:[1,1,0] op_sel_hi:[0,1,1] neg_lo:[1,0,0]
    v_pk_fma_f16 v79, v43, v49, v179 op_sel:[1,1,0] op_sel_hi:[0,1,1] neg_lo:[1,0,0]
    v_pk_mul_f16 v180, v44, v48 op_sel:[0,0] op_sel_hi:[1,0]
    v_pk_mul_f16 v181, v45, v49 op_sel:[0,0] op_sel_hi:[1,0]
    v_pk_fma_f16 v80, v44, v48, v180 op_sel:[1,1,0] op_sel_hi:[0,1,1] neg_lo:[1,0,0]
    v_pk_fma_f16 v81, v45, v49, v181 op_sel:[1,1,0] op_sel_hi:[0,1,1] neg_lo:[1,0,0]
    v_pk_mul_f16 v182, v66, v48 op_sel:[0,0] op_sel_hi:[1,0]
    v_pk_mul_f16 v183, v67, v49 op_sel:[0,0] op_sel_hi:[1,0]
    v_pk_fma_f16 v82, v66, v48, v182 op_sel:[1,1,0] op_sel_hi:[0,1,1] neg_lo:[1,0,0]
    v_pk_fma_f16 v83, v67, v49, v183 op_sel:[1,1,0] op_sel_hi:[0,1,1] neg_lo:[1,0,0]
    v_pk_mul_f16 v184, v46, v48 op_sel:[0,0] op_sel_hi:[1,0]
    v_pk_mul_f16 v185, v47, v49 op_sel:[0,0] op_sel_hi:[1,0]
    v_pk_fma_f16 v84, v46, v48, v184 op_sel:[1,1,0] op_sel_hi:[0,1,1] neg_lo:[1,0,0]
    v_pk_fma_f16 v85, v47, v49, v185 op_sel:[1,1,0] op_sel_hi:[0,1,1] neg_lo:[1,0,0]
    v_pk_mul_f16 v178, v70, v48 op_sel:[0,0] op_sel_hi:[1,0]
    v_pk_mul_f16 v179, v71, v49 op_sel:[0,0] op_sel_hi:[1,0]
    v_pk_fma_f16 v86, v70, v48, v178 op_sel:[1,1,0] op_sel_hi:[0,1,1] neg_lo:[1,0,0]
    v_pk_fma_f16 v87, v71, v49, v179 op_sel:[1,1,0] op_sel_hi:[0,1,1] neg_lo:[1,0,0]
    v_pk_mul_f16 v180, v72, v48 op_sel:[0,0] op_sel_hi:[1,0]
    v_pk_mul_f16 v181, v73, v49 op_sel:[0,0] op_sel_hi:[1,0]
    v_pk_fma_f16 v88, v72, v48, v180 op_sel:[1,1,0] op_sel_hi:[0,1,1] neg_lo:[1,0,0]
    v_pk_fma_f16 v89, v73, v49, v181 op_sel:[1,1,0] op_sel_hi:[0,1,1] neg_lo:[1,0,0]
    v_pk_mul_f16 v182, v74, v48 op_sel:[0,0] op_sel_hi:[1,0]
    v_pk_mul_f16 v183, v75, v49 op_sel:[0,0] op_sel_hi:[1,0]
    v_pk_fma_f16 v90, v74, v48, v182 op_sel:[1,1,0] op_sel_hi:[0,1,1] neg_lo:[1,0,0]
    v_pk_fma_f16 v91, v75, v49, v183 op_sel:[1,1,0] op_sel_hi:[0,1,1] neg_lo:[1,0,0]
    v_pk_mul_f16 v184, v42, v50 op_sel:[0,0] op_sel_hi:[1,0]
    v_pk_mul_f16 v185, v43, v51 op_sel:[0,0] op_sel_hi:[1,0]
    v_pk_fma_f16 v94, v42, v50, v184 op_sel:[1,1,0] op_sel_hi:[0,1,1] neg_lo:[1,0,0]
    v_pk_fma_f16 v95, v43, v51, v185 op_sel:[1,1,0] op_sel_hi:[0,1,1] neg_lo:[1,0,0]
    v_pk_mul_f16 v178, v44, v50 op_sel:[0,0] op_sel_hi:[1,0]
    v_pk_mul_f16 v179, v45, v51 op_sel:[0,0] op_sel_hi:[1,0]
    v_pk_fma_f16 v96, v44, v50, v178 op_sel:[1,1,0] op_sel_hi:[0,1,1] neg_lo:[1,0,0]
    v_pk_fma_f16 v97, v45, v51, v179 op_sel:[1,1,0] op_sel_hi:[0,1,1] neg_lo:[1,0,0]
    v_pk_mul_f16 v180, v66, v50 op_sel:[0,0] op_sel_hi:[1,0]
    v_pk_mul_f16 v181, v67, v51 op_sel:[0,0] op_sel_hi:[1,0]
    v_pk_fma_f16 v98, v66, v50, v180 op_sel:[1,1,0] op_sel_hi:[0,1,1] neg_lo:[1,0,0]
    v_pk_fma_f16 v99, v67, v51, v181 op_sel:[1,1,0] op_sel_hi:[0,1,1] neg_lo:[1,0,0]
    v_pk_mul_f16 v182, v46, v50 op_sel:[0,0] op_sel_hi:[1,0]
    v_pk_mul_f16 v183, v47, v51 op_sel:[0,0] op_sel_hi:[1,0]
    v_pk_fma_f16 v100, v46, v50, v182 op_sel:[1,1,0] op_sel_hi:[0,1,1] neg_lo:[1,0,0]
    v_pk_fma_f16 v101, v47, v51, v183 op_sel:[1,1,0] op_sel_hi:[0,1,1] neg_lo:[1,0,0]
    v_pk_mul_f16 v184, v70, v50 op_sel:[0,0] op_sel_hi:[1,0]
    v_pk_mul_f16 v185, v71, v51 op_sel:[0,0] op_sel_hi:[1,0]
    v_pk_fma_f16 v102, v70, v50, v184 op_sel:[1,1,0] op_sel_hi:[0,1,1] neg_lo:[1,0,0]
    v_pk_fma_f16 v103, v71, v51, v185 op_sel:[1,1,0] op_sel_hi:[0,1,1] neg_lo:[1,0,0]
    v_pk_mul_f16 v178, v72, v50 op_sel:[0,0] op_sel_hi:[1,0]
    v_pk_mul_f16 v179, v73, v51 op_sel:[0,0] op_sel_hi:[1,0]
    v_pk_fma_f16 v104, v72, v50, v178 op_sel:[1,1,0] op_sel_hi:[0,1,1] neg_lo:[1,0,0]
    v_pk_fma_f16 v105, v73, v51, v179 op_sel:[1,1,0] op_sel_hi:[0,1,1] neg_lo:[1,0,0]
    v_pk_mul_f16 v180, v74, v50 op_sel:[0,0] op_sel_hi:[1,0]
    v_pk_mul_f16 v181, v75, v51 op_sel:[0,0] op_sel_hi:[1,0]
    v_pk_fma_f16 v106, v74, v50, v180 op_sel:[1,1,0] op_sel_hi:[0,1,1] neg_lo:[1,0,0]
    v_pk_fma_f16 v107, v75, v51, v181 op_sel:[1,1,0] op_sel_hi:[0,1,1] neg_lo:[1,0,0]
    v_pk_mul_f16 v182, v48, v50 op_sel:[0,0] op_sel_hi:[1,0]
    v_pk_mul_f16 v183, v49, v51 op_sel:[0,0] op_sel_hi:[1,0]
    v_pk_fma_f16 v108, v48, v50, v182 op_sel:[1,1,0] op_sel_hi:[0,1,1] neg_lo:[1,0,0]
    v_pk_fma_f16 v109, v49, v51, v183 op_sel:[1,1,0] op_sel_hi:[0,1,1] neg_lo:[1,0,0]
    v_pk_mul_f16 v184, v78, v50 op_sel:[0,0] op_sel_hi:[1,0]
    v_pk_mul_f16 v185, v79, v51 op_sel:[0,0] op_sel_hi:[1,0]
    v_pk_fma_f16 v110, v78, v50, v184 op_sel:[1,1,0] op_sel_hi:[0,1,1] neg_lo:[1,0,0]
    v_pk_fma_f16 v111, v79, v51, v185 op_sel:[1,1,0] op_sel_hi:[0,1,1] neg_lo:[1,0,0]
    v_pk_mul_f16 v178, v80, v50 op_sel:[0,0] op_sel_hi:[1,0]
    v_pk_mul_f16 v179, v81, v51 op_sel:[0,0] op_sel_hi:[1,0]
    v_pk_fma_f16 v112, v80, v50, v178 op_sel:[1,1,0] op_sel_hi:[0,1,1] neg_lo:[1,0,0]
    v_pk_fma_f16 v113, v81, v51, v179 op_sel:[1,1,0] op_sel_hi:[0,1,1] neg_lo:[1,0,0]
    v_pk_mul_f16 v180, v82, v50 op_sel:[0,0] op_sel_hi:[1,0]
    v_pk_mul_f16 v181, v83, v51 op_sel:[0,0] op_sel_hi:[1,0]
    v_pk_fma_f16 v114, v82, v50, v180 op_sel:[1,1,0] op_sel_hi:[0,1,1] neg_lo:[1,0,0]
    v_pk_fma_f16 v115, v83, v51, v181 op_sel:[1,1,0] op_sel_hi:[0,1,1] neg_lo:[1,0,0]
    v_pk_mul_f16 v182, v84, v50 op_sel:[0,0] op_sel_hi:[1,0]
    v_pk_mul_f16 v183, v85, v51 op_sel:[0,0] op_sel_hi:[1,0]
    v_pk_fma_f16 v116, v84, v50, v182 op_sel:[1,1,0] op_sel_hi:[0,1,1] neg_lo:[1,0,0]
    v_pk_fma_f16 v117, v85, v51, v183 op_sel:[1,1,0] op_sel_hi:[0,1,1] neg_lo:[1,0,0]
    v_pk_mul_f16 v184, v86, v50 op_sel:[0,0] op_sel_hi:[1,0]
    v_pk_mul_f16 v185, v87, v51 op_sel:[0,0] op_sel_hi:[1,0]
    v_pk_fma_f16 v118, v86, v50, v184 op_sel:[1,1,0] op_sel_hi:[0,1,1] neg_lo:[1,0,0]
    v_pk_fma_f16 v119, v87, v51, v185 op_sel:[1,1,0] op_sel_hi:[0,1,1] neg_lo:[1,0,0]
    v_pk_mul_f16 v178, v88, v50 op_sel:[0,0] op_sel_hi:[1,0]
    v_pk_mul_f16 v179, v89, v51 op_sel:[0,0] op_sel_hi:[1,0]
    v_pk_fma_f16 v120, v88, v50, v178 op_sel:[1,1,0] op_sel_hi:[0,1,1] neg_lo:[1,0,0]
    v_pk_fma_f16 v121, v89, v51, v179 op_sel:[1,1,0] op_sel_hi:[0,1,1] neg_lo:[1,0,0]
    v_pk_mul_f16 v180, v90, v50 op_sel:[0,0] op_sel_hi:[1,0]
    v_pk_mul_f16 v181, v91, v51 op_sel:[0,0] op_sel_hi:[1,0]
    v_pk_fma_f16 v122, v90, v50, v180 op_sel:[1,1,0] op_sel_hi:[0,1,1] neg_lo:[1,0,0]
    v_pk_fma_f16 v123, v91, v51, v181 op_sel:[1,1,0] op_sel_hi:[0,1,1] neg_lo:[1,0,0]
    v_pk_mul_f16 v182, v58, v52 op_sel:[0,0] op_sel_hi:[1,0]
    v_pk_mul_f16 v183, v59, v53 op_sel:[0,0] op_sel_hi:[1,0]
    v_pk_fma_f16 v124, v58, v52, v182 op_sel:[1,1,0] op_sel_hi:[0,1,1] neg_hi:[1,0,0]
    v_pk_fma_f16 v125, v59, v53, v183 op_sel:[1,1,0] op_sel_hi:[0,1,1] neg_hi:[1,0,0]
    v_pk_mul_f16 v184, v58, v54 op_sel:[0,0] op_sel_hi:[1,0]
    v_pk_mul_f16 v185, v59, v55 op_sel:[0,0] op_sel_hi:[1,0]
    v_pk_fma_f16 v126, v58, v54, v184 op_sel:[1,1,0] op_sel_hi:[0,1,1] neg_hi:[1,0,0]
    v_pk_fma_f16 v127, v59, v55, v185 op_sel:[1,1,0] op_sel_hi:[0,1,1] neg_hi:[1,0,0]
    v_pk_mul_f16 v178, v58, v56 op_sel:[0,0] op_sel_hi:[1,0]
    v_pk_mul_f16 v179, v59, v57 op_sel:[0,0] op_sel_hi:[1,0]
    v_pk_fma_f16 v128, v58, v56, v178 op_sel:[1,1,0] op_sel_hi:[0,1,1] neg_hi:[1,0,0]
    v_pk_fma_f16 v129, v59, v57, v179 op_sel:[1,1,0] op_sel_hi:[0,1,1] neg_hi:[1,0,0]
    v_pk_mul_f16 v180, v58, v36 op_sel:[0,0] op_sel_hi:[1,0]
    v_pk_mul_f16 v181, v59, v37 op_sel:[0,0] op_sel_hi:[1,0]
    v_pk_fma_f16 v130, v58, v36, v180 op_sel:[1,1,0] op_sel_hi:[0,1,1] neg_hi:[1,0,0]
    v_pk_fma_f16 v131, v59, v37, v181 op_sel:[1,1,0] op_sel_hi:[0,1,1] neg_hi:[1,0,0]
    v_pk_mul_f16 v182, v58, v38 op_sel:[0,0] op_sel_hi:[1,0]
    v_pk_mul_f16 v183, v59, v39 op_sel:[0,0] op_sel_hi:[1,0]
    v_pk_fma_f16 v132, v58, v38, v182 op_sel:[1,1,0] op_sel_hi:[0,1,1] neg_hi:[1,0,0]
    v_pk_fma_f16 v133, v59, v39, v183 op_sel:[1,1,0] op_sel_hi:[0,1,1] neg_hi:[1,0,0]
    v_pk_mul_f16 v184, v58, v40 op_sel:[0,0] op_sel_hi:[1,0]
    v_pk_mul_f16 v185, v59, v41 op_sel:[0,0] op_sel_hi:[1,0]
    v_pk_fma_f16 v134, v58, v40, v184 op_sel:[1,1,0] op_sel_hi:[0,1,1] neg_hi:[1,0,0]
    v_pk_fma_f16 v135, v59, v41, v185 op_sel:[1,1,0] op_sel_hi:[0,1,1] neg_hi:[1,0,0]
    v_pk_mul_f16 v178, v58, v42 op_sel:[0,0] op_sel_hi:[1,0]
    v_pk_mul_f16 v179, v59, v43 op_sel:[0,0] op_sel_hi:[1,0]
    v_pk_fma_f16 v136, v58, v42, v178 op_sel:[1,1,0] op_sel_hi:[0,1,1] neg_hi:[1,0,0]
    v_pk_fma_f16 v137, v59, v43, v179 op_sel:[1,1,0] op_sel_hi:[0,1,1] neg_hi:[1,0,0]
    v_pk_mul_f16 v180, v124, v54 op_sel:[0,0] op_sel_hi:[1,0]
    v_pk_mul_f16 v181, v125, v55 op_sel:[0,0] op_sel_hi:[1,0]
    v_pk_fma_f16 v138, v124, v54, v180 op_sel:[1,1,0] op_sel_hi:[0,1,1] neg_hi:[1,0,0]
    v_pk_fma_f16 v139, v125, v55, v181 op_sel:[1,1,0] op_sel_hi:[0,1,1] neg_hi:[1,0,0]
    v_pk_mul_f16 v182, v130, v38 op_sel:[0,0] op_sel_hi:[1,0]
    v_pk_mul_f16 v183, v131, v39 op_sel:[0,0] op_sel_hi:[1,0]
    v_pk_fma_f16 v140, v130, v38, v182 op_sel:[1,1,0] op_sel_hi:[0,1,1] neg_hi:[1,0,0]
    v_pk_fma_f16 v141, v131, v39, v183 op_sel:[1,1,0] op_sel_hi:[0,1,1] neg_hi:[1,0,0]
    v_pk_mul_f16 v184, v124, v38 op_sel:[0,0] op_sel_hi:[1,0]
    v_pk_mul_f16 v185, v125, v39 op_sel:[0,0] op_sel_hi:[1,0]
    v_pk_fma_f16 v142, v124, v38, v184 op_sel:[1,1,0] op_sel_hi:[0,1,1] neg_hi:[1,0,0]
    v_pk_fma_f16 v143, v125, v39, v185 op_sel:[1,1,0] op_sel_hi:[0,1,1] neg_hi:[1,0,0]
    v_pk_mul_f16 v178, v124, v56 op_sel:[0,0] op_sel_hi:[1,0]
    v_pk_mul_f16 v179, v125, v57 op_sel:[0,0] op_sel_hi:[1,0]
    v_pk_fma_f16 v144, v124, v56, v178 op_sel:[1,1,0] op_sel_hi:[0,1,1] neg_hi:[1,0,0]
    v_pk_fma_f16 v145, v125, v57, v179 op_sel:[1,1,0] op_sel_hi:[0,1,1] neg_hi:[1,0,0]
    v_pk_mul_f16 v180, v126, v56 op_sel:[0,0] op_sel_hi:[1,0]
    v_pk_mul_f16 v181, v127, v57 op_sel:[0,0] op_sel_hi:[1,0]
    v_pk_fma_f16 v146, v126, v56, v180 op_sel:[1,1,0] op_sel_hi:[0,1,1] neg_hi:[1,0,0]
    v_pk_fma_f16 v147, v127, v57, v181 op_sel:[1,1,0] op_sel_hi:[0,1,1] neg_hi:[1,0,0]
    v_pk_mul_f16 v182, v138, v56 op_sel:[0,0] op_sel_hi:[1,0]
    v_pk_mul_f16 v183, v139, v57 op_sel:[0,0] op_sel_hi:[1,0]
    v_pk_fma_f16 v148, v138, v56, v182 op_sel:[1,1,0] op_sel_hi:[0,1,1] neg_hi:[1,0,0]
    v_pk_fma_f16 v149, v139, v57, v183 op_sel:[1,1,0] op_sel_hi:[0,1,1] neg_hi:[1,0,0]
    v_pk_mul_f16 v184, v130, v40 op_sel:[0,0] op_sel_hi:[1,0]
    v_pk_mul_f16 v185, v131, v41 op_sel:[0,0] op_sel_hi:[1,0]
    v_pk_fma_f16 v150, v130, v40, v184 op_sel:[1,1,0] op_sel_hi:[0,1,1] neg_hi:[1,0,0]
    v_pk_fma_f16 v151, v131, v41, v185 op_sel:[1,1,0] op_sel_hi:[0,1,1] neg_hi:[1,0,0]
    v_pk_mul_f16 v178, v132, v40 op_sel:[0,0] op_sel_hi:[1,0]
    v_pk_mul_f16 v179, v133, v41 op_sel:[0,0] op_sel_hi:[1,0]
    v_pk_fma_f16 v152, v132, v40, v178 op_sel:[1,1,0] op_sel_hi:[0,1,1] neg_hi:[1,0,0]
    v_pk_fma_f16 v153, v133, v41, v179 op_sel:[1,1,0] op_sel_hi:[0,1,1] neg_hi:[1,0,0]
    v_pk_mul_f16 v180, v140, v40 op_sel:[0,0] op_sel_hi:[1,0]
    v_pk_mul_f16 v181, v141, v41 op_sel:[0,0] op_sel_hi:[1,0]
    v_pk_fma_f16 v154, v140, v40, v180 op_sel:[1,1,0] op_sel_hi:[0,1,1] neg_hi:[1,0,0]
    v_pk_fma_f16 v155, v141, v41, v181 op_sel:[1,1,0] op_sel_hi:[0,1,1] neg_hi:[1,0,0]
    v_pk_mul_f16 v182, v124, v40 op_sel:[0,0] op_sel_hi:[1,0]
    v_pk_mul_f16 v183, v125, v41 op_sel:[0,0] op_sel_hi:[1,0]
    v_pk_fma_f16 v156, v124, v40, v182 op_sel:[1,1,0] op_sel_hi:[0,1,1] neg_hi:[1,0,0]
    v_pk_fma_f16 v157, v125, v41, v183 op_sel:[1,1,0] op_sel_hi:[0,1,1] neg_hi:[1,0,0]
    v_pk_mul_f16 v184, v142, v40 op_sel:[0,0] op_sel_hi:[1,0]
    v_pk_mul_f16 v185, v143, v41 op_sel:[0,0] op_sel_hi:[1,0]
    v_pk_fma_f16 v158, v142, v40, v184 op_sel:[1,1,0] op_sel_hi:[0,1,1] neg_hi:[1,0,0]
    v_pk_fma_f16 v159, v143, v41, v185 op_sel:[1,1,0] op_sel_hi:[0,1,1] neg_hi:[1,0,0]
    v_pk_mul_f16 v178, v124, v42 op_sel:[0,0] op_sel_hi:[1,0]
    v_pk_mul_f16 v179, v125, v43 op_sel:[0,0] op_sel_hi:[1,0]
    v_pk_fma_f16 v160, v124, v42, v178 op_sel:[1,1,0] op_sel_hi:[0,1,1] neg_hi:[1,0,0]
    v_pk_fma_f16 v161, v125, v43, v179 op_sel:[1,1,0] op_sel_hi:[0,1,1] neg_hi:[1,0,0]
    v_pk_mul_f16 v180, v126, v40 op_sel:[0,0] op_sel_hi:[1,0]
    v_pk_mul_f16 v181, v127, v41 op_sel:[0,0] op_sel_hi:[1,0]
    v_pk_fma_f16 v162, v126, v40, v180 op_sel:[1,1,0] op_sel_hi:[0,1,1] neg_hi:[1,0,0]
    v_pk_fma_f16 v163, v127, v41, v181 op_sel:[1,1,0] op_sel_hi:[0,1,1] neg_hi:[1,0,0]
    v_pk_mul_f16 v182, v126, v42 op_sel:[0,0] op_sel_hi:[1,0]
    v_pk_mul_f16 v183, v127, v43 op_sel:[0,0] op_sel_hi:[1,0]
    v_pk_fma_f16 v164, v126, v42, v182 op_sel:[1,1,0] op_sel_hi:[0,1,1] neg_hi:[1,0,0]
    v_pk_fma_f16 v165, v127, v43, v183 op_sel:[1,1,0] op_sel_hi:[0,1,1] neg_hi:[1,0,0]
    v_pk_mul_f16 v184, v138, v40 op_sel:[0,0] op_sel_hi:[1,0]
    v_pk_mul_f16 v185, v139, v41 op_sel:[0,0] op_sel_hi:[1,0]
    v_pk_fma_f16 v166, v138, v40, v184 op_sel:[1,1,0] op_sel_hi:[0,1,1] neg_hi:[1,0,0]
    v_pk_fma_f16 v167, v139, v41, v185 op_sel:[1,1,0] op_sel_hi:[0,1,1] neg_hi:[1,0,0]
    v_pk_mul_f16 v178, v138, v42 op_sel:[0,0] op_sel_hi:[1,0]
    v_pk_mul_f16 v179, v139, v43 op_sel:[0,0] op_sel_hi:[1,0]
    v_pk_fma_f16 v168, v138, v42, v178 op_sel:[1,1,0] op_sel_hi:[0,1,1] neg_hi:[1,0,0]
    v_pk_fma_f16 v169, v139, v43, v179 op_sel:[1,1,0] op_sel_hi:[0,1,1] neg_hi:[1,0,0]
    v_pk_mul_f16 v180, v128, v42 op_sel:[0,0] op_sel_hi:[1,0]
    v_pk_mul_f16 v181, v129, v43 op_sel:[0,0] op_sel_hi:[1,0]
    v_pk_fma_f16 v170, v128, v42, v180 op_sel:[1,1,0] op_sel_hi:[0,1,1] neg_hi:[1,0,0]
    v_pk_fma_f16 v171, v129, v43, v181 op_sel:[1,1,0] op_sel_hi:[0,1,1] neg_hi:[1,0,0]
    v_pk_mul_f16 v182, v144, v42 op_sel:[0,0] op_sel_hi:[1,0]
    v_pk_mul_f16 v183, v145, v43 op_sel:[0,0] op_sel_hi:[1,0]
    v_pk_fma_f16 v172, v144, v42, v182 op_sel:[1,1,0] op_sel_hi:[0,1,1] neg_hi:[1,0,0]
    v_pk_fma_f16 v173, v145, v43, v183 op_sel:[1,1,0] op_sel_hi:[0,1,1] neg_hi:[1,0,0]
    v_pk_mul_f16 v184, v146, v42 op_sel:[0,0] op_sel_hi:[1,0]
    v_pk_mul_f16 v185, v147, v43 op_sel:[0,0] op_sel_hi:[1,0]
    v_pk_fma_f16 v174, v146, v42, v184 op_sel:[1,1,0] op_sel_hi:[0,1,1] neg_hi:[1,0,0]
    v_pk_fma_f16 v175, v147, v43, v185 op_sel:[1,1,0] op_sel_hi:[0,1,1] neg_hi:[1,0,0]
    v_pk_mul_f16 v178, v148, v42 op_sel:[0,0] op_sel_hi:[1,0]
    v_pk_mul_f16 v179, v149, v43 op_sel:[0,0] op_sel_hi:[1,0]
    v_pk_fma_f16 v176, v148, v42, v178 op_sel:[1,1,0] op_sel_hi:[0,1,1] neg_hi:[1,0,0]
    v_pk_fma_f16 v177, v149, v43, v179 op_sel:[1,1,0] op_sel_hi:[0,1,1] neg_hi:[1,0,0]
    v_lshrrev_b32 v247, 4, v1
    v_and_b32 v245, 15, v1
    v_lshlrev_b32 v248, 5, v245
    v_lshl_add_u32 v248, v247, 4, v248
    v_add_u32 v248, s40, v248
    v_add_u32 v248, 8704, v248
    v_lshlrev_b32 v247, 4, v247
    v_lshlrev_b32 v249, 1, v245
    v_sub_u32 v247, v247, v249
    v_add_u32 v247, s40, v247
    s_mov_b32 vcc_lo, 0xaaaaaaaa
    s_mov_b32 vcc_hi, 0xaaaaaaaa
    v_mov_b32 v249, 7648
    v_mov_b32 v250, 3486
    v_cndmask_b32 v249, v249, v250, vcc
    v_add_u32 v250, v247, v249
    v_subrev_u32 v251, 1024, v250
    v_subrev_u32 v252, 2048, v250
    v_subrev_u32 v253, 3072, v250
    v_lshrrev_b32 v247, 4, v1
    v_lshlrev_b32 v244, 14, v247
    v_lshl_add_u32 v244, v245, 4, v244
    v_lshl_add_u32 v246, v1, 4, s40
    v_bfe_u32 v249, v1, 3, 1
    v_lshlrev_b32 v249, 14, v249
    v_and_b32 v245, 7, v1
    v_lshl_add_u32 v249, v245, 5, v249
    v_lshl_add_u32 v249, v247, 3, v249
    s_lshl_b32 s36, s34, 18
    s_lshl2_add_u32 s37, s35, s32
    s_lshl_b32 s37, s37, 8
    s_add_u32 s38, s36, s37
    s_add_u32 s36, s38, 10747904
    s_bfe_u32 s3, s2, 0x30003
    s_mul_i32 s3, s3, 160
    v_add_u32 v232, 0, v1
    v_mul_u32_u24 v233, 205, v232
    v_lshrrev_b32 v233, 11, v233
    v_mul_u32_u24 v233, 1120, v233
    v_lshl_add_u32 v233, v232, 4, v233
    v_add_u32 v12, s3, v233
    v_add_u32 v232, 64, v1
    v_mul_u32_u24 v233, 205, v232
    v_lshrrev_b32 v233, 11, v233
    v_mul_u32_u24 v233, 1120, v233
    v_lshl_add_u32 v233, v232, 4, v233
    v_add_u32 v13, s3, v233
    v_add_u32 v232, 128, v1
    v_mul_u32_u24 v233, 205, v232
    v_lshrrev_b32 v233, 11, v233
    v_mul_u32_u24 v233, 1120, v233
    v_lshl_add_u32 v233, v232, 4, v233
    v_add_u32 v14, s3, v233
    v_add_u32 v232, 192, v1
    v_mul_u32_u24 v233, 205, v232
    v_lshrrev_b32 v233, 11, v233
    v_mul_u32_u24 v233, 1120, v233
    v_lshl_add_u32 v233, v232, 4, v233
    v_add_u32 v15, s3, v233
    v_add_u32 v232, 256, v1
    v_mul_u32_u24 v233, 205, v232
    v_lshrrev_b32 v233, 11, v233
    v_mul_u32_u24 v233, 1120, v233
    v_lshl_add_u32 v233, v232, 4, v233
    v_add_u32 v254, s3, v233
    s_lshr_b32 s48, s32, 1
    s_and_b32 s47, s32, 1
    v_lshrrev_b32 v233, 4, v1
    v_bfe_u32 v232, v1, 2, 2
    v_lshl_add_u32 v232, v233, 3, v232
    v_mul_u32_u24 v232, 160, v232
    v_and_b32 v234, 3, v1
    s_mul_i32 s3, s48, 5120
    v_add_u32 v232, s3, v232
    v_lshl_add_u32 v4, v234, 4, v232
    v_lshl_add_u32 v5, v234, 3, v232
    s_and_b32 s3, s2, 7
    s_lshl_b32 s44, s3, 2
    s_lshr_b32 s3, s2, 6
    s_add_u32 s44, s44, s3
    s_lshl_b32 s45, s44, 10
    s_lshl_b32 s3, s47, 9
    s_add_u32 s45, s45, s3
    s_lshl_b32 s3, s48, 17
    s_add_u32 s45, s45, s3
    s_add_u32 s45, s45, 8126464
    v_and_b32 v232, 15, v1
    v_lshlrev_b32 v234, 15, v233
    v_lshl_add_u32 v234, v232, 4, v234
    s_lshl_b32 s3, s48, 8
    v_add_u32 v6, s3, v234
    v_xor_b32 v7, 256, v6
    s_bfe_u32 s3, s2, 0x30003
    s_lshl3_add_u32 s51, s44, s3
    s_lshl_b32 s51, s51, 7
    s_add_u32 s51, s51, 16052224
    s_lshl_b32 s46, s44, 6
    s_lshl_b32 s3, s47, 5
    s_add_u32 s46, s46, s3
    s_lshl_b32 s3, s48, 4
    s_add_u32 s46, s46, s3
    s_mul_i32 s46, s46, 2560
    s_bfe_u32 s3, s2, 0x30003
    s_mul_i32 s3, s3, 160
    s_add_u32 s46, s46, s3
    v_mul_u32_u24 v232, 2560, v232
    v_lshl_add_u32 v9, v233, 3, v232
    v_lshl_add_u32 v8, v233, 4, v232
    s_mul_i32 s3, s32, 5120
    s_add_u32 s3, s3, 61440
    v_lshl_add_u32 v10, v1, 4, s3
    s_xor_b32 s3, s32, 2
    s_mul_i32 s3, s3, 5120
    s_add_u32 s3, s3, 61440
    v_lshl_add_u32 v11, v1, 4, s3
    s_cmp_lg_u32 s32, 0
    s_cbranch_scc1 aux_hw_34
    s_mov_b32 s58, 64
spin_top_35:
    s_load_dword s3, s[16:17], s56 glc
    s_waitcnt lgkmcnt(0)
    s_and_b32 s3, s3, 1
    s_cbranch_scc1 spin_ok_36
    s_sub_u32 s58, s58, 1
    s_cbranch_scc1 spin_ok_36
    s_sleep 3
    s_branch spin_top_35
spin_ok_36:
aux_hw_34:
    s_barrier
    ds_write_b64 v219, v[60:61] offset:0
    ds_write_b64 v219, v[42:43] offset:528
    ds_write_b64 v219, v[44:45] offset:1056
    ds_write_b64 v219, v[66:67] offset:1584
    ds_write_b64 v219, v[46:47] offset:2112
    ds_write_b64 v219, v[70:71] offset:2640
    ds_write_b64 v219, v[72:73] offset:3168
    ds_write_b64 v219, v[74:75] offset:3696
    ds_write_b64 v219, v[48:49] offset:4224
    ds_write_b64 v219, v[78:79] offset:4752
    ds_write_b64 v219, v[80:81] offset:5280
    ds_write_b64 v219, v[82:83] offset:5808
    ds_write_b64 v219, v[84:85] offset:6336
    ds_write_b64 v219, v[86:87] offset:6864
    ds_write_b64 v219, v[88:89] offset:7392
    ds_write_b64 v219, v[90:91] offset:7920
    ds_write_b64 v219, v[50:51] offset:8448
    ds_write_b64 v219, v[94:95] offset:8976
    ds_write_b64 v219, v[96:97] offset:9504
    ds_write_b64 v219, v[98:99] offset:10032
    ds_write_b64 v219, v[100:101] offset:10560
    ds_write_b64 v219, v[102:103] offset:11088
    ds_write_b64 v219, v[104:105] offset:11616
    ds_write_b64 v219, v[106:107] offset:12144
    ds_write_b64 v219, v[108:109] offset:12672
    ds_write_b64 v219, v[110:111] offset:13200
    ds_write_b64 v219, v[112:113] offset:13728
    ds_write_b64 v219, v[114:115] offset:14256
    ds_write_b64 v219, v[116:117] offset:14784
    ds_write_b64 v219, v[118:119] offset:15312
    ds_write_b64 v219, v[120:121] offset:15840
    ds_write_b64 v219, v[122:123] offset:16368
    s_waitcnt lgkmcnt(0)
    ds_read_b128 v[60:63], v220 offset:0
    ds_read_b128 v[64:67], v220 offset:32
    ds_read_b128 v[68:71], v220 offset:64
    ds_read_b128 v[72:75], v220 offset:96
    ds_read_b128 v[76:79], v220 offset:128
    ds_read_b128 v[80:83], v220 offset:160
    ds_read_b128 v[84:87], v220 offset:192
    ds_read_b128 v[88:91], v220 offset:224
    ds_read_b128 v[92:95], v220 offset:256
    ds_read_b128 v[96:99], v220 offset:288
    ds_read_b128 v[100:103], v220 offset:320
    ds_read_b128 v[104:107], v220 offset:352
    ds_read_b128 v[108:111], v220 offset:384
    ds_read_b128 v[112:115], v220 offset:416
    ds_read_b128 v[116:119], v220 offset:448
    ds_read_b128 v[120:123], v220 offset:480
    s_waitcnt lgkmcnt(0)
    ds_write_b64 v219, v[58:59] offset:0
    ds_write_b64 v219, v[124:125] offset:2112
    ds_write_b64 v219, v[124:125] offset:2640
    ds_write_b64 v219, v[130:131] offset:528
    ds_write_b64 v219, v[132:133] offset:1056
    ds_write_b64 v219, v[142:143] offset:3168
    ds_write_b64 v219, v[140:141] offset:1584
    ds_write_b64 v219, v[156:157] offset:3696
    ds_write_b64 v219, v[156:157] offset:6336
    ds_write_b64 v219, v[156:157] offset:6864
    ds_write_b64 v219, v[134:135] offset:4224
    ds_write_b64 v219, v[150:151] offset:4752
    ds_write_b64 v219, v[152:153] offset:5280
    ds_write_b64 v219, v[158:159] offset:7392
    ds_write_b64 v219, v[154:155] offset:5808
    ds_write_b64 v219, v[160:161] offset:7920
    ds_write_b64 v219, v[160:161] offset:10560
    ds_write_b64 v219, v[136:137] offset:8448
    ds_write_b64 v219, v[126:127] offset:8976
    ds_write_b64 v219, v[162:163] offset:9504
    ds_write_b64 v219, v[164:165] offset:10032
    ds_write_b64 v219, v[128:129] offset:12672
    ds_write_b64 v219, v[146:147] offset:13728
    ds_write_b64 v219, v[170:171] offset:13200
    ds_write_b64 v219, v[174:175] offset:14256
    ds_write_b64 v219, v[138:139] offset:11088
    ds_write_b64 v219, v[166:167] offset:11616
    ds_write_b64 v219, v[168:169] offset:12144
    ds_write_b64 v219, v[144:145] offset:14784
    ds_write_b64 v219, v[148:149] offset:15840
    ds_write_b64 v219, v[172:173] offset:15312
    ds_write_b64 v219, v[176:177] offset:16368
    v_and_b32 v204, 31, v1
    v_lshrrev_b32 v205, 5, v1
    v_lshlrev_b32 v206, 4, v204
    v_lshl_add_u32 v206, v205, 9, v206
    v_sub_u32 v206, 1008, v206
    v_add_u32 v208, s40, v206
    s_mov_b64 s[42:43], 1
    v_lshlrev_b32 v205, 16, v229
    v_cndmask_b32 v205, 0, v205, s[42:43]
    v_mov_b32 v204, 0
    v_lshl_add_u32 v209, v1, 2, s40
    v_lshl_add_u32 v210, v1, 4, s40
    s_mov_b32 vcc_lo, 0xaaaaaaaa
    s_mov_b32 vcc_hi, 0xaaaaaaaa
    s_waitcnt lgkmcnt(0)
    ds_read_b128 v[124:127], v220 offset:0
    ds_read_b128 v[128:131], v220 offset:32
    ds_read_b128 v[132:135], v220 offset:64
    ds_read_b128 v[136:139], v220 offset:96
    ds_read_b128 v[140:143], v220 offset:128
    ds_read_b128 v[144:147], v220 offset:160
    ds_read_b128 v[148:151], v220 offset:192
    ds_read_b128 v[152:155], v220 offset:224
    s_waitcnt lgkmcnt(7)
    v_mfma_f32_32x32x16_f16 v[160:175], v[124:127], v[60:63], 0
    ds_read_b128 v[124:127], v220 offset:256
    s_waitcnt lgkmcnt(7)
    v_mfma_f32_32x32x16_f16 v[160:175], v[128:131], v[64:67], v[160:175]
    ds_read_b128 v[128:131], v220 offset:288
    s_waitcnt lgkmcnt(7)
    v_mfma_f32_32x32x16_f16 v[160:175], v[132:135], v[68:71], v[160:175]
    ds_read_b128 v[132:135], v220 offset:320
    s_waitcnt lgkmcnt(7)
    v_mfma_f32_32x32x16_f16 v[160:175], v[136:139], v[72:75], v[160:175]
    ds_read_b128 v[136:139], v220 offset:352
    s_waitcnt lgkmcnt(7)
    v_mfma_f32_32x32x16_f16 v[160:175], v[140:143], v[76:79], v[160:175]
    ds_read_b128 v[140:143], v220 offset:384
    s_waitcnt lgkmcnt(7)
    v_mfma_f32_32x32x16_f16 v[160:175], v[144:147], v[80:83], v[160:175]
    ds_read_b128 v[144:147], v220 offset:416
    s_waitcnt lgkmcnt(7)
    v_mfma_f32_32x32x16_f16 v[160:175], v[148:151], v[84:87], v[160:175]
    ds_read_b128 v[148:151], v220 offset:448
    s_waitcnt lgkmcnt(7)
    v_mfma_f32_32x32x16_f16 v[160:175], v[152:155], v[88:91], v[160:175]
    ds_read_b128 v[152:155], v220 offset:480
    s_waitcnt lgkmcnt(7)
    v_mfma_f32_32x32x16_f16 v[160:175], v[124:127], v[92:95], v[160:175]
    s_waitcnt lgkmcnt(6)
    v_mfma_f32_32x32x16_f16 v[160:175], v[128:131], v[96:99], v[160:175]
    s_waitcnt lgkmcnt(5)
    v_mfma_f32_32x32x16_f16 v[160:175], v[132:135], v[100:103], v[160:175]
    s_waitcnt lgkmcnt(4)
    v_mfma_f32_32x32x16_f16 v[160:175], v[136:139], v[104:107], v[160:175]
    s_waitcnt lgkmcnt(3)
    v_mfma_f32_32x32x16_f16 v[160:175], v[140:143], v[108:111], v[160:175]
    s_waitcnt lgkmcnt(2)
    v_mfma_f32_32x32x16_f16 v[160:175], v[144:147], v[112:115], v[160:175]
    s_waitcnt lgkmcnt(1)
    v_mfma_f32_32x32x16_f16 v[160:175], v[148:151], v[116:119], v[160:175]
    s_waitcnt lgkmcnt(0)
    v_mfma_f32_32x32x16_f16 v[160:175], v[152:155], v[120:123], v[160:175]
    ds_write_b32 v209, v204 offset:8320
    s_mov_b32 exec_hi, 0x00ffffff
    ds_write_b32 v209, v204 offset:8576
    s_mov_b64 exec, 0xff
    ds_write_b32 v209, v204 offset:4096
    s_mov_b64 exec, -1
    s_nop 5
    v_fma_f32 v160, v160, v218, v205
    v_mul_f32 v161, v161, v218
    v_mul_f32 v162, v162, v218
    v_mul_f32 v163, v163, v218
    v_mul_f32 v164, v164, v218
    v_mul_f32 v165, v165, v218
    v_mul_f32 v166, v166, v218
    v_mul_f32 v167, v167, v218
    v_mul_f32 v168, v168, v218
    v_mul_f32 v169, v169, v218
    v_mul_f32 v170, v170, v218
    v_mul_f32 v171, v171, v218
    v_mul_f32 v172, v172, v218
    v_mul_f32 v173, v173, v218
    v_mul_f32 v174, v174, v218
    v_mul_f32 v175, v175, v218
    v_cndmask_b32 v206, v172, v173, vcc
    v_cndmask_b32 v207, v174, v175, vcc
    v_cvt_pk_bf16_f32 v60, v167, v166
    v_cvt_pk_bf16_f32 v61, v165, v164
    v_cvt_pk_bf16_f32 v62, v163, v162
    v_cvt_pk_bf16_f32 v63, v161, v160
    ds_write_b128 v208, v[60:63] offset:3072
    v_cvt_pk_bf16_f32 v64, v168, v167
    v_cvt_pk_bf16_f32 v65, v166, v165
    v_cvt_pk_bf16_f32 v66, v164, v163
    v_cvt_pk_bf16_f32 v67, v162, v161
    ds_write_b128 v208, v[64:67] offset:7232
    v_cvt_pk_bf16_f32 v68, v171, v171
    v_cvt_pk_bf16_f32 v69, v170, v170
    v_cvt_pk_bf16_f32 v70, v170, v169
    v_cvt_pk_bf16_f32 v71, v169, v169
    ds_write_b128 v208, v[68:71] offset:2048
    v_cvt_pk_bf16_f32 v72, v171, v171
    v_cvt_pk_bf16_f32 v73, v171, v170
    v_cvt_pk_bf16_f32 v74, v170, v170
    v_cvt_pk_bf16_f32 v75, v169, v169
    ds_write_b128 v208, v[72:75] offset:6208
    v_cvt_pk_bf16_f32 v76, v173, v173
    v_cvt_pk_bf16_f32 v77, v173, v206
    v_cvt_pk_bf16_f32 v78, v172, v172
    v_cvt_pk_bf16_f32 v79, v172, v172
    ds_write_b128 v208, v[76:79] offset:1024
    v_cvt_pk_bf16_f32 v80, v173, v173
    v_cvt_pk_bf16_f32 v81, v173, v173
    v_cvt_pk_bf16_f32 v82, v206, v172
    v_cvt_pk_bf16_f32 v83, v172, v172
    ds_write_b128 v208, v[80:83] offset:5184
    v_cvt_pk_bf16_f32 v84, v175, v175
    v_cvt_pk_bf16_f32 v85, v175, v207
    v_cvt_pk_bf16_f32 v86, v174, v174
    v_cvt_pk_bf16_f32 v87, v174, v174
    ds_write_b128 v208, v[84:87] offset:0
    v_cvt_pk_bf16_f32 v88, v175, v175
    v_cvt_pk_bf16_f32 v89, v175, v175
    v_cvt_pk_bf16_f32 v90, v207, v174
    v_cvt_pk_bf16_f32 v91, v174, v174
    ds_write_b128 v208, v[88:91] offset:4160
    v_cvt_pk_bf16_f32 v205, v160, v204
    v_cndmask_b32 v205, 0, v205, s[42:43]
    s_mov_b64 exec, 0xff
    ds_write_b32 v209, v205 offset:8256
    s_mov_b64 exec, -1
    v_mov_b32 v116, 0
    v_mov_b32 v117, 0
    v_mov_b32 v118, 0
    v_mov_b32 v119, 0
    v_mov_b32 v120, 0
    v_mov_b32 v121, 0
    v_mov_b32 v122, 0
    v_mov_b32 v123, 0
    v_mov_b32 v124, 0
    v_mov_b32 v125, 0
    v_mov_b32 v126, 0
    v_mov_b32 v127, 0
    v_mov_b32 v128, 0
    v_mov_b32 v129, 0
    v_mov_b32 v130, 0
    v_mov_b32 v131, 0
    v_mov_b32 v132, 0
    v_mov_b32 v133, 0
    v_mov_b32 v134, 0
    v_mov_b32 v135, 0
    v_mov_b32 v136, 0
    v_mov_b32 v137, 0
    v_mov_b32 v138, 0
    v_mov_b32 v139, 0
    v_mov_b32 v140, 0
    v_mov_b32 v141, 0
    v_mov_b32 v142, 0
    v_mov_b32 v143, 0
    v_mov_b32 v144, 0
    v_mov_b32 v145, 0
    v_mov_b32 v146, 0
    v_mov_b32 v147, 0
    s_branch aux_l_25
aux_l_24:
    s_cmp_lg_u32 s32, 0
    s_cbranch_scc1 noclr_37
    s_sub_u32 s3, s57, 240
    s_cbranch_scc1 noclr_37
    s_mul_i32 s3, s3, 6144
    s_add_u32 s3, s3, 15990784
    v_lshlrev_b32 v10, 7, v1
    v_mov_b32 v4, 0
    v_mov_b32 v5, 0
    v_mov_b32 v6, 0
    v_mov_b32 v7, 0
    s_mov_b32 exec_hi, 0xffff
    buffer_store_dwordx4 v[4:7], v10, s[16:19], s3 offen sc1
    v_mov_b32 v8, 1
    v_mov_b32 v9, 1
    s_mov_b64 exec, 1
    s_waitcnt vmcnt(0)
    buffer_atomic_add v8, v4, s[28:31], 0 offen sc0 sc1
    s_waitcnt vmcnt(0)
    v_cmp_eq_u32 vcc, 15, v8
    s_cbranch_vccz noclr_37x
    buffer_store_dword v9, v4, s[28:31], 0 offen offset:128 sc1
noclr_37x:
    s_mov_b64 exec, -1
noclr_37:
    s_bfe_u32 s3, s2, 0x30003
    s_mul_i32 s3, s3, 160
    v_add_u32 v232, 0, v1
    v_mul_u32_u24 v233, 205, v232
    v_lshrrev_b32 v233, 11, v233
    v_mul_u32_u24 v233, 1120, v233
    v_lshl_add_u32 v233, v232, 4, v233
    v_add_u32 v12, s3, v233
    v_add_u32 v232, 64, v1
    v_mul_u32_u24 v233, 205, v232
    v_lshrrev_b32 v233, 11, v233
    v_mul_u32_u24 v233, 1120, v233
    v_lshl_add_u32 v233, v232, 4, v233
    v_add_u32 v13, s3, v233
    v_add_u32 v232, 128, v1
    v_mul_u32_u24 v233, 205, v232
    v_lshrrev_b32 v233, 11, v233
    v_mul_u32_u24 v233, 1120, v233
    v_lshl_add_u32 v233, v232, 4, v233
    v_add_u32 v14, s3, v233
    v_add_u32 v232, 192, v1
    v_mul_u32_u24 v233, 205, v232
    v_lshrrev_b32 v233, 11, v233
    v_mul_u32_u24 v233, 1120, v233
    v_lshl_add_u32 v233, v232, 4, v233
    v_add_u32 v15, s3, v233
    v_add_u32 v232, 256, v1
    v_mul_u32_u24 v233, 205, v232
    v_lshrrev_b32 v233, 11, v233
    v_mul_u32_u24 v233, 1120, v233
    v_lshl_add_u32 v233, v232, 4, v233
    v_add_u32 v254, s3, v233
    s_lshr_b32 s48, s32, 1
    s_and_b32 s47, s32, 1
    v_lshrrev_b32 v233, 4, v1
    v_bfe_u32 v232, v1, 2, 2
    v_lshl_add_u32 v232, v233, 3, v232
    v_mul_u32_u24 v232, 160, v232
    v_and_b32 v234, 3, v1
    s_mul_i32 s3, s48, 5120
    v_add_u32 v232, s3, v232
    v_lshl_add_u32 v4, v234, 4, v232
    v_lshl_add_u32 v5, v234, 3, v232
    s_and_b32 s3, s2, 7
    s_lshl_b32 s44, s3, 2
    s_lshr_b32 s3, s2, 6
    s_add_u32 s44, s44, s3
    s_lshl_b32 s45, s44, 10
    s_lshl_b32 s3, s47, 9
    s_add_u32 s45, s45, s3
    s_lshl_b32 s3, s48, 17
    s_add_u32 s45, s45, s3
    s_add_u32 s45, s45, 8126464
    v_and_b32 v232, 15, v1
    v_lshlrev_b32 v234, 15, v233
    v_lshl_add_u32 v234, v232, 4, v234
    s_lshl_b32 s3, s48, 8
    v_add_u32 v6, s3, v234
    v_xor_b32 v7, 256, v6
    s_bfe_u32 s3, s2, 0x30003
    s_lshl3_add_u32 s51, s44, s3
    s_lshl_b32 s51, s51, 7
    s_add_u32 s51, s51, 16052224
    s_lshl_b32 s46, s44, 6
    s_lshl_b32 s3, s47, 5
    s_add_u32 s46, s46, s3
    s_lshl_b32 s3, s48, 4
    s_add_u32 s46, s46, s3
    s_mul_i32 s46, s46, 2560
    s_bfe_u32 s3, s2, 0x30003
    s_mul_i32 s3, s3, 160
    s_add_u32 s46, s46, s3
    v_mul_u32_u24 v232, 2560, v232
    v_lshl_add_u32 v9, v233, 3, v232
    v_lshl_add_u32 v8, v233, 4, v232
    s_mul_i32 s3, s32, 5120
    s_add_u32 s3, s3, 61440
    v_lshl_add_u32 v10, v1, 4, s3
    s_xor_b32 s3, s32, 2
    s_mul_i32 s3, s3, 5120
    s_add_u32 s3, s3, 61440
    v_lshl_add_u32 v11, v1, 4, s3
    v_mov_b32 v216, 0
    v_mov_b32 v217, 0
    v_mov_b32 v218, 0
    v_mov_b32 v219, 0
    v_mov_b32 v220, 0
    v_mov_b32 v221, 0
    v_mov_b32 v222, 0
    v_mov_b32 v223, 0
    v_mov_b32 v224, 0
    v_mov_b32 v225, 0
    v_mov_b32 v226, 0
    v_mov_b32 v227, 0
    v_mov_b32 v228, 0
    v_mov_b32 v229, 0
    v_mov_b32 v230, 0
    v_mov_b32 v231, 0
    v_mov_b32 v232, 0
    v_mov_b32 v233, 0
    v_mov_b32 v234, 0
    v_mov_b32 v235, 0
    v_mov_b32 v236, 0
    v_mov_b32 v237, 0
    v_mov_b32 v238, 0
    v_mov_b32 v239, 0
    v_mov_b32 v240, 0
    v_mov_b32 v241, 0
    v_mov_b32 v242, 0
    v_mov_b32 v243, 0
    v_mov_b32 v244, 0
    v_mov_b32 v245, 0
    v_mov_b32 v246, 0
    v_mov_b32 v247, 0
    v_mov_b32 v248, 0
    v_mov_b32 v249, 0
    v_mov_b32 v250, 0
    v_mov_b32 v251, 0
    v_mov_b32 v252, 0
    v_mov_b32 v253, 0
    s_waitcnt vmcnt(0)
    s_sub_u32 s33, s57, 160
    s_lshl_b32 s33, s33, 1
    s_lshr_b32 s34, s33, 4
    s_and_b32 s35, s33, 15
    s_mov_b32 s60, 0x05040100
    s_mov_b32 s61, 0x07060302
    s_mul_i32 s62, s34, 128
    s_add_u32 s63, s62, s35
    s_add_u32 s63, s63, 16084992
    s_add_u32 s62, s62, 16086272
    s_sub_u32 s3, s57, 160
    s_cmp_ge_u32 s3, 80
    s_cbranch_scc1 aux_l_25
    s_setprio 3
    s_cmp_lg_u32 s32, 0
    s_cbranch_scc1 aux_hw_38
    s_mov_b32 s58, 64
spin_top_39:
    s_load_dword s3, s[16:17], s56 glc
    s_waitcnt lgkmcnt(0)
    s_and_b32 s3, s3, 8
    s_cbranch_scc1 spin_ok_40
    s_sub_u32 s58, s58, 1
    s_cbranch_scc1 spin_ok_40
    s_sleep 3
    s_branch spin_top_39
spin_ok_40:
aux_hw_38:
    s_barrier
    s_lshl_b32 s36, s35, 7
    s_lshl_b32 s37, s32, 5
    s_add_u32 s36, s36, s37
    s_mul_i32 s36, s36, 1280
    s_lshl_b32 s37, s34, 7
    s_add_u32 s36, s36, s37
    s_add_u32 s37, s36, 163840
    v_lshrrev_b32 v116, 3, v1
    v_and_b32 v117, 7, v1
    v_mul_u32_u24 v118, 5120, v116
    v_lshl_add_u32 v118, v117, 4, v118
    buffer_load_dwordx4 v[16:19], v118, s[8:11], s36 offen offset:0
    buffer_load_dwordx4 v[20:23], v118, s[8:11], s36 offen offset:1280
    buffer_load_dwordx4 v[24:27], v118, s[8:11], s36 offen offset:2560
    buffer_load_dwordx4 v[28:31], v118, s[8:11], s36 offen offset:3840
    buffer_load_dwordx4 v[32:35], v118, s[8:11], s37 offen offset:0
    buffer_load_dwordx4 v[36:39], v118, s[8:11], s37 offen offset:1280
    buffer_load_dwordx4 v[40:43], v118, s[8:11], s37 offen offset:2560
    buffer_load_dwordx4 v[44:47], v118, s[8:11], s37 offen offset:3840
    v_lshrrev_b32 v119, 4, v0
    v_xor_b32 v119, v119, v117
    v_lshlrev_b32 v119, 4, v119
    v_lshl_add_u32 v119, v117, 11, v119
    v_and_b32 v120, 1, v116
    v_lshl_add_u32 v119, v120, 3, v119
    s_lshl_b32 s37, s32, 12
    v_lshl_add_u32 v116, v1, 4, s37
    s_lshl_b32 s36, s33, 14
    s_add_u32 s36, s36, s37
    s_add_u32 s36, s36, 10747904
    s_lshl_b32 s37, s32, 1
    v_xor_b32 v117, s37, v1
    v_lshlrev_b32 v117, 4, v117
    v_xor_b32 v118, 16, v117
    s_add_u32 s37, s36, 16384
    s_waitcnt vmcnt(4)
    v_perm_b32 v48, v20, v16, s60
    v_perm_b32 v49, v28, v24, s60
    ds_write_b64 v119, v[48:49] offset:0
    v_perm_b32 v50, v20, v16, s61
    v_perm_b32 v51, v28, v24, s61
    ds_write_b64 v119, v[50:51] offset:256
    v_perm_b32 v52, v21, v17, s60
    v_perm_b32 v53, v29, v25, s60
    ds_write_b64 v119, v[52:53] offset:512
    v_perm_b32 v54, v21, v17, s61
    v_perm_b32 v55, v29, v25, s61
    ds_write_b64 v119, v[54:55] offset:768
    v_perm_b32 v56, v22, v18, s60
    v_perm_b32 v57, v30, v26, s60
    ds_write_b64 v119, v[56:57] offset:1024
    v_perm_b32 v58, v22, v18, s61
    v_perm_b32 v59, v30, v26, s61
    ds_write_b64 v119, v[58:59] offset:1280
    v_perm_b32 v60, v23, v19, s60
    v_perm_b32 v61, v31, v27, s60
    ds_write_b64 v119, v[60:61] offset:1536
    v_perm_b32 v62, v23, v19, s61
    v_perm_b32 v63, v31, v27, s61
    ds_write_b64 v119, v[62:63] offset:1792
    s_waitcnt vmcnt(0)
    v_perm_b32 v64, v36, v32, s60
    v_perm_b32 v65, v44, v40, s60
    ds_write_b64 v119, v[64:65] offset:16384
    v_perm_b32 v66, v36, v32, s61
    v_perm_b32 v67, v44, v40, s61
    ds_write_b64 v119, v[66:67] offset:16640
    v_perm_b32 v68, v37, v33, s60
    v_perm_b32 v69, v45, v41, s60
    ds_write_b64 v119, v[68:69] offset:16896
    v_perm_b32 v70, v37, v33, s61
    v_perm_b32 v71, v45, v41, s61
    ds_write_b64 v119, v[70:71] offset:17152
    v_perm_b32 v72, v38, v34, s60
    v_perm_b32 v73, v46, v42, s60
    ds_write_b64 v119, v[72:73] offset:17408
    v_perm_b32 v74, v38, v34, s61
    v_perm_b32 v75, v46, v42, s61
    ds_write_b64 v119, v[74:75] offset:17664
    v_perm_b32 v76, v39, v35, s60
    v_perm_b32 v77, v47, v43, s60
    ds_write_b64 v119, v[76:77] offset:17920
    v_perm_b32 v78, v39, v35, s61
    v_perm_b32 v79, v47, v43, s61
    ds_write_b64 v119, v[78:79] offset:18176
    s_waitcnt lgkmcnt(0)
    s_barrier
    ds_read_b128 v[16:19], v116 offset:0
    ds_read_b128 v[20:23], v116 offset:1024
    ds_read_b128 v[24:27], v116 offset:2048
    ds_read_b128 v[28:31], v116 offset:3072
    ds_read_b128 v[32:35], v116 offset:16384
    ds_read_b128 v[36:39], v116 offset:17408
    ds_read_b128 v[40:43], v116 offset:18432
    ds_read_b128 v[44:47], v116 offset:19456
    s_waitcnt lgkmcnt(0)
    buffer_store_dwordx4 v[16:19], v117, s[16:19], s36 offen offset:0 sc1
    buffer_store_dwordx4 v[20:23], v117, s[16:19], s36 offen offset:1024 sc1
    buffer_store_dwordx4 v[24:27], v118, s[16:19], s36 offen offset:2048 sc1
    buffer_store_dwordx4 v[28:31], v118, s[16:19], s36 offen offset:3072 sc1
    buffer_store_dwordx4 v[32:35], v117, s[16:19], s37 offen offset:0 sc1
    buffer_store_dwordx4 v[36:39], v117, s[16:19], s37 offen offset:1024 sc1
    buffer_store_dwordx4 v[40:43], v118, s[16:19], s37 offen offset:2048 sc1
    buffer_store_dwordx4 v[44:47], v118, s[16:19], s37 offen offset:3072 sc1
    buffer_load_dword v2, off, s[28:31], 0 offset:128 sc1
    s_waitcnt vmcnt(0)
    s_barrier
    s_cmp_lg_u32 s32, 0
    s_cbranch_scc1 aux_l_25
    s_mov_b32 s58, 0x40000
clr_top_41:
    v_cmp_eq_u32 vcc, 0, v2
    s_cbranch_vccz clr_ok_42
    s_sub_u32 s58, s58, 1
    s_cbranch_scc1 clr_ok_42
    s_sleep 8
    buffer_load_dword v2, off, s[28:31], 0 offset:128 sc1
    s_waitcnt vmcnt(0)
    s_branch clr_top_41
clr_ok_42:
    v_mov_b32 v2, 0x0101
    v_mov_b32 v3, 0
    s_mov_b64 exec, 1
    buffer_store_short v2, v3, s[16:19], s63 offen sc1
    s_mov_b64 exec, -1
aux_l_25:
    s_setprio 0
    s_cmp_lg_u32 s32, 0
    s_cbranch_scc1 aux_hw_43
    s_mov_b32 s58, 64
spin_top_44:
    s_load_dword s3, s[16:17], s56 glc
    s_waitcnt lgkmcnt(0)
    s_and_b32 s3, s3, 2
    s_cbranch_scc1 spin_ok_45
    s_sub_u32 s58, s58, 1
    s_cbranch_scc1 spin_ok_45
    s_sleep 3
    s_branch spin_top_44
spin_ok_45:
aux_hw_43:
    s_barrier
    buffer_load_dword v255, off, s[28:31], 0 offset:128 sc1
    s_mul_i32 s3, s48, 15360
    s_add_u32 s3, s3, 15360
    v_add_u32 v2, s3, v4
    v_add_u32 v3, s3, v5
    s_lshl_b32 s3, s32, 3
    s_lshr_b32 s4, 0x5040100, s3
    s_and_b32 s4, s4, 0xff
    s_mul_i32 s4, s4, 40960
    s_lshr_b32 s5, 0xf0b0703, s3
    s_and_b32 s5, s5, 0xff
    s_mul_i32 s5, s5, 5120
    s_add_u32 m0, s5, 0
    s_nop 0
    buffer_load_dwordx4 v12, s[20:23], s4 offen lds
    s_waitcnt vmcnt(3)
    s_add_u32 m0, s5, 1024
    s_nop 0
    buffer_load_dwordx4 v13, s[20:23], s4 offen lds
    s_waitcnt vmcnt(3)
    s_add_u32 m0, s5, 2048
    s_nop 0
    buffer_load_dwordx4 v14, s[20:23], s4 offen lds
    s_waitcnt vmcnt(3)
    s_add_u32 m0, s5, 3072
    s_nop 0
    buffer_load_dwordx4 v15, s[20:23], s4 offen lds
    s_waitcnt vmcnt(3)
    s_add_u32 m0, s5, 4096
    s_nop 0
    buffer_load_dwordx4 v254, s[20:23], s4 offen lds
    s_waitcnt vmcnt(3)
    s_waitcnt vmcnt(0)
    s_barrier
    ds_read_b64_tr_b16 v[16:17], v2 offset:0
    ds_read_b64_tr_b16 v[18:19], v2 offset:640
    ds_read_b64_tr_b16 v[20:21], v2 offset:8
    ds_read_b64_tr_b16 v[22:23], v2 offset:648
    ds_read_b64_tr_b16 v[24:25], v2 offset:64
    ds_read_b64_tr_b16 v[26:27], v2 offset:704
    ds_read_b64_tr_b16 v[28:29], v2 offset:72
    ds_read_b64_tr_b16 v[30:31], v2 offset:712
    ds_read_b64_tr_b16 v[32:33], v3 offset:128
    ds_read_b64_tr_b16 v[34:35], v3 offset:768
    ds_read_b64_tr_b16 v[36:37], v2 offset:40960
    ds_read_b64_tr_b16 v[38:39], v2 offset:41600
    ds_read_b64_tr_b16 v[40:41], v2 offset:40968
    ds_read_b64_tr_b16 v[42:43], v2 offset:41608
    ds_read_b64_tr_b16 v[44:45], v2 offset:41024
    ds_read_b64_tr_b16 v[46:47], v2 offset:41664
    ds_read_b64_tr_b16 v[48:49], v2 offset:41032
    ds_read_b64_tr_b16 v[50:51], v2 offset:41672
    ds_read_b64_tr_b16 v[52:53], v3 offset:41088
    ds_read_b64_tr_b16 v[54:55], v3 offset:41728
    s_waitcnt lgkmcnt(0)
    s_barrier
    s_lshl_b32 s3, s32, 3
    s_lshr_b32 s4, 0xd0c0908, s3
    s_and_b32 s4, s4, 0xff
    s_mul_i32 s4, s4, 40960
    s_lshr_b32 s5, 0xf0b0703, s3
    s_and_b32 s5, s5, 0xff
    s_mul_i32 s5, s5, 5120
    s_add_u32 m0, s5, 0
    s_nop 0
    buffer_load_dwordx4 v12, s[20:23], s4 offen lds
    s_waitcnt vmcnt(3)
    s_add_u32 m0, s5, 1024
    s_nop 0
    buffer_load_dwordx4 v13, s[20:23], s4 offen lds
    s_waitcnt vmcnt(3)
    s_add_u32 m0, s5, 2048
    s_nop 0
    buffer_load_dwordx4 v14, s[20:23], s4 offen lds
    s_waitcnt vmcnt(3)
    s_add_u32 m0, s5, 3072
    s_nop 0
    buffer_load_dwordx4 v15, s[20:23], s4 offen lds
    s_waitcnt vmcnt(3)
    s_add_u32 m0, s5, 4096
    s_nop 0
    buffer_load_dwordx4 v254, s[20:23], s4 offen lds
    s_waitcnt vmcnt(3)
    s_waitcnt vmcnt(0)
    s_barrier
    ds_read_b64_tr_b16 v[56:57], v2 offset:0
    ds_read_b64_tr_b16 v[58:59], v2 offset:640
    ds_read_b64_tr_b16 v[60:61], v2 offset:8
    ds_read_b64_tr_b16 v[62:63], v2 offset:648
    ds_read_b64_tr_b16 v[64:65], v2 offset:64
    ds_read_b64_tr_b16 v[66:67], v2 offset:704
    ds_read_b64_tr_b16 v[68:69], v2 offset:72
    ds_read_b64_tr_b16 v[70:71], v2 offset:712
    ds_read_b64_tr_b16 v[72:73], v3 offset:128
    ds_read_b64_tr_b16 v[74:75], v3 offset:768
    ds_read_b64_tr_b16 v[76:77], v2 offset:40960
    ds_read_b64_tr_b16 v[78:79], v2 offset:41600
    ds_read_b64_tr_b16 v[80:81], v2 offset:40968
    ds_read_b64_tr_b16 v[82:83], v2 offset:41608
    ds_read_b64_tr_b16 v[84:85], v2 offset:41024
    ds_read_b64_tr_b16 v[86:87], v2 offset:41664
    ds_read_b64_tr_b16 v[88:89], v2 offset:41032
    ds_read_b64_tr_b16 v[90:91], v2 offset:41672
    ds_read_b64_tr_b16 v[92:93], v3 offset:41088
    ds_read_b64_tr_b16 v[94:95], v3 offset:41728
    s_waitcnt lgkmcnt(0)
    s_barrier
    s_mov_b32 s58, 0x40000
clr_top_46:
    v_cmp_eq_u32 vcc, 0, v255
    s_cbranch_vccz clr_ok_47
    s_sub_u32 s58, s58, 1
    s_cbranch_scc1 clr_ok_47
    s_sleep 8
    buffer_load_dword v255, off, s[28:31], 0 offset:128 sc1
    s_waitcnt vmcnt(0)
    s_branch clr_top_46
clr_ok_47:
    s_cmp_ge_u32 s57, 160
    s_cbranch_scc1 aux_l_27
    s_setprio 3
    s_cmp_lg_u32 s32, 0
    s_cbranch_scc1 aux_l_28
    s_mov_b32 s58, 262144
spin_top_48:
    s_load_dwordx4 s[64:67], s[16:17], s62 glc
    s_waitcnt lgkmcnt(0)
    s_and_b64 s[64:65], s[64:65], s[66:67]
    s_and_b32 s64, s64, s65
    s_cmp_eq_u32 s64, 0x01010101
    s_cbranch_scc1 spin_ok_49
    s_sub_u32 s58, s58, 1
    s_cbranch_scc1 spin_ok_49
    s_sleep 3
    s_branch spin_top_48
spin_ok_49:
aux_l_28:
    s_barrier
    buffer_load_dwordx4 v[212:215], v244, s[16:19], s36 offen sc1
    s_add_u32 s36, s36, 65536
    buffer_load_dwordx4 v[216:219], v244, s[16:19], s36 offen sc1
    s_add_u32 s36, s36, 65536
    buffer_load_dwordx4 v[220:223], v244, s[16:19], s36 offen sc1
    s_add_u32 s36, s36, 65536
    buffer_load_dwordx4 v[224:227], v244, s[16:19], s36 offen sc1
    s_waitcnt vmcnt(3)
    ds_write_b128 v246, v[212:215] offset:8800
    s_waitcnt vmcnt(2)
    ds_write_b128 v246, v[216:219] offset:9824
    s_waitcnt vmcnt(1)
    ds_write_b128 v246, v[220:223] offset:10848
    s_waitcnt vmcnt(0)
    ds_write_b128 v246, v[224:227] offset:11872
    s_mov_b32 s41, 4
    s_waitcnt lgkmcnt(0)
    ds_read2_b32 v[180:181], v250 offset0:144 offset1:145
    ds_read2_b32 v[182:183], v250 offset0:146 offset1:147
    ds_read_b128 v[196:199], v248 offset:64
    ds_read2_b32 v[184:185], v250 offset0:16 offset1:17
    ds_read2_b32 v[186:187], v250 offset0:18 offset1:19
    ds_read_b128 v[200:203], v248 offset:576
    ds_read2_b32 v[188:189], v251 offset0:144 offset1:145
    ds_read2_b32 v[190:191], v251 offset0:146 offset1:147
    ds_read_b128 v[204:207], v248 offset:1088
    ds_read2_b32 v[192:193], v251 offset0:16 offset1:17
    ds_read2_b32 v[194:195], v251 offset0:18 offset1:19
    ds_read_b128 v[208:211], v248 offset:1600
    s_setprio 0
.p2align 3
cv_loop_50:
    s_waitcnt lgkmcnt(9)
    v_mfma_f32_16x16x32_bf16 v[116:119], v[180:183], v[196:199], v[116:119]
    ds_read2_b32 v[148:149], v252 offset0:144 offset1:145
    ds_read2_b32 v[150:151], v252 offset0:146 offset1:147
    ds_read_b128 v[164:167], v248 offset:2112
    s_waitcnt lgkmcnt(9)
    v_mfma_f32_16x16x32_bf16 v[120:123], v[184:187], v[196:199], v[120:123]
    ds_read2_b32 v[152:153], v252 offset0:16 offset1:17
    v_mfma_f32_16x16x32_bf16 v[124:127], v[184:187], v[200:203], v[124:127]
    ds_read2_b32 v[154:155], v252 offset0:18 offset1:19
    v_mfma_f32_16x16x32_bf16 v[120:123], v[180:183], v[200:203], v[120:123]
    ds_read_b128 v[168:171], v248 offset:2624
    s_waitcnt lgkmcnt(9)
    v_mfma_f32_16x16x32_bf16 v[124:127], v[188:191], v[196:199], v[124:127]
    ds_read2_b32 v[156:157], v253 offset0:144 offset1:145
    v_mfma_f32_16x16x32_bf16 v[128:131], v[188:191], v[200:203], v[128:131]
    ds_read2_b32 v[158:159], v253 offset0:146 offset1:147
    v_mfma_f32_16x16x32_bf16 v[132:135], v[188:191], v[204:207], v[132:135]
    ds_read_b128 v[172:175], v248 offset:3136
    v_mfma_f32_16x16x32_bf16 v[124:127], v[180:183], v[204:207], v[124:127]
    v_mfma_f32_16x16x32_bf16 v[128:131], v[184:187], v[204:207], v[128:131]
    s_waitcnt lgkmcnt(9)
    v_mfma_f32_16x16x32_bf16 v[128:131], v[192:195], v[196:199], v[128:131]
    ds_read2_b32 v[160:161], v253 offset0:16 offset1:17
    v_mfma_f32_16x16x32_bf16 v[132:135], v[192:195], v[200:203], v[132:135]
    ds_read2_b32 v[162:163], v253 offset0:18 offset1:19
    v_mfma_f32_16x16x32_bf16 v[136:139], v[192:195], v[204:207], v[136:139]
    ds_read_b128 v[176:179], v248 offset:3648
    v_mfma_f32_16x16x32_bf16 v[140:143], v[192:195], v[208:211], v[140:143]
    v_mfma_f32_16x16x32_bf16 v[128:131], v[180:183], v[208:211], v[128:131]
    v_mfma_f32_16x16x32_bf16 v[132:135], v[184:187], v[208:211], v[132:135]
    v_mfma_f32_16x16x32_bf16 v[136:139], v[188:191], v[208:211], v[136:139]
    s_waitcnt lgkmcnt(9)
    v_mfma_f32_16x16x32_bf16 v[132:135], v[148:151], v[196:199], v[132:135]
    ds_read2_b32 v[212:213], v250 offset0:128 offset1:129
    v_mfma_f32_16x16x32_bf16 v[136:139], v[148:151], v[200:203], v[136:139]
    ds_read2_b32 v[214:215], v250 offset0:130 offset1:131
    v_mfma_f32_16x16x32_bf16 v[140:143], v[148:151], v[204:207], v[140:143]
    ds_read_b128 v[228:231], v248 offset:0
    v_mfma_f32_16x16x32_bf16 v[144:147], v[148:151], v[208:211], v[144:147]
    v_mfma_f32_16x16x32_bf16 v[132:135], v[180:183], v[164:167], v[132:135]
    v_mfma_f32_16x16x32_bf16 v[136:139], v[184:187], v[164:167], v[136:139]
    v_mfma_f32_16x16x32_bf16 v[140:143], v[188:191], v[164:167], v[140:143]
    v_mfma_f32_16x16x32_bf16 v[144:147], v[192:195], v[164:167], v[144:147]
    s_waitcnt lgkmcnt(9)
    v_mfma_f32_16x16x32_bf16 v[136:139], v[152:155], v[196:199], v[136:139]
    ds_read2_b32 v[216:217], v250 offset0:0 offset1:1
    v_mfma_f32_16x16x32_bf16 v[140:143], v[152:155], v[200:203], v[140:143]
    ds_read2_b32 v[218:219], v250 offset0:2 offset1:3
    v_mfma_f32_16x16x32_bf16 v[144:147], v[152:155], v[204:207], v[144:147]
    ds_read_b128 v[232:235], v248 offset:512
    v_mfma_f32_16x16x32_bf16 v[136:139], v[180:183], v[168:171], v[136:139]
    v_mfma_f32_16x16x32_bf16 v[140:143], v[184:187], v[168:171], v[140:143]
    v_mfma_f32_16x16x32_bf16 v[144:147], v[188:191], v[168:171], v[144:147]
    s_waitcnt lgkmcnt(9)
    v_mfma_f32_16x16x32_bf16 v[140:143], v[156:159], v[196:199], v[140:143]
    ds_read2_b32 v[220:221], v251 offset0:128 offset1:129
    v_mfma_f32_16x16x32_bf16 v[144:147], v[156:159], v[200:203], v[144:147]
    ds_read2_b32 v[222:223], v251 offset0:130 offset1:131
    v_mfma_f32_16x16x32_bf16 v[140:143], v[180:183], v[172:175], v[140:143]
    ds_read_b128 v[236:239], v248 offset:1024
    v_mfma_f32_16x16x32_bf16 v[144:147], v[184:187], v[172:175], v[144:147]
    s_waitcnt lgkmcnt(9)
    v_mfma_f32_16x16x32_bf16 v[144:147], v[160:163], v[196:199], v[144:147]
    ds_read2_b32 v[224:225], v251 offset0:0 offset1:1
    ds_read2_b32 v[226:227], v251 offset0:2 offset1:3
    v_mfma_f32_16x16x32_bf16 v[144:147], v[180:183], v[176:179], v[144:147]
    ds_read_b128 v[240:243], v248 offset:1536
    s_waitcnt lgkmcnt(9)
    v_mfma_f32_16x16x32_bf16 v[116:119], v[212:215], v[228:231], v[116:119]
    ds_read2_b32 v[148:149], v252 offset0:128 offset1:129
    ds_read2_b32 v[150:151], v252 offset0:130 offset1:131
    ds_read_b128 v[164:167], v248 offset:2048
    s_waitcnt lgkmcnt(9)
    v_mfma_f32_16x16x32_bf16 v[120:123], v[216:219], v[228:231], v[120:123]
    ds_read2_b32 v[152:153], v252 offset0:0 offset1:1
    v_mfma_f32_16x16x32_bf16 v[124:127], v[216:219], v[232:235], v[124:127]
    ds_read2_b32 v[154:155], v252 offset0:2 offset1:3
    v_mfma_f32_16x16x32_bf16 v[120:123], v[212:215], v[232:235], v[120:123]
    ds_read_b128 v[168:171], v248 offset:2560
    s_waitcnt lgkmcnt(9)
    v_mfma_f32_16x16x32_bf16 v[124:127], v[220:223], v[228:231], v[124:127]
    ds_read2_b32 v[156:157], v253 offset0:128 offset1:129
    v_mfma_f32_16x16x32_bf16 v[128:131], v[220:223], v[232:235], v[128:131]
    ds_read2_b32 v[158:159], v253 offset0:130 offset1:131
    v_mfma_f32_16x16x32_bf16 v[132:135], v[220:223], v[236:239], v[132:135]
    ds_read_b128 v[172:175], v248 offset:3072
    v_mfma_f32_16x16x32_bf16 v[124:127], v[212:215], v[236:239], v[124:127]
    v_mfma_f32_16x16x32_bf16 v[128:131], v[216:219], v[236:239], v[128:131]
    s_waitcnt lgkmcnt(9)
    v_mfma_f32_16x16x32_bf16 v[128:131], v[224:227], v[228:231], v[128:131]
    ds_read2_b32 v[160:161], v253 offset0:0 offset1:1
    v_mfma_f32_16x16x32_bf16 v[132:135], v[224:227], v[232:235], v[132:135]
    ds_read2_b32 v[162:163], v253 offset0:2 offset1:3
    v_mfma_f32_16x16x32_bf16 v[136:139], v[224:227], v[236:239], v[136:139]
    ds_read_b128 v[176:179], v248 offset:3584
    v_mfma_f32_16x16x32_bf16 v[140:143], v[224:227], v[240:243], v[140:143]
    v_mfma_f32_16x16x32_bf16 v[128:131], v[212:215], v[240:243], v[128:131]
    v_mfma_f32_16x16x32_bf16 v[132:135], v[216:219], v[240:243], v[132:135]
    v_mfma_f32_16x16x32_bf16 v[136:139], v[220:223], v[240:243], v[136:139]
    s_waitcnt lgkmcnt(9)
    v_mfma_f32_16x16x32_bf16 v[132:135], v[148:151], v[228:231], v[132:135]
    v_subrev_u32 v248, 128, v248
    v_mfma_f32_16x16x32_bf16 v[136:139], v[148:151], v[232:235], v[136:139]
    v_subrev_u32 v250, 128, v250
    v_mfma_f32_16x16x32_bf16 v[140:143], v[148:151], v[236:239], v[140:143]
    v_subrev_u32 v251, 128, v251
    v_mfma_f32_16x16x32_bf16 v[144:147], v[148:151], v[240:243], v[144:147]
    v_subrev_u32 v252, 128, v252
    v_mfma_f32_16x16x32_bf16 v[132:135], v[212:215], v[164:167], v[132:135]
    v_subrev_u32 v253, 128, v253
    v_mfma_f32_16x16x32_bf16 v[136:139], v[216:219], v[164:167], v[136:139]
    ds_read2_b32 v[180:181], v250 offset0:144 offset1:145
    v_mfma_f32_16x16x32_bf16 v[140:143], v[220:223], v[164:167], v[140:143]
    ds_read2_b32 v[182:183], v250 offset0:146 offset1:147
    v_mfma_f32_16x16x32_bf16 v[144:147], v[224:227], v[164:167], v[144:147]
    ds_read_b128 v[196:199], v248 offset:64
    s_waitcnt lgkmcnt(9)
    v_mfma_f32_16x16x32_bf16 v[136:139], v[152:155], v[228:231], v[136:139]
    ds_read2_b32 v[184:185], v250 offset0:16 offset1:17
    v_mfma_f32_16x16x32_bf16 v[140:143], v[152:155], v[232:235], v[140:143]
    ds_read2_b32 v[186:187], v250 offset0:18 offset1:19
    v_mfma_f32_16x16x32_bf16 v[144:147], v[152:155], v[236:239], v[144:147]
    ds_read_b128 v[200:203], v248 offset:576
    v_mfma_f32_16x16x32_bf16 v[136:139], v[212:215], v[168:171], v[136:139]
    v_mfma_f32_16x16x32_bf16 v[140:143], v[216:219], v[168:171], v[140:143]
    v_mfma_f32_16x16x32_bf16 v[144:147], v[220:223], v[168:171], v[144:147]
    s_waitcnt lgkmcnt(9)
    v_mfma_f32_16x16x32_bf16 v[140:143], v[156:159], v[228:231], v[140:143]
    ds_read2_b32 v[188:189], v251 offset0:144 offset1:145
    v_mfma_f32_16x16x32_bf16 v[144:147], v[156:159], v[232:235], v[144:147]
    ds_read2_b32 v[190:191], v251 offset0:146 offset1:147
    v_mfma_f32_16x16x32_bf16 v[140:143], v[212:215], v[172:175], v[140:143]
    ds_read_b128 v[204:207], v248 offset:1088
    v_mfma_f32_16x16x32_bf16 v[144:147], v[216:219], v[172:175], v[144:147]
    s_waitcnt lgkmcnt(9)
    v_mfma_f32_16x16x32_bf16 v[144:147], v[160:163], v[228:231], v[144:147]
    ds_read2_b32 v[192:193], v251 offset0:16 offset1:17
    ds_read2_b32 v[194:195], v251 offset0:18 offset1:19
    v_mfma_f32_16x16x32_bf16 v[144:147], v[212:215], v[176:179], v[144:147]
    ds_read_b128 v[208:211], v248 offset:1600
    s_sub_u32 s41, s41, 1
    s_cmp_lg_u32 s41, 0
    s_cbranch_scc1 cv_loop_50
    s_setprio 3
    s_add_u32 s36, s38, 13369344
    s_waitcnt vmcnt(0) lgkmcnt(0)
    s_nop 2
    v_cvt_pk_bf16_f32 v148, v116, v117
    v_cvt_pk_bf16_f32 v149, v118, v119
    buffer_store_dwordx2 v[148:149], v249, s[16:19], s36 offen sc1
    s_add_u32 s36, s36, 32768
    v_cvt_pk_bf16_f32 v150, v120, v121
    v_cvt_pk_bf16_f32 v151, v122, v123
    buffer_store_dwordx2 v[150:151], v249, s[16:19], s36 offen sc1
    s_add_u32 s36, s36, 32768
    v_cvt_pk_bf16_f32 v152, v124, v125
    v_cvt_pk_bf16_f32 v153, v126, v127
    buffer_store_dwordx2 v[152:153], v249, s[16:19], s36 offen sc1
    s_add_u32 s36, s36, 32768
    v_cvt_pk_bf16_f32 v154, v128, v129
    v_cvt_pk_bf16_f32 v155, v130, v131
    buffer_store_dwordx2 v[154:155], v249, s[16:19], s36 offen sc1
    s_add_u32 s36, s36, 32768
    v_cvt_pk_bf16_f32 v156, v132, v133
    v_cvt_pk_bf16_f32 v157, v134, v135
    buffer_store_dwordx2 v[156:157], v249, s[16:19], s36 offen sc1
    s_add_u32 s36, s36, 32768
    v_cvt_pk_bf16_f32 v158, v136, v137
    v_cvt_pk_bf16_f32 v159, v138, v139
    buffer_store_dwordx2 v[158:159], v249, s[16:19], s36 offen sc1
    s_add_u32 s36, s36, 32768
    v_cvt_pk_bf16_f32 v160, v140, v141
    v_cvt_pk_bf16_f32 v161, v142, v143
    buffer_store_dwordx2 v[160:161], v249, s[16:19], s36 offen sc1
    s_add_u32 s36, s36, 32768
    v_cvt_pk_bf16_f32 v162, v144, v145
    v_cvt_pk_bf16_f32 v163, v146, v147
    buffer_store_dwordx2 v[162:163], v249, s[16:19], s36 offen sc1
    v_mov_b32 v216, 0
    v_mov_b32 v217, 0
    v_mov_b32 v218, 0
    v_mov_b32 v219, 0
    v_mov_b32 v220, 0
    v_mov_b32 v221, 0
    v_mov_b32 v222, 0
    v_mov_b32 v223, 0
    v_mov_b32 v224, 0
    v_mov_b32 v225, 0
    v_mov_b32 v226, 0
    v_mov_b32 v227, 0
    v_mov_b32 v228, 0
    v_mov_b32 v229, 0
    v_mov_b32 v230, 0
    v_mov_b32 v231, 0
    v_mov_b32 v232, 0
    v_mov_b32 v233, 0
    v_mov_b32 v234, 0
    v_mov_b32 v235, 0
    v_mov_b32 v236, 0
    v_mov_b32 v237, 0
    v_mov_b32 v238, 0
    v_mov_b32 v239, 0
    v_mov_b32 v240, 0
    v_mov_b32 v241, 0
    v_mov_b32 v242, 0
    v_mov_b32 v243, 0
    v_mov_b32 v244, 0
    v_mov_b32 v245, 0
    v_mov_b32 v246, 0
    v_mov_b32 v247, 0
    v_mov_b32 v248, 0
    v_mov_b32 v249, 0
    v_mov_b32 v250, 0
    v_mov_b32 v251, 0
    v_mov_b32 v252, 0
    v_mov_b32 v253, 0
    s_waitcnt vmcnt(0)
    s_barrier
    s_cmp_lg_u32 s32, 0
    s_cbranch_scc1 aux_l_27
    v_mov_b32 v2, 1
    v_mov_b32 v3, 0
    s_mov_b64 exec, 1
    buffer_store_byte v2, v3, s[16:19], s59 offen sc1
    s_mov_b64 exec, -1
aux_l_27:
    s_setprio 0
    s_lshl_b32 s3, s32, 3
    s_lshr_b32 s4, 0x11111110, s3
    s_and_b32 s4, s4, 0xff
    s_mul_i32 s4, s4, 40960
    s_lshr_b32 s5, 0xb0b0b0a, s3
    s_and_b32 s5, s5, 0xff
    s_mul_i32 s5, s5, 5120
    s_add_u32 m0, s5, 0
    s_nop 0
    buffer_load_dwordx4 v12, s[20:23], s4 offen lds
    s_waitcnt vmcnt(3)
    s_add_u32 m0, s5, 1024
    s_nop 0
    buffer_load_dwordx4 v13, s[20:23], s4 offen lds
    s_waitcnt vmcnt(3)
    s_add_u32 m0, s5, 2048
    s_nop 0
    buffer_load_dwordx4 v14, s[20:23], s4 offen lds
    s_waitcnt vmcnt(3)
    s_add_u32 m0, s5, 3072
    s_nop 0
    buffer_load_dwordx4 v15, s[20:23], s4 offen lds
    s_waitcnt vmcnt(3)
    s_add_u32 m0, s5, 4096
    s_nop 0
    buffer_load_dwordx4 v254, s[20:23], s4 offen lds
    s_waitcnt vmcnt(3)
    s_lshl_b32 s3, s32, 3
    s_lshr_b32 s4, 0x7060302, s3
    s_and_b32 s4, s4, 0xff
    s_mul_i32 s4, s4, 40960
    s_lshr_b32 s5, 0x3020100, s3
    s_and_b32 s5, s5, 0xff
    s_mul_i32 s5, s5, 5120
    s_add_u32 m0, s5, 0
    s_nop 0
    buffer_load_dwordx4 v12, s[20:23], s4 offen lds
    s_waitcnt vmcnt(3)
    s_add_u32 m0, s5, 1024
    s_nop 0
    buffer_load_dwordx4 v13, s[20:23], s4 offen lds
    s_waitcnt vmcnt(3)
    s_add_u32 m0, s5, 2048
    s_nop 0
    buffer_load_dwordx4 v14, s[20:23], s4 offen lds
    s_waitcnt vmcnt(3)
    s_add_u32 m0, s5, 3072
    s_nop 0
    buffer_load_dwordx4 v15, s[20:23], s4 offen lds
    s_waitcnt vmcnt(3)
    s_add_u32 m0, s5, 4096
    s_nop 0
    buffer_load_dwordx4 v254, s[20:23], s4 offen lds
    s_waitcnt vmcnt(3)
    s_lshl_b32 s3, s32, 3
    s_lshr_b32 s4, 0xf0e0b0a, s3
    s_and_b32 s4, s4, 0xff
    s_mul_i32 s4, s4, 40960
    s_lshr_b32 s5, 0x7060504, s3
    s_and_b32 s5, s5, 0xff
    s_mul_i32 s5, s5, 5120
    s_add_u32 m0, s5, 0
    s_nop 0
    buffer_load_dwordx4 v12, s[20:23], s4 offen lds
    s_waitcnt vmcnt(3)
    s_add_u32 m0, s5, 1024
    s_nop 0
    buffer_load_dwordx4 v13, s[20:23], s4 offen lds
    s_waitcnt vmcnt(3)
    s_add_u32 m0, s5, 2048
    s_nop 0
    buffer_load_dwordx4 v14, s[20:23], s4 offen lds
    s_waitcnt vmcnt(3)
    s_add_u32 m0, s5, 3072
    s_nop 0
    buffer_load_dwordx4 v15, s[20:23], s4 offen lds
    s_waitcnt vmcnt(3)
    s_add_u32 m0, s5, 4096
    s_nop 0
    buffer_load_dwordx4 v254, s[20:23], s4 offen lds
    s_waitcnt vmcnt(3)
    s_lshl_b32 s3, s32, 3
    s_lshr_b32 s4, 0x13131312, s3
    s_and_b32 s4, s4, 0xff
    s_mul_i32 s4, s4, 40960
    s_lshr_b32 s5, 0x9090908, s3
    s_and_b32 s5, s5, 0xff
    s_mul_i32 s5, s5, 5120
    s_add_u32 m0, s5, 0
    s_nop 0
    buffer_load_dwordx4 v12, s[20:23], s4 offen lds
    s_waitcnt vmcnt(3)
    s_add_u32 m0, s5, 1024
    s_nop 0
    buffer_load_dwordx4 v13, s[20:23], s4 offen lds
    s_waitcnt vmcnt(3)
    s_add_u32 m0, s5, 2048
    s_nop 0
    buffer_load_dwordx4 v14, s[20:23], s4 offen lds
    s_waitcnt vmcnt(3)
    s_add_u32 m0, s5, 3072
    s_nop 0
    buffer_load_dwordx4 v15, s[20:23], s4 offen lds
    s_waitcnt vmcnt(3)
    s_add_u32 m0, s5, 4096
    s_nop 0
    buffer_load_dwordx4 v254, s[20:23], s4 offen lds
    s_waitcnt vmcnt(3)
    v_add_u32 v2, 51200, v4
    v_add_u32 v3, 51200, v5
    s_waitcnt vmcnt(0)
    s_barrier
    ds_read_b64_tr_b16 v[96:97], v2 offset:0
    ds_read_b64_tr_b16 v[98:99], v2 offset:640
    ds_read_b64_tr_b16 v[100:101], v2 offset:8
    ds_read_b64_tr_b16 v[102:103], v2 offset:648
    ds_read_b64_tr_b16 v[104:105], v2 offset:64
    ds_read_b64_tr_b16 v[106:107], v2 offset:704
    ds_read_b64_tr_b16 v[108:109], v2 offset:72
    ds_read_b64_tr_b16 v[110:111], v2 offset:712
    ds_read_b64_tr_b16 v[112:113], v3 offset:128
    ds_read_b64_tr_b16 v[114:115], v3 offset:768
    s_waitcnt lgkmcnt(0)
    v_mov_b32 v254, 0
    v_mov_b32 v255, 0
    s_sub_u32 s3, s57, 160
    s_cmp_ge_u32 s3, 80
    s_cbranch_scc1 aux_l_29
    s_cmp_lg_u32 s32, 0
    s_cbranch_scc1 aux_l_30
    s_mov_b32 s58, 262144
spin_top_51:
    s_load_dwordx4 s[40:43], s[16:17], s62 glc
    s_waitcnt lgkmcnt(0)
    s_and_b64 s[40:41], s[40:41], s[42:43]
    s_and_b32 s40, s40, s41
    s_cmp_eq_u32 s40, 0x01010101
    s_cbranch_scc1 spin_ok_52
    s_sub_u32 s58, s58, 1
    s_cbranch_scc1 spin_ok_52
    s_sleep 5
    s_branch spin_top_51
spin_ok_52:
aux_l_30:
    s_barrier
    s_setprio 3
    v_lshrrev_b32 v136, 4, v1
    v_and_b32 v137, 15, v1
    v_lshlrev_b32 v138, 10, v136
    v_lshl_add_u32 v138, v137, 4, v138
    s_lshl_b32 s36, s33, 14
    s_lshl_b32 s38, s32, 12
    s_add_u32 s36, s36, s38
    s_add_u32 s36, s36, 13369344
    s_add_u32 s37, s36, 16384
    buffer_load_dwordx4 v[148:151], v138, s[16:19], s36 offen offset:0 sc1
    buffer_load_dwordx4 v[152:155], v138, s[16:19], s36 offen offset:256 sc1
    buffer_load_dwordx4 v[156:159], v138, s[16:19], s36 offen offset:512 sc1
    buffer_load_dwordx4 v[160:163], v138, s[16:19], s36 offen offset:768 sc1
    buffer_load_dwordx4 v[164:167], v138, s[16:19], s37 offen offset:0 sc1
    buffer_load_dwordx4 v[168:171], v138, s[16:19], s37 offen offset:256 sc1
    buffer_load_dwordx4 v[172:175], v138, s[16:19], s37 offen offset:512 sc1
    buffer_load_dwordx4 v[176:179], v138, s[16:19], s37 offen offset:768 sc1
    v_lshrrev_b32 v139, 5, v0
    v_xor_b32 v139, v139, v137
    v_and_b32 v139, 7, v139
    v_lshlrev_b32 v139, 4, v139
    v_lshl_add_u32 v139, v137, 10, v139
    v_and_b32 v140, 1, v136
    v_lshl_add_u32 v139, v140, 3, v139
    v_add_u32 v139, 0x10000, v139
    v_lshlrev_b32 v136, 4, v1
    v_add_u32 v136, s38, v136
    v_add_u32 v136, 0x10000, v136
    s_lshl_b32 s36, s35, 7
    s_lshl_b32 s37, s32, 5
    s_add_u32 s36, s36, s37
    s_mul_i32 s36, s36, 2560
    s_lshl_b32 s37, s34, 7
    s_add_u32 s36, s36, s37
    s_add_u32 s36, s36, 1280
    v_lshrrev_b32 v137, 3, v1
    v_mul_u32_u24 v137, 2560, v137
    s_lshl_b32 s37, s32, 2
    v_xor_b32 v138, s37, v1
    v_and_b32 v138, 7, v138
    v_xor_b32 v140, 0, v138
    v_lshl_add_u32 v141, v140, 4, v137
    v_xor_b32 v140, 1, v138
    v_lshl_add_u32 v142, v140, 4, v137
    v_xor_b32 v140, 2, v138
    v_lshl_add_u32 v143, v140, 4, v137
    v_xor_b32 v140, 3, v138
    v_lshl_add_u32 v144, v140, 4, v137
    s_waitcnt vmcnt(0)
    v_perm_b32 v180, v152, v148, s60
    v_perm_b32 v181, v160, v156, s60
    ds_write_b64 v139, v[180:181] offset:0
    v_perm_b32 v182, v152, v148, s61
    v_perm_b32 v183, v160, v156, s61
    ds_write_b64 v139, v[182:183] offset:128
    v_perm_b32 v184, v153, v149, s60
    v_perm_b32 v185, v161, v157, s60
    ds_write_b64 v139, v[184:185] offset:256
    v_perm_b32 v186, v153, v149, s61
    v_perm_b32 v187, v161, v157, s61
    ds_write_b64 v139, v[186:187] offset:384
    v_perm_b32 v188, v154, v150, s60
    v_perm_b32 v189, v162, v158, s60
    ds_write_b64 v139, v[188:189] offset:512
    v_perm_b32 v190, v154, v150, s61
    v_perm_b32 v191, v162, v158, s61
    ds_write_b64 v139, v[190:191] offset:640
    v_perm_b32 v192, v155, v151, s60
    v_perm_b32 v193, v163, v159, s60
    ds_write_b64 v139, v[192:193] offset:768
    v_perm_b32 v194, v155, v151, s61
    v_perm_b32 v195, v163, v159, s61
    ds_write_b64 v139, v[194:195] offset:896
    s_waitcnt lgkmcnt(0)
    s_barrier
    ds_read_b128 v[148:151], v136 offset:0
    ds_read_b128 v[152:155], v136 offset:1024
    ds_read_b128 v[156:159], v136 offset:2048
    ds_read_b128 v[160:163], v136 offset:3072
    s_waitcnt lgkmcnt(3)
    buffer_store_dwordx4 v[148:151], v141, s[24:27], s36 offen
    s_add_u32 s36, s36, 20480
    s_waitcnt lgkmcnt(2)
    buffer_store_dwordx4 v[152:155], v142, s[24:27], s36 offen
    s_add_u32 s36, s36, 20480
    s_waitcnt lgkmcnt(1)
    buffer_store_dwordx4 v[156:159], v143, s[24:27], s36 offen
    s_add_u32 s36, s36, 20480
    s_waitcnt lgkmcnt(0)
    buffer_store_dwordx4 v[160:163], v144, s[24:27], s36 offen
    s_add_u32 s36, s36, 266240
    s_barrier
    v_perm_b32 v180, v168, v164, s60
    v_perm_b32 v181, v176, v172, s60
    ds_write_b64 v139, v[180:181] offset:0
    v_perm_b32 v182, v168, v164, s61
    v_perm_b32 v183, v176, v172, s61
    ds_write_b64 v139, v[182:183] offset:128
    v_perm_b32 v184, v169, v165, s60
    v_perm_b32 v185, v177, v173, s60
    ds_write_b64 v139, v[184:185] offset:256
    v_perm_b32 v186, v169, v165, s61
    v_perm_b32 v187, v177, v173, s61
    ds_write_b64 v139, v[186:187] offset:384
    v_perm_b32 v188, v170, v166, s60
    v_perm_b32 v189, v178, v174, s60
    ds_write_b64 v139, v[188:189] offset:512
    v_perm_b32 v190, v170, v166, s61
    v_perm_b32 v191, v178, v174, s61
    ds_write_b64 v139, v[190:191] offset:640
    v_perm_b32 v192, v171, v167, s60
    v_perm_b32 v193, v179, v175, s60
    ds_write_b64 v139, v[192:193] offset:768
    v_perm_b32 v194, v171, v167, s61
    v_perm_b32 v195, v179, v175, s61
    ds_write_b64 v139, v[194:195] offset:896
    s_waitcnt lgkmcnt(0)
    s_barrier
    ds_read_b128 v[164:167], v136 offset:0
    ds_read_b128 v[168:171], v136 offset:1024
    ds_read_b128 v[172:175], v136 offset:2048
    ds_read_b128 v[176:179], v136 offset:3072
    s_waitcnt lgkmcnt(3)
    buffer_store_dwordx4 v[164:167], v141, s[24:27], s36 offen
    s_add_u32 s36, s36, 20480
    s_waitcnt lgkmcnt(2)
    buffer_store_dwordx4 v[168:171], v142, s[24:27], s36 offen
    s_add_u32 s36, s36, 20480
    s_waitcnt lgkmcnt(1)
    buffer_store_dwordx4 v[172:175], v143, s[24:27], s36 offen
    s_add_u32 s36, s36, 20480
    s_waitcnt lgkmcnt(0)
    buffer_store_dwordx4 v[176:179], v144, s[24:27], s36 offen
    s_add_u32 s36, s36, 266240
aux_l_29:
    s_cmp_lg_u32 s32, 0
    s_cbranch_scc1 aux_hw_53
    s_mov_b32 s58, 64
spin_top_54:
    s_load_dword s3, s[16:17], s56 glc
    s_waitcnt lgkmcnt(0)
    s_and_b32 s3, s3, 4
    s_cbranch_scc1 spin_ok_55
    s_sub_u32 s58, s58, 1
    s_cbranch_scc1 spin_ok_55
    s_sleep 3
    s_branch spin_top_54
spin_ok_55:
aux_hw_53:
    s_barrier
    s_mov_b32 s49, 0x1249
    s_mov_b32 s53, 0
    s_mov_b32 s58, 0x40000
op_again_56:
    s_load_dwordx4 s[36:39], s[16:17], s51 glc
    s_waitcnt lgkmcnt(0)
    s_mul_i32 s36, s36, 0x01020408
    s_mul_i32 s37, s37, 0x01020408
    s_mul_i32 s38, s38, 0x01020408
    s_mul_i32 s39, s39, 0x01020408
    s_bfe_u32 s36, s36, 0x40018
    s_bfe_u32 s37, s37, 0x40018
    s_bfe_u32 s38, s38, 0x40018
    s_bfe_u32 s39, s39, 0x40018
    s_lshl4_add_u32 s36, s37, s36
    s_lshl4_add_u32 s38, s39, s38
    s_lshl_b32 s38, s38, 8
    s_or_b32 s36, s36, s38
    s_lshr_b32 s3, s36, 1
    s_and_b32 s3, s3, s36
    s_lshr_b32 s4, s3, 2
    s_and_b32 s3, s3, s4
    s_and_b32 s50, s3, s49
    s_cbranch_scc1 op_go_58
    s_sub_u32 s58, s58, 1
    s_cbranch_scc1 op_fin_57
    s_sleep 1
    s_branch op_again_56
op_go_58:
    s_bitcmp1_b32 s50, 0
    s_cbranch_scc0 op_li_60
    s_add_u32 s3, s45, 0
    buffer_load_dwordx4 v[136:139], v6, s[16:19], s3 offen sc1
    buffer_load_dwordx4 v[140:143], v7, s[16:19], s3 offen sc1
    s_add_u32 s3, s45, 262144
    buffer_load_dwordx4 v[144:147], v6, s[16:19], s3 offen sc1
    buffer_load_dwordx4 v[148:151], v7, s[16:19], s3 offen sc1
op_li_60:
    s_bitcmp1_b32 s50, 3
    s_cbranch_scc0 op_li_61
    s_add_u32 s3, s45, 524288
    buffer_load_dwordx4 v[152:155], v6, s[16:19], s3 offen sc1
    buffer_load_dwordx4 v[156:159], v7, s[16:19], s3 offen sc1
    s_add_u32 s3, s45, 786432
    buffer_load_dwordx4 v[160:163], v6, s[16:19], s3 offen sc1
    buffer_load_dwordx4 v[164:167], v7, s[16:19], s3 offen sc1
op_li_61:
    s_bitcmp1_b32 s50, 6
    s_cbranch_scc0 op_li_62
    s_add_u32 s3, s45, 1048576
    buffer_load_dwordx4 v[168:171], v6, s[16:19], s3 offen sc1
    buffer_load_dwordx4 v[172:175], v7, s[16:19], s3 offen sc1
    s_add_u32 s3, s45, 1310720
    buffer_load_dwordx4 v[176:179], v6, s[16:19], s3 offen sc1
    buffer_load_dwordx4 v[180:183], v7, s[16:19], s3 offen sc1
op_li_62:
    s_bitcmp1_b32 s50, 9
    s_cbranch_scc0 op_li_63
    s_add_u32 s3, s45, 1572864
    buffer_load_dwordx4 v[184:187], v6, s[16:19], s3 offen sc1
    buffer_load_dwordx4 v[188:191], v7, s[16:19], s3 offen sc1
    s_add_u32 s3, s45, 1835008
    buffer_load_dwordx4 v[192:195], v6, s[16:19], s3 offen sc1
    buffer_load_dwordx4 v[196:199], v7, s[16:19], s3 offen sc1
op_li_63:
    s_bitcmp1_b32 s50, 12
    s_cbranch_scc0 op_li_64
    s_add_u32 s3, s45, 2097152
    buffer_load_dwordx4 v[200:203], v6, s[16:19], s3 offen sc1
    buffer_load_dwordx4 v[204:207], v7, s[16:19], s3 offen sc1
    s_add_u32 s3, s45, 2359296
    buffer_load_dwordx4 v[208:211], v6, s[16:19], s3 offen sc1
    buffer_load_dwordx4 v[212:215], v7, s[16:19], s3 offen sc1
op_li_64:
    s_andn2_b32 s49, s49, s50
    s_cbranch_scc0 op_last_65
    s_or_b32 s53, s53, s50
    s_branch op_again_56
op_last_65:
    s_bcnt1_i32_b32 s3, s50
    s_cmp_gt_u32 s3, 4
    s_cbranch_scc1 op_cmp_59
    s_waitcnt vmcnt(16)
    s_cmp_gt_u32 s3, 3
    s_cbranch_scc1 op_cmp_59
    s_waitcnt vmcnt(12)
    s_cmp_gt_u32 s3, 2
    s_cbranch_scc1 op_cmp_59
    s_waitcnt vmcnt(8)
    s_cmp_gt_u32 s3, 1
    s_cbranch_scc1 op_cmp_59
    s_waitcnt vmcnt(4)
op_cmp_59:
    s_bitcmp1_b32 s53, 0
    s_cbranch_scc0 op_lc_66
    v_mfma_f32_16x16x32_bf16 v[216:219], v[16:19], v[136:139], v[216:219]
    ds_read_b64_tr_b16 v[116:117], v4 offset:0
    ds_read_b64_tr_b16 v[118:119], v4 offset:640
    v_mfma_f32_16x16x32_bf16 v[220:223], v[16:19], v[140:143], v[220:223]
    ds_read_b64_tr_b16 v[120:121], v4 offset:8
    ds_read_b64_tr_b16 v[122:123], v4 offset:648
    v_mfma_f32_16x16x32_bf16 v[224:227], v[20:23], v[136:139], v[224:227]
    ds_read_b64_tr_b16 v[124:125], v4 offset:64
    ds_read_b64_tr_b16 v[126:127], v4 offset:704
    v_mfma_f32_16x16x32_bf16 v[228:231], v[20:23], v[140:143], v[228:231]
    ds_read_b64_tr_b16 v[128:129], v4 offset:72
    ds_read_b64_tr_b16 v[130:131], v4 offset:712
    v_mfma_f32_16x16x32_bf16 v[232:235], v[24:27], v[136:139], v[232:235]
    ds_read_b64_tr_b16 v[132:133], v5 offset:128
    ds_read_b64_tr_b16 v[134:135], v5 offset:768
    v_mfma_f32_16x16x32_bf16 v[236:239], v[24:27], v[140:143], v[236:239]
    v_mfma_f32_16x16x32_bf16 v[240:243], v[28:31], v[136:139], v[240:243]
    v_mfma_f32_16x16x32_bf16 v[244:247], v[28:31], v[140:143], v[244:247]
    v_mfma_f32_16x16x32_bf16 v[248:251], v[32:35], v[136:139], v[248:251]
    v_mfma_f32_16x16x32_bf16 v[252:255], v[32:35], v[140:143], v[252:255]
    s_waitcnt lgkmcnt(0)
    v_mfma_f32_16x16x32_bf16 v[216:219], v[116:119], v[144:147], v[216:219]
    v_mfma_f32_16x16x32_bf16 v[220:223], v[116:119], v[148:151], v[220:223]
    v_mfma_f32_16x16x32_bf16 v[224:227], v[120:123], v[144:147], v[224:227]
    v_mfma_f32_16x16x32_bf16 v[228:231], v[120:123], v[148:151], v[228:231]
    v_mfma_f32_16x16x32_bf16 v[232:235], v[124:127], v[144:147], v[232:235]
    v_mfma_f32_16x16x32_bf16 v[236:239], v[124:127], v[148:151], v[236:239]
    v_mfma_f32_16x16x32_bf16 v[240:243], v[128:131], v[144:147], v[240:243]
    v_mfma_f32_16x16x32_bf16 v[244:247], v[128:131], v[148:151], v[244:247]
    v_mfma_f32_16x16x32_bf16 v[248:251], v[132:135], v[144:147], v[248:251]
    v_mfma_f32_16x16x32_bf16 v[252:255], v[132:135], v[148:151], v[252:255]
op_lc_66:
    s_bitcmp1_b32 s53, 3
    s_cbranch_scc0 op_lc_67
    v_mfma_f32_16x16x32_bf16 v[216:219], v[36:39], v[152:155], v[216:219]
    ds_read_b64_tr_b16 v[116:117], v4 offset:10240
    ds_read_b64_tr_b16 v[118:119], v4 offset:10880
    v_mfma_f32_16x16x32_bf16 v[220:223], v[36:39], v[156:159], v[220:223]
    ds_read_b64_tr_b16 v[120:121], v4 offset:10248
    ds_read_b64_tr_b16 v[122:123], v4 offset:10888
    v_mfma_f32_16x16x32_bf16 v[224:227], v[40:43], v[152:155], v[224:227]
    ds_read_b64_tr_b16 v[124:125], v4 offset:10304
    ds_read_b64_tr_b16 v[126:127], v4 offset:10944
    v_mfma_f32_16x16x32_bf16 v[228:231], v[40:43], v[156:159], v[228:231]
    ds_read_b64_tr_b16 v[128:129], v4 offset:10312
    ds_read_b64_tr_b16 v[130:131], v4 offset:10952
    v_mfma_f32_16x16x32_bf16 v[232:235], v[44:47], v[152:155], v[232:235]
    ds_read_b64_tr_b16 v[132:133], v5 offset:10368
    ds_read_b64_tr_b16 v[134:135], v5 offset:11008
    v_mfma_f32_16x16x32_bf16 v[236:239], v[44:47], v[156:159], v[236:239]
    v_mfma_f32_16x16x32_bf16 v[240:243], v[48:51], v[152:155], v[240:243]
    v_mfma_f32_16x16x32_bf16 v[244:247], v[48:51], v[156:159], v[244:247]
    v_mfma_f32_16x16x32_bf16 v[248:251], v[52:55], v[152:155], v[248:251]
    v_mfma_f32_16x16x32_bf16 v[252:255], v[52:55], v[156:159], v[252:255]
    s_waitcnt lgkmcnt(0)
    v_mfma_f32_16x16x32_bf16 v[216:219], v[116:119], v[160:163], v[216:219]
    v_mfma_f32_16x16x32_bf16 v[220:223], v[116:119], v[164:167], v[220:223]
    v_mfma_f32_16x16x32_bf16 v[224:227], v[120:123], v[160:163], v[224:227]
    v_mfma_f32_16x16x32_bf16 v[228:231], v[120:123], v[164:167], v[228:231]
    v_mfma_f32_16x16x32_bf16 v[232:235], v[124:127], v[160:163], v[232:235]
    v_mfma_f32_16x16x32_bf16 v[236:239], v[124:127], v[164:167], v[236:239]
    v_mfma_f32_16x16x32_bf16 v[240:243], v[128:131], v[160:163], v[240:243]
    v_mfma_f32_16x16x32_bf16 v[244:247], v[128:131], v[164:167], v[244:247]
    v_mfma_f32_16x16x32_bf16 v[248:251], v[132:135], v[160:163], v[248:251]
    v_mfma_f32_16x16x32_bf16 v[252:255], v[132:135], v[164:167], v[252:255]
op_lc_67:
    s_bitcmp1_b32 s53, 6
    s_cbranch_scc0 op_lc_68
    v_mfma_f32_16x16x32_bf16 v[216:219], v[56:59], v[168:171], v[216:219]
    ds_read_b64_tr_b16 v[116:117], v4 offset:20480
    ds_read_b64_tr_b16 v[118:119], v4 offset:21120
    v_mfma_f32_16x16x32_bf16 v[220:223], v[56:59], v[172:175], v[220:223]
    ds_read_b64_tr_b16 v[120:121], v4 offset:20488
    ds_read_b64_tr_b16 v[122:123], v4 offset:21128
    v_mfma_f32_16x16x32_bf16 v[224:227], v[60:63], v[168:171], v[224:227]
    ds_read_b64_tr_b16 v[124:125], v4 offset:20544
    ds_read_b64_tr_b16 v[126:127], v4 offset:21184
    v_mfma_f32_16x16x32_bf16 v[228:231], v[60:63], v[172:175], v[228:231]
    ds_read_b64_tr_b16 v[128:129], v4 offset:20552
    ds_read_b64_tr_b16 v[130:131], v4 offset:21192
    v_mfma_f32_16x16x32_bf16 v[232:235], v[64:67], v[168:171], v[232:235]
    ds_read_b64_tr_b16 v[132:133], v5 offset:20608
    ds_read_b64_tr_b16 v[134:135], v5 offset:21248
    v_mfma_f32_16x16x32_bf16 v[236:239], v[64:67], v[172:175], v[236:239]
    v_mfma_f32_16x16x32_bf16 v[240:243], v[68:71], v[168:171], v[240:243]
    v_mfma_f32_16x16x32_bf16 v[244:247], v[68:71], v[172:175], v[244:247]
    v_mfma_f32_16x16x32_bf16 v[248:251], v[72:75], v[168:171], v[248:251]
    v_mfma_f32_16x16x32_bf16 v[252:255], v[72:75], v[172:175], v[252:255]
    s_waitcnt lgkmcnt(0)
    v_mfma_f32_16x16x32_bf16 v[216:219], v[116:119], v[176:179], v[216:219]
    v_mfma_f32_16x16x32_bf16 v[220:223], v[116:119], v[180:183], v[220:223]
    v_mfma_f32_16x16x32_bf16 v[224:227], v[120:123], v[176:179], v[224:227]
    v_mfma_f32_16x16x32_bf16 v[228:231], v[120:123], v[180:183], v[228:231]
    v_mfma_f32_16x16x32_bf16 v[232:235], v[124:127], v[176:179], v[232:235]
    v_mfma_f32_16x16x32_bf16 v[236:239], v[124:127], v[180:183], v[236:239]
    v_mfma_f32_16x16x32_bf16 v[240:243], v[128:131], v[176:179], v[240:243]
    v_mfma_f32_16x16x32_bf16 v[244:247], v[128:131], v[180:183], v[244:247]
    v_mfma_f32_16x16x32_bf16 v[248:251], v[132:135], v[176:179], v[248:251]
    v_mfma_f32_16x16x32_bf16 v[252:255], v[132:135], v[180:183], v[252:255]
op_lc_68:
    s_bitcmp1_b32 s53, 9
    s_cbranch_scc0 op_lc_69
    v_mfma_f32_16x16x32_bf16 v[216:219], v[76:79], v[184:187], v[216:219]
    ds_read_b64_tr_b16 v[116:117], v4 offset:30720
    ds_read_b64_tr_b16 v[118:119], v4 offset:31360
    v_mfma_f32_16x16x32_bf16 v[220:223], v[76:79], v[188:191], v[220:223]
    ds_read_b64_tr_b16 v[120:121], v4 offset:30728
    ds_read_b64_tr_b16 v[122:123], v4 offset:31368
    v_mfma_f32_16x16x32_bf16 v[224:227], v[80:83], v[184:187], v[224:227]
    ds_read_b64_tr_b16 v[124:125], v4 offset:30784
    ds_read_b64_tr_b16 v[126:127], v4 offset:31424
    v_mfma_f32_16x16x32_bf16 v[228:231], v[80:83], v[188:191], v[228:231]
    ds_read_b64_tr_b16 v[128:129], v4 offset:30792
    ds_read_b64_tr_b16 v[130:131], v4 offset:31432
    v_mfma_f32_16x16x32_bf16 v[232:235], v[84:87], v[184:187], v[232:235]
    ds_read_b64_tr_b16 v[132:133], v5 offset:30848
    ds_read_b64_tr_b16 v[134:135], v5 offset:31488
    v_mfma_f32_16x16x32_bf16 v[236:239], v[84:87], v[188:191], v[236:239]
    v_mfma_f32_16x16x32_bf16 v[240:243], v[88:91], v[184:187], v[240:243]
    v_mfma_f32_16x16x32_bf16 v[244:247], v[88:91], v[188:191], v[244:247]
    v_mfma_f32_16x16x32_bf16 v[248:251], v[92:95], v[184:187], v[248:251]
    v_mfma_f32_16x16x32_bf16 v[252:255], v[92:95], v[188:191], v[252:255]
    s_waitcnt lgkmcnt(0)
    v_mfma_f32_16x16x32_bf16 v[216:219], v[116:119], v[192:195], v[216:219]
    v_mfma_f32_16x16x32_bf16 v[220:223], v[116:119], v[196:199], v[220:223]
    v_mfma_f32_16x16x32_bf16 v[224:227], v[120:123], v[192:195], v[224:227]
    v_mfma_f32_16x16x32_bf16 v[228:231], v[120:123], v[196:199], v[228:231]
    v_mfma_f32_16x16x32_bf16 v[232:235], v[124:127], v[192:195], v[232:235]
    v_mfma_f32_16x16x32_bf16 v[236:239], v[124:127], v[196:199], v[236:239]
    v_mfma_f32_16x16x32_bf16 v[240:243], v[128:131], v[192:195], v[240:243]
    v_mfma_f32_16x16x32_bf16 v[244:247], v[128:131], v[196:199], v[244:247]
    v_mfma_f32_16x16x32_bf16 v[248:251], v[132:135], v[192:195], v[248:251]
    v_mfma_f32_16x16x32_bf16 v[252:255], v[132:135], v[196:199], v[252:255]
op_lc_69:
    s_bitcmp1_b32 s53, 12
    s_cbranch_scc0 op_lc_70
    v_mfma_f32_16x16x32_bf16 v[216:219], v[96:99], v[200:203], v[216:219]
    ds_read_b64_tr_b16 v[116:117], v4 offset:40960
    ds_read_b64_tr_b16 v[118:119], v4 offset:41600
    v_mfma_f32_16x16x32_bf16 v[220:223], v[96:99], v[204:207], v[220:223]
    ds_read_b64_tr_b16 v[120:121], v4 offset:40968
    ds_read_b64_tr_b16 v[122:123], v4 offset:41608
    v_mfma_f32_16x16x32_bf16 v[224:227], v[100:103], v[200:203], v[224:227]
    ds_read_b64_tr_b16 v[124:125], v4 offset:41024
    ds_read_b64_tr_b16 v[126:127], v4 offset:41664
    v_mfma_f32_16x16x32_bf16 v[228:231], v[100:103], v[204:207], v[228:231]
    ds_read_b64_tr_b16 v[128:129], v4 offset:41032
    ds_read_b64_tr_b16 v[130:131], v4 offset:41672
    v_mfma_f32_16x16x32_bf16 v[232:235], v[104:107], v[200:203], v[232:235]
    ds_read_b64_tr_b16 v[132:133], v5 offset:41088
    ds_read_b64_tr_b16 v[134:135], v5 offset:41728
    v_mfma_f32_16x16x32_bf16 v[236:239], v[104:107], v[204:207], v[236:239]
    v_mfma_f32_16x16x32_bf16 v[240:243], v[108:111], v[200:203], v[240:243]
    v_mfma_f32_16x16x32_bf16 v[244:247], v[108:111], v[204:207], v[244:247]
    v_mfma_f32_16x16x32_bf16 v[248:251], v[112:115], v[200:203], v[248:251]
    v_mfma_f32_16x16x32_bf16 v[252:255], v[112:115], v[204:207], v[252:255]
    s_waitcnt lgkmcnt(0)
    v_mfma_f32_16x16x32_bf16 v[216:219], v[116:119], v[208:211], v[216:219]
    v_mfma_f32_16x16x32_bf16 v[220:223], v[116:119], v[212:215], v[220:223]
    v_mfma_f32_16x16x32_bf16 v[224:227], v[120:123], v[208:211], v[224:227]
    v_mfma_f32_16x16x32_bf16 v[228:231], v[120:123], v[212:215], v[228:231]
    v_mfma_f32_16x16x32_bf16 v[232:235], v[124:127], v[208:211], v[232:235]
    v_mfma_f32_16x16x32_bf16 v[236:239], v[124:127], v[212:215], v[236:239]
    v_mfma_f32_16x16x32_bf16 v[240:243], v[128:131], v[208:211], v[240:243]
    v_mfma_f32_16x16x32_bf16 v[244:247], v[128:131], v[212:215], v[244:247]
    v_mfma_f32_16x16x32_bf16 v[248:251], v[132:135], v[208:211], v[248:251]
    v_mfma_f32_16x16x32_bf16 v[252:255], v[132:135], v[212:215], v[252:255]
op_lc_70:
    s_mov_b32 s53, s50
    s_mov_b32 s50, 0
    s_waitcnt vmcnt(0)
    s_cmp_lg_u32 s53, 0
    s_cbranch_scc1 op_cmp_59
op_fin_57:
    s_nop 3
    ds_write_b128 v10, v[220:223] offset:0
    ds_write_b128 v10, v[228:231] offset:1024
    ds_write_b128 v10, v[236:239] offset:2048
    ds_write_b128 v10, v[244:247] offset:3072
    ds_write_b128 v10, v[252:255] offset:4096
    s_waitcnt lgkmcnt(0)
    s_barrier
    ds_read_b128 v[220:223], v11 offset:0
    ds_read_b128 v[228:231], v11 offset:1024
    ds_read_b128 v[236:239], v11 offset:2048
    ds_read_b128 v[244:247], v11 offset:3072
    ds_read_b128 v[252:255], v11 offset:4096
    s_waitcnt lgkmcnt(4)
    v_pk_add_f32 v[216:217], v[216:217], v[220:221]
    v_pk_add_f32 v[218:219], v[218:219], v[222:223]
    v_cvt_pk_bf16_f32 v136, v216, v217
    v_cvt_pk_bf16_f32 v137, v218, v219
    s_waitcnt lgkmcnt(3)
    v_pk_add_f32 v[224:225], v[224:225], v[228:229]
    v_pk_add_f32 v[226:227], v[226:227], v[230:231]
    v_cvt_pk_bf16_f32 v138, v224, v225
    v_cvt_pk_bf16_f32 v139, v226, v227
    buffer_store_dwordx4 v[136:139], v8, s[24:27], s46 offen
    s_waitcnt lgkmcnt(2)
    v_pk_add_f32 v[232:233], v[232:233], v[236:237]
    v_pk_add_f32 v[234:235], v[234:235], v[238:239]
    v_cvt_pk_bf16_f32 v140, v232, v233
    v_cvt_pk_bf16_f32 v141, v234, v235
    s_waitcnt lgkmcnt(1)
    v_pk_add_f32 v[240:241], v[240:241], v[244:245]
    v_pk_add_f32 v[242:243], v[242:243], v[246:247]
    v_cvt_pk_bf16_f32 v142, v240, v241
    v_cvt_pk_bf16_f32 v143, v242, v243
    buffer_store_dwordx4 v[140:143], v8, s[24:27], s46 offen offset:64
    s_waitcnt lgkmcnt(0)
    v_pk_add_f32 v[248:249], v[248:249], v[252:253]
    v_pk_add_f32 v[250:251], v[250:251], v[254:255]
    v_cvt_pk_bf16_f32 v144, v248, v249
    v_cvt_pk_bf16_f32 v145, v250, v251
    buffer_store_dwordx2 v[144:145], v9, s[24:27], s46 offen offset:128
    s_endpgm
at_late_17:
    s_mov_b32 exec_lo, s34
    s_mov_b32 exec_hi, 0
    buffer_load_dword v2, v254, s[16:19], 0 offen sc1
    s_mov_b32 s58, 0x40000
poll_top_71:
    s_waitcnt vmcnt(0)
    v_cmp_ne_u32 vcc, 0x1010101, v2
    s_cbranch_vccz poll_ok_72
    s_mov_b64 exec, vcc
    s_sub_u32 s58, s58, 1
    s_cbranch_scc1 poll_ok_72
    s_sleep 1
    buffer_load_dword v2, v254, s[16:19], 0 offen sc1
    s_branch poll_top_71
poll_ok_72:
    s_mov_b64 exec, -1
    s_branch at_late_back_18
at_late_17b:
    s_mov_b64 exec, vcc
    buffer_load_dword v2, v254, s[16:19], 0 offen sc1
    s_mov_b32 s58, 0x40000
poll_top_73:
    s_waitcnt vmcnt(0)
    v_cmp_ne_u32 vcc, 0x1010101, v2
    s_cbranch_vccz poll_ok_74
    s_mov_b64 exec, vcc
    s_sub_u32 s58, s58, 1
    s_cbranch_scc1 poll_ok_74
    s_sleep 1
    buffer_load_dword v2, v254, s[16:19], 0 offen sc1
    s_branch poll_top_73
poll_ok_74:
    s_mov_b64 exec, -1
    s_branch at_late_back_18b
at_slow_20:
    s_mov_b32 s33, 1
    s_waitcnt vmcnt(0)
    v_mov_b32 v4, 0xff800000
    v_mov_b32 v5, 0xff800000
    s_mov_b32 s47, 2621440
    s_mov_b32 s49, 0
    s_mov_b32 s46, 64
slow_loop_75:
    buffer_load_dwordx4 v[172:175], v250, s[16:19], s47 offen offset:0 sc1
    buffer_load_dwordx2 v[220:221], v251, s[16:19], s47 offen offset:0 sc1
    s_waitcnt vmcnt(0)
    v_mfma_f32_32x32x4_2b_bf16 v[24:55], v[220:221], v[168:169], 0 cbsz:1 abid:0
    s_nop 15
    s_nop 1
    v_mfma_f32_32x32x16_bf16 v[24:39], v[172:175], v[152:155], v[24:39]
    v_mfma_f32_32x32x16_bf16 v[40:55], v[172:175], v[156:159], v[40:55]
    s_nop 11
    v_max3_f32 v4, v4, v24, v25
    v_max3_f32 v4, v4, v26, v27
    v_max3_f32 v4, v4, v28, v29
    v_max3_f32 v4, v4, v30, v31
    v_max3_f32 v4, v4, v32, v33
    v_max3_f32 v4, v4, v34, v35
    v_max3_f32 v4, v4, v36, v37
    v_max3_f32 v4, v4, v38, v39
    v_max3_f32 v5, v5, v40, v41
    v_max3_f32 v5, v5, v42, v43
    v_max3_f32 v5, v5, v44, v45
    v_max3_f32 v5, v5, v46, v47
    v_max3_f32 v5, v5, v48, v49
    v_max3_f32 v5, v5, v50, v51
    v_max3_f32 v5, v5, v52, v53
    v_max3_f32 v5, v5, v54, v55
    s_add_u32 s47, s47, 512
    s_add_u32 s49, s49, 8704
    s_sub_u32 s46, s46, 1
    s_cmp_lg_u32 s46, 0
    s_cbranch_scc1 slow_loop_75
    v_mov_b32 v6, v4
    v_mov_b32 v7, v4
    s_nop 1
    v_permlane32_swap_b32 v6, v7
    s_nop 1
    v_max_f32 v4, v6, v7
    v_mov_b32 v6, v5
    v_mov_b32 v7, v5
    s_nop 1
    v_permlane32_swap_b32 v6, v7
    s_nop 1
    v_max_f32 v5, v6, v7
    v_mov_b32 v88, 0
    v_mov_b32 v89, 0
    v_mov_b32 v90, 0
    v_mov_b32 v91, 0
    v_mov_b32 v92, 0
    v_mov_b32 v93, 0
    v_mov_b32 v94, 0
    v_mov_b32 v95, 0
    v_mov_b32 v96, 0
    v_mov_b32 v97, 0
    v_mov_b32 v98, 0
    v_mov_b32 v99, 0
    v_mov_b32 v100, 0
    v_mov_b32 v101, 0
    v_mov_b32 v102, 0
    v_mov_b32 v103, 0
    v_mov_b32 v104, 0
    v_mov_b32 v105, 0
    v_mov_b32 v106, 0
    v_mov_b32 v107, 0
    v_mov_b32 v108, 0
    v_mov_b32 v109, 0
    v_mov_b32 v110, 0
    v_mov_b32 v111, 0
    v_mov_b32 v112, 0
    v_mov_b32 v113, 0
    v_mov_b32 v114, 0
    v_mov_b32 v115, 0
    v_mov_b32 v116, 0
    v_mov_b32 v117, 0
    v_mov_b32 v118, 0
    v_mov_b32 v119, 0
    s_mov_b32 s47, 2621440
    s_mov_b32 s49, 0
    s_mov_b32 s46, 64
slow_loop_76:
    buffer_load_dwordx4 v[172:175], v250, s[16:19], s47 offen offset:0 sc1
    buffer_load_dwordx2 v[220:221], v251, s[16:19], s47 offen offset:0 sc1
    buffer_load_dwordx4 v[176:179], v252, s[16:19], s49 offen sc1
    buffer_load_dwordx4 v[180:183], v252, s[16:19], s49 offen offset:2176 sc1
    s_waitcnt vmcnt(0)
    v_mfma_f32_32x32x4_2b_bf16 v[24:55], v[220:221], v[168:169], 0 cbsz:1 abid:0
    s_nop 15
    s_nop 1
    v_mfma_f32_32x32x16_bf16 v[24:39], v[172:175], v[152:155], v[24:39]
    v_mfma_f32_32x32x16_bf16 v[40:55], v[172:175], v[156:159], v[40:55]
    s_nop 11
    v_sub_f32 v24, v24, v4
    v_sub_f32 v25, v25, v4
    v_sub_f32 v26, v26, v4
    v_sub_f32 v27, v27, v4
    v_sub_f32 v28, v28, v4
    v_sub_f32 v29, v29, v4
    v_sub_f32 v30, v30, v4
    v_sub_f32 v31, v31, v4
    v_sub_f32 v32, v32, v4
    v_sub_f32 v33, v33, v4
    v_sub_f32 v34, v34, v4
    v_sub_f32 v35, v35, v4
    v_sub_f32 v36, v36, v4
    v_sub_f32 v37, v37, v4
    v_sub_f32 v38, v38, v4
    v_sub_f32 v39, v39, v4
    v_sub_f32 v40, v40, v5
    v_sub_f32 v41, v41, v5
    v_sub_f32 v42, v42, v5
    v_sub_f32 v43, v43, v5
    v_sub_f32 v44, v44, v5
    v_sub_f32 v45, v45, v5
    v_sub_f32 v46, v46, v5
    v_sub_f32 v47, v47, v5
    v_sub_f32 v48, v48, v5
    v_sub_f32 v49, v49, v5
    v_sub_f32 v50, v50, v5
    v_sub_f32 v51, v51, v5
    v_sub_f32 v52, v52, v5
    v_sub_f32 v53, v53, v5
    v_sub_f32 v54, v54, v5
    v_sub_f32 v55, v55, v5
    v_exp_f32 v24, v24
    v_exp_f32 v25, v25
    v_exp_f32 v26, v26
    v_exp_f32 v27, v27
    v_exp_f32 v28, v28
    v_exp_f32 v29, v29
    v_exp_f32 v30, v30
    v_exp_f32 v31, v31
    v_exp_f32 v32, v32
    v_exp_f32 v33, v33
    v_exp_f32 v34, v34
    v_exp_f32 v35, v35
    v_exp_f32 v36, v36
    v_exp_f32 v37, v37
    v_exp_f32 v38, v38
    v_exp_f32 v39, v39
    v_exp_f32 v40, v40
    v_exp_f32 v41, v41
    v_exp_f32 v42, v42
    v_exp_f32 v43, v43
    v_exp_f32 v44, v44
    v_exp_f32 v45, v45
    v_exp_f32 v46, v46
    v_exp_f32 v47, v47
    v_exp_f32 v48, v48
    v_exp_f32 v49, v49
    v_exp_f32 v50, v50
    v_exp_f32 v51, v51
    v_exp_f32 v52, v52
    v_exp_f32 v53, v53
    v_exp_f32 v54, v54
    v_exp_f32 v55, v55
    v_cvt_pk_bf16_f32 v224, v24, v25
    v_cvt_pk_bf16_f32 v225, v26, v27
    v_cvt_pk_bf16_f32 v226, v28, v29
    v_cvt_pk_bf16_f32 v227, v30, v31
    v_cvt_pk_bf16_f32 v228, v32, v33
    v_cvt_pk_bf16_f32 v229, v34, v35
    v_cvt_pk_bf16_f32 v230, v36, v37
    v_cvt_pk_bf16_f32 v231, v38, v39
    v_cvt_pk_bf16_f32 v232, v40, v41
    v_cvt_pk_bf16_f32 v233, v42, v43
    v_cvt_pk_bf16_f32 v234, v44, v45
    v_cvt_pk_bf16_f32 v235, v46, v47
    v_cvt_pk_bf16_f32 v236, v48, v49
    v_cvt_pk_bf16_f32 v237, v50, v51
    v_cvt_pk_bf16_f32 v238, v52, v53
    v_cvt_pk_bf16_f32 v239, v54, v55
    s_nop 1
    v_mfma_f32_32x32x16_bf16 v[88:103], v[176:179], v[224:227], v[88:103]
    v_mfma_f32_32x32x16_bf16 v[88:103], v[180:183], v[228:231], v[88:103]
    v_mfma_f32_32x32x16_bf16 v[104:119], v[176:179], v[232:235], v[104:119]
    v_mfma_f32_32x32x16_bf16 v[104:119], v[180:183], v[236:239], v[104:119]
    s_add_u32 s47, s47, 512
    s_add_u32 s49, s49, 8704
    s_sub_u32 s46, s46, 1
    s_cmp_lg_u32 s46, 0
    s_cbranch_scc1 slow_loop_76
    s_nop 11
    s_branch at_back_21
code_end:
.fill (46080 - (code_end - concat_heads__mha_block__ssm_conv_s4d__prompt_kernel)) / 4, 4, 0xbf810000
.section .rodata,"a"
.p2align 6
.amdhsa_kernel concat_heads__mha_block__ssm_conv_s4d__prompt_kernel
  .amdhsa_next_free_vgpr 256
  .amdhsa_next_free_sgpr 102
  .amdhsa_accum_offset 256
  .amdhsa_group_segment_fixed_size 0
  .amdhsa_kernarg_size 104
  .amdhsa_user_sgpr_count 2
  .amdhsa_user_sgpr_kernarg_segment_ptr 1
  .amdhsa_system_sgpr_workgroup_id_x 1
.end_amdhsa_kernel
```
